```python
import torch

def _softmax(x, axis=-1):
    return torch.softmax(x, dim=axis)

def _gelu(x):
    return torch.nn.functional.gelu(x, approximate='tanh')

def _silu(x):
    return torch.nn.functional.silu(x)

def _sigmoid(x):
    return torch.sigmoid(x)

def _layernorm(x, axis=-1, eps=1e-05):
    m = x.mean(dim=axis, keepdim=True)
    v = x.var(dim=axis, keepdim=True, unbiased=False)
    return (x - m) / torch.sqrt(v + eps)

def _scatter_add(tgt, idx, src, axis=0):
    return tgt.clone().index_add_(axis, idx, src)

def _segment_sum(src, seg, n):
    out = torch.zeros((n,) + src.shape[1:], dtype=src.dtype)
    return out.index_add_(0, seg, src)

def _pad(x, pw):
    flat = tuple((v for pair in reversed(pw) for v in pair))
    return torch.nn.functional.pad(x, flat)
kernel_name = 'interleave_layers__memory_aug_recurrent_mem_tr__swiglu_ffn__prompt'

def setup_inputs():

    _w = lambda a: (lambda t: t.to(torch.bfloat16) if t.is_floating_point() else t)(torch.as_tensor(a))

    def _A_setup():
        B, S, Dm = (1, 2048, 512)
        H, Dh = (32, 128)
        M, seg = (8, 32)
        seg = min(seg, S)
        S = S // seg * seg
        return {'x': _w((lambda *s: torch.randn(*s, dtype=torch.bfloat16) * 0.05)(B, S, Dm)), 'mem0': _w((lambda *s: torch.randn(*s, dtype=torch.bfloat16) * 0.8)(B, M, Dm)), 'Wq': _w((lambda *s: torch.randn(*s, dtype=torch.bfloat16) * 0.8)(Dm, H, Dh) * Dm ** (-0.5)), 'Wk': _w((lambda *s: torch.randn(*s, dtype=torch.bfloat16) * 0.8)(Dm, H, Dh) * Dm ** (-0.5)), 'Wv': _w((lambda *s: torch.randn(*s, dtype=torch.bfloat16) * 0.8)(Dm, H, Dh) * Dm ** (-0.5)), 'Wo': _w((lambda *s: torch.randn(*s, dtype=torch.bfloat16) * 0.8)(H, Dh, Dm) * (H * Dh) ** (-0.5)), 'seg_len': seg}
    _A_in = _A_setup()

    def _B_setup():
        B, S, D, F = (1, 2048, 512, 1792)
        return {'x': _w((lambda *s: torch.randn(*s, dtype=torch.bfloat16) * 0.05)(B, S, D)), 'w_gate': _w((lambda *s: torch.randn(*s, dtype=torch.bfloat16) * 0.05)(D, F)), 'w_up': _w((lambda *s: torch.randn(*s, dtype=torch.bfloat16) * 0.05)(D, F)), 'w_down': _w((lambda *s: torch.randn(*s, dtype=torch.bfloat16) * 0.05)(F, D))}
    _B_in = _B_setup()
    return {'A_x': _A_in['x'], 'A_mem0': _A_in['mem0'], 'A_Wq': _A_in['Wq'], 'A_Wk': _A_in['Wk'], 'A_Wv': _A_in['Wv'], 'A_Wo': _A_in['Wo'], 'A_seg_len': _A_in['seg_len'], 'B_x': _B_in['x'], 'B_w_gate': _B_in['w_gate'], 'B_w_up': _B_in['w_up'], 'B_w_down': _B_in['w_down']}

def reference(A_x, A_mem0, A_Wq, A_Wk, A_Wv, A_Wo, A_seg_len, B_x, B_w_gate, B_w_up, B_w_down):

    def _A_ref(x, mem0, Wq, Wk, Wv, Wo, seg_len):
        B, S, Dm = x.shape
        H, Dh = (Wq.shape[1], Wq.shape[2])
        M = mem0.shape[1]
        scale = Dh ** (-0.5)
        n_seg = S // seg_len
        L = M + seg_len
        idx = torch.arange(L)
        mask = (idx[:, None] < M) | (idx[:, None] >= idx[None, :])
        mem = mem0
        outs = []
        for s in range(n_seg):
            xs = x[:, s * seg_len:(s + 1) * seg_len, :].clone()
            h = torch.concatenate([mem, xs], axis=1)
            q = torch.einsum('btd,dhe->bhte', h, Wq)
            k = torch.einsum('btd,dhe->bhte', h, Wk)
            v = torch.einsum('btd,dhe->bhte', h, Wv)
            scores = torch.einsum('bhqe,bhke->bhqk', q, k) * scale
            scores = torch.where(mask[None, None], scores, -1000000000.0)
            p = _softmax(scores, axis=-1)
            o = torch.einsum('bhqk,bhke->bhqe', p, v)
            o = torch.einsum('bhte,hed->btd', o, Wo)
            mem = o[:, :M, :].clone()
            outs.append(o[:, M:, :])
        return torch.concatenate(outs, axis=1)

    def _B_ref(x, w_gate, w_up, w_down):
        g = _silu(x @ w_gate)
        u = x @ w_up
        return g * u @ w_down
    x = A_x
    x = x + _A_ref(_layernorm(x, axis=-1), A_mem0, A_Wq, A_Wk, A_Wv, A_Wo, A_seg_len)
    x = x + _B_ref(_layernorm(x, axis=-1), B_w_gate, B_w_up, B_w_down)
    x = x + _A_ref(_layernorm(x, axis=-1), A_mem0, A_Wq, A_Wk, A_Wv, A_Wo, A_seg_len)
    x = x + _B_ref(_layernorm(x, axis=-1), B_w_gate, B_w_up, B_w_down)
    return x
```

```asm
; @launch grid=(256,1,1) block=(256,1,1) lds=163840
.amdgcn_target "amdgcn-amd-amdhsa--gfx950"
.text
.globl interleave_layers__memory_aug_recurrent_mem_tr__swiglu_ffn__prompt_kernel
.p2align 8
.type interleave_layers__memory_aug_recurrent_mem_tr__swiglu_ffn__prompt_kernel,@function
interleave_layers__memory_aug_recurrent_mem_tr__swiglu_ffn__prompt_kernel:
    s_cmp_ge_u32 s2, 256
    s_cbranch_scc1 L_exit
    s_load_dwordx2 s[4:5], s[0:1], 104
    s_load_dwordx2 s[8:9], s[0:1], 96
    s_getreg_b32 s28, hwreg(HW_REG_XCC_ID, 0, 3)
    v_lshrrev_b32 v1, 6, v0
    v_and_b32 v0, 63, v0
    v_readfirstlane_b32 s30, v1
    s_mov_b32 s31, 0
    s_waitcnt lgkmcnt(0)
    s_mov_b32 s6, 0x10000000
    s_mov_b32 s7, 0x20000
    s_mov_b32 s10, 256
    s_mov_b32 s11, 0x20000
    s_cmp_eq_u32 s30, 0
    s_cbranch_scc0 L_tick1
    s_mov_b64 exec, 1
    v_mov_b32 v1, 1
    s_lshl_b32 s3, s28, 2
    v_mov_b32 v2, s3
    buffer_atomic_add v1, v2, s[8:11], 0 offen sc0
    s_waitcnt vmcnt(0)
    v_mov_b32 v2, 0
    ds_write_b32 v2, v1
    v_mov_b32 v3, 163776
    v_mov_b32 v4, 0
    v_mov_b32 v5, 0
    ds_write_b64 v3, v[4:5]
    s_waitcnt lgkmcnt(0)
    s_mov_b64 exec, -1
L_tick1:
    s_barrier
    v_mov_b32 v2, 0
    ds_read_b32 v1, v2
    s_waitcnt lgkmcnt(0)
    v_readfirstlane_b32 s29, v1
    s_barrier
    s_nop 2
    s_cmp_ge_u32 s29, 32
    s_cbranch_scc1 L_exit
    s_cmp_eq_u32 s30, 0
    s_cbranch_scc0 L_zf
    s_cmp_lt_u32 s28, 4
    s_cbranch_scc1 L_zf
    s_sub_u32 s3, s28, 4
    s_lshl_b32 s3, s3, 5
    s_add_u32 s3, s3, s29
    s_mul_i32 s3, s3, 6144
    v_lshlrev_b32 v1, 4, v0
    v_mov_b32 v4, 0
    v_mov_b32 v5, 0
    v_mov_b32 v6, 0
    v_mov_b32 v7, 0
    buffer_store_dwordx4 v[4:7], v1, s[4:7], s3 offen offset:0 sc1
    buffer_store_dwordx4 v[4:7], v1, s[4:7], s3 offen offset:1024 sc1
    buffer_store_dwordx4 v[4:7], v1, s[4:7], s3 offen offset:2048 sc1
    buffer_store_dwordx4 v[4:7], v1, s[4:7], s3 offen offset:3072 sc1
    s_add_u32 s3, s3, 4096
    buffer_store_dwordx4 v[4:7], v1, s[4:7], s3 offen offset:0 sc1
    buffer_store_dwordx4 v[4:7], v1, s[4:7], s3 offen offset:1024 sc1
    s_nop 1
L_zf:
    s_cmp_lt_u32 s28, 2
    s_cbranch_scc1 L_chain
    s_cmp_lt_u32 s28, 4
    s_cbranch_scc1 L_s1j
    s_cmp_eq_u32 s28, 4
    s_cbranch_scc0 L_n4
    s_mov_b32 s52, s29
    s_branch L_miscj
L_n4:
    s_cmp_lt_u32 s28, 7
    s_cbranch_scc0 L_x7
    s_sub_u32 s52, s28, 5
    s_cmp_lt_u32 s29, 16
    s_cbranch_scc0 L_x56b
    s_lshr_b32 s53, s29, 2
    s_and_b32 s54, s29, 3
    s_branch L_s3j
L_x56b:
    s_cmp_lt_u32 s29, 30
    s_cbranch_scc0 L_x56c
    s_sub_u32 s53, s29, 16
    s_branch L_s4j
L_x56c:
    s_lshl_b32 s52, s52, 1
    s_add_u32 s52, s52, s29
    s_add_u32 s52, s52, 2
    s_branch L_miscj
L_x7:
    s_cmp_lt_u32 s29, 16
    s_cbranch_scc0 L_x7b
    s_lshr_b32 s52, s29, 3
    s_bfe_u32 s53, s29, 0x10002
    s_and_b32 s54, s29, 3
    s_branch L_s5j
L_x7b:
    s_add_u32 s52, s29, 20
    s_branch L_miscj
L_chain:
    s_mov_b32 s32, s28
    s_cmp_eq_u32 s32, 0
    s_cbranch_scc1 go_1
    s_cmp_eq_u32 s30, 0
    s_cbranch_scc0 gwb_2
    v_mov_b32 v15, 192
    s_nop 1
wd_3:
    buffer_load_dword v14, v15, s[8:11], 0 offen sc1
    s_waitcnt vmcnt(0)
    v_cmp_le_u32 vcc, 24, v14
    s_nop 3
    s_cbranch_vccnz wdd_4
    s_add_u32 s31, s31, 1
    s_cmp_gt_u32 s31, 300000
    s_cbranch_scc1 wdd_4
    s_sleep 16
    s_branch wd_3
wdd_4:
gwb_2:
    s_barrier
go_1:
    s_mov_b32 s32, s28
    s_mov_b32 s33, s29
    s_load_dwordx2 s[12:13], s[0:1], 16
    s_load_dwordx2 s[16:17], s[0:1], 24
    s_load_dwordx2 s[20:21], s[0:1], 32
    s_load_dwordx2 s[24:25], s[0:1], 40
    s_load_dwordx2 s[68:69], s[0:1], 8
    v_mov_b32 v13, v0
    s_waitcnt lgkmcnt(0)
    s_mov_b32 s14, 0x400000
    s_mov_b32 s15, 0x20000
    s_mov_b32 s18, 0x400000
    s_mov_b32 s19, 0x20000
    s_mov_b32 s22, 0x400000
    s_mov_b32 s23, 0x20000
    s_mov_b32 s26, 0x400000
    s_mov_b32 s27, 0x20000
    s_mov_b32 s70, 8192
    s_mov_b32 s71, 0x20000
    v_bfe_u32 v14, v13, 2, 1
    v_lshlrev_b32 v14, 10, v14
    v_bfe_u32 v15, v13, 4, 1
    v_lshl_add_u32 v14, v15, 6, v14
    v_and_b32 v15, 3, v13
    v_lshl_add_u32 v14, v15, 1, v14
    s_and_b32 s46, s33, 3
    s_lshl_b32 s46, s46, 11
    s_lshr_b32 s47, s33, 2
    s_lshl_b32 s47, s47, 7
    s_add_u32 s46, s46, s47
    s_lshl_b32 s47, s30, 3
    s_add_u32 s46, s46, s47
    buffer_load_ushort v124, v14, s[68:71], s46 offen
    buffer_load_ushort v125, v14, s[68:71], s46 offen offset:32
    v_and_b32 v15, 3, v13
    v_bfe_u32 v20, v13, 5, 1
    v_lshlrev_b32 v20, 1, v20
    v_xor_b32 v15, v15, v20
    v_lshlrev_b32 v15, 4, v15
    v_bfe_u32 v20, v13, 3, 1
    v_lshlrev_b32 v20, 5, v20
    v_bfe_u32 v21, v13, 2, 1
    v_lshl_add_u32 v20, v21, 4, v20
    v_bfe_u32 v21, v13, 4, 2
    v_add_u32 v20, v20, v21
    v_lshl_add_u32 v16, v20, 13, v15
    v_bfe_u32 v20, v13, 3, 1
    v_lshlrev_b32 v20, 5, v20
    v_bfe_u32 v21, v13, 5, 1
    v_lshl_add_u32 v20, v21, 4, v20
    v_bfe_u32 v21, v13, 4, 1
    v_lshl_add_u32 v20, v21, 1, v20
    v_bfe_u32 v21, v13, 2, 1
    v_add_u32 v20, v20, v21
    v_lshl_add_u32 v17, v20, 10, v15
    v_lshrrev_b32 v20, 4, v13
    v_lshlrev_b32 v21, 3, v20
    v_bfe_u32 v22, v13, 2, 2
    v_add_u32 v21, v21, v22
    v_lshlrev_b32 v21, 6, v21
    v_and_b32 v22, 3, v13
    v_lshl_add_u32 v21, v22, 3, v21
    s_lshl_b32 s46, s30, 15
    v_add_u32 v21, s46, v21
    v_and_b32 v20, 1, v20
    v_lshl_add_u32 v18, v20, 5, v21
    v_xor_b32 v19, 32, v18
    s_lshl_b32 s72, s33, 8
    s_lshl_b32 s46, s30, 6
    s_add_u32 s72, s72, s46
    s_lshl_b32 s73, s33, 17
    s_lshl_b32 s46, s30, 8
    s_add_u32 s73, s73, s46
    s_lshl_b32 s74, s30, 15
    v_lshlrev_b32 v23, 6, v13
    s_lshl_b32 s75, s33, 2
    s_add_u32 s75, s75, s30
    s_lshl_b32 s75, s75, 15
    s_add_u32 s58, s30, 0
    s_and_b32 s58, s58, 3
    s_lshl_b32 s58, s58, 1
    s_lshl_b32 s58, s58, 19
    s_add_u32 s58, s58, s72
    s_add_u32 m0, s74, 0
    s_nop 0
    buffer_load_dwordx4 v16, s[12:15], s58 offen lds
    s_add_u32 s58, s58, 32768
    s_add_u32 m0, s74, 1024
    s_nop 0
    buffer_load_dwordx4 v16, s[12:15], s58 offen lds
    s_add_u32 s58, s58, 32768
    s_add_u32 m0, s74, 2048
    s_nop 0
    buffer_load_dwordx4 v16, s[12:15], s58 offen lds
    s_add_u32 s58, s58, 32768
    s_add_u32 m0, s74, 3072
    s_nop 0
    buffer_load_dwordx4 v16, s[12:15], s58 offen lds
    s_add_u32 s58, s30, 0
    s_and_b32 s58, s58, 3
    s_lshl_b32 s58, s58, 1
    s_add_u32 s58, s58, 1
    s_lshl_b32 s58, s58, 19
    s_add_u32 s58, s58, s72
    s_add_u32 m0, s74, 4096
    s_nop 0
    buffer_load_dwordx4 v16, s[12:15], s58 offen lds
    s_add_u32 s58, s58, 32768
    s_add_u32 m0, s74, 5120
    s_nop 0
    buffer_load_dwordx4 v16, s[12:15], s58 offen lds
    s_add_u32 s58, s58, 32768
    s_add_u32 m0, s74, 6144
    s_nop 0
    buffer_load_dwordx4 v16, s[12:15], s58 offen lds
    s_add_u32 s58, s58, 32768
    s_add_u32 m0, s74, 7168
    s_nop 0
    buffer_load_dwordx4 v16, s[12:15], s58 offen lds
    s_add_u32 s58, s30, 1
    s_and_b32 s58, s58, 3
    s_lshl_b32 s58, s58, 1
    s_lshl_b32 s58, s58, 19
    s_add_u32 s58, s58, s72
    s_add_u32 m0, s74, 8192
    s_nop 0
    buffer_load_dwordx4 v16, s[12:15], s58 offen lds
    s_add_u32 s58, s58, 32768
    s_add_u32 m0, s74, 9216
    s_nop 0
    buffer_load_dwordx4 v16, s[12:15], s58 offen lds
    s_add_u32 s58, s58, 32768
    s_add_u32 m0, s74, 10240
    s_nop 0
    buffer_load_dwordx4 v16, s[12:15], s58 offen lds
    s_add_u32 s58, s58, 32768
    s_add_u32 m0, s74, 11264
    s_nop 0
    buffer_load_dwordx4 v16, s[12:15], s58 offen lds
    s_add_u32 s58, s30, 1
    s_and_b32 s58, s58, 3
    s_lshl_b32 s58, s58, 1
    s_add_u32 s58, s58, 1
    s_lshl_b32 s58, s58, 19
    s_add_u32 s58, s58, s72
    s_add_u32 m0, s74, 12288
    s_nop 0
    buffer_load_dwordx4 v16, s[12:15], s58 offen lds
    s_add_u32 s58, s58, 32768
    s_add_u32 m0, s74, 13312
    s_nop 0
    buffer_load_dwordx4 v16, s[12:15], s58 offen lds
    s_add_u32 s58, s58, 32768
    s_add_u32 m0, s74, 14336
    s_nop 0
    buffer_load_dwordx4 v16, s[12:15], s58 offen lds
    s_add_u32 s58, s58, 32768
    s_add_u32 m0, s74, 15360
    s_nop 0
    buffer_load_dwordx4 v16, s[12:15], s58 offen lds
    s_add_u32 s58, s30, 2
    s_and_b32 s58, s58, 3
    s_lshl_b32 s58, s58, 1
    s_lshl_b32 s58, s58, 19
    s_add_u32 s58, s58, s72
    s_add_u32 m0, s74, 16384
    s_nop 0
    buffer_load_dwordx4 v16, s[12:15], s58 offen lds
    s_add_u32 s58, s58, 32768
    s_add_u32 m0, s74, 17408
    s_nop 0
    buffer_load_dwordx4 v16, s[12:15], s58 offen lds
    s_add_u32 s58, s58, 32768
    s_add_u32 m0, s74, 18432
    s_nop 0
    buffer_load_dwordx4 v16, s[12:15], s58 offen lds
    s_add_u32 s58, s58, 32768
    s_add_u32 m0, s74, 19456
    s_nop 0
    buffer_load_dwordx4 v16, s[12:15], s58 offen lds
    s_add_u32 s58, s30, 2
    s_and_b32 s58, s58, 3
    s_lshl_b32 s58, s58, 1
    s_add_u32 s58, s58, 1
    s_lshl_b32 s58, s58, 19
    s_add_u32 s58, s58, s72
    s_add_u32 m0, s74, 20480
    s_nop 0
    buffer_load_dwordx4 v16, s[12:15], s58 offen lds
    s_add_u32 s58, s58, 32768
    s_add_u32 m0, s74, 21504
    s_nop 0
    buffer_load_dwordx4 v16, s[12:15], s58 offen lds
    s_add_u32 s58, s58, 32768
    s_add_u32 m0, s74, 22528
    s_nop 0
    buffer_load_dwordx4 v16, s[12:15], s58 offen lds
    s_add_u32 s58, s58, 32768
    s_add_u32 m0, s74, 23552
    s_nop 0
    buffer_load_dwordx4 v16, s[12:15], s58 offen lds
    s_add_u32 s58, s30, 3
    s_and_b32 s58, s58, 3
    s_lshl_b32 s58, s58, 1
    s_lshl_b32 s58, s58, 19
    s_add_u32 s58, s58, s72
    s_add_u32 m0, s74, 24576
    s_nop 0
    buffer_load_dwordx4 v16, s[12:15], s58 offen lds
    s_add_u32 s58, s58, 32768
    s_add_u32 m0, s74, 25600
    s_nop 0
    buffer_load_dwordx4 v16, s[12:15], s58 offen lds
    s_add_u32 s58, s58, 32768
    s_add_u32 m0, s74, 26624
    s_nop 0
    buffer_load_dwordx4 v16, s[12:15], s58 offen lds
    s_add_u32 s58, s58, 32768
    s_add_u32 m0, s74, 27648
    s_nop 0
    buffer_load_dwordx4 v16, s[12:15], s58 offen lds
    s_add_u32 s58, s30, 3
    s_and_b32 s58, s58, 3
    s_lshl_b32 s58, s58, 1
    s_add_u32 s58, s58, 1
    s_lshl_b32 s58, s58, 19
    s_add_u32 s58, s58, s72
    s_add_u32 m0, s74, 28672
    s_nop 0
    buffer_load_dwordx4 v16, s[12:15], s58 offen lds
    s_add_u32 s58, s58, 32768
    s_add_u32 m0, s74, 29696
    s_nop 0
    buffer_load_dwordx4 v16, s[12:15], s58 offen lds
    s_add_u32 s58, s58, 32768
    s_add_u32 m0, s74, 30720
    s_nop 0
    buffer_load_dwordx4 v16, s[12:15], s58 offen lds
    s_add_u32 s58, s58, 32768
    s_add_u32 m0, s74, 31744
    s_nop 0
    buffer_load_dwordx4 v16, s[12:15], s58 offen lds
    v_lshlrev_b32 v5, 4, v13
    v_add_u32 v5, 0x20000, v5
    v_and_b32 v14, 2, v13
    v_cmp_eq_u32 vcc, 0, v14
    v_mov_b32 v15, 0xeeee
    v_mov_b32 v0, 0x4444
    v_cndmask_b32 v0, v15, v0, vcc
    s_add_u32 s46, s30, 0
    s_and_b32 s46, s46, 3
    s_lshl_b32 s46, s46, 11
    v_add_u32 v1, s46, v5
    s_add_u32 s46, s30, 1
    s_and_b32 s46, s46, 3
    s_lshl_b32 s46, s46, 11
    v_add_u32 v2, s46, v5
    s_add_u32 s46, s30, 2
    s_and_b32 s46, s46, 3
    s_lshl_b32 s46, s46, 11
    v_add_u32 v3, s46, v5
    s_add_u32 s46, s30, 3
    s_and_b32 s46, s46, 3
    s_lshl_b32 s46, s46, 11
    v_add_u32 v4, s46, v5
    v_and_b32 v14, 15, v13
    s_lshl_b32 s46, s30, 5
    v_add_u32 v14, s46, v14
    v_mul_u32_u24 v14, 40, v14
    v_lshrrev_b32 v15, 4, v13
    v_lshl_add_u32 v6, v15, 2, v14
    v_add_u32 v6, 0x26000, v6
    v_lshl_add_u32 v7, v15, 3, v14
    v_add_u32 v7, 0x24000, v7
    v_lshrrev_b32 v14, 5, v13
    v_lshlrev_b32 v14, 4, v14
    v_bfe_u32 v15, v13, 4, 1
    v_lshl_add_u32 v14, v15, 2, v14
    v_bfe_u32 v15, v13, 2, 2
    v_add_u32 v14, v14, v15
    v_mul_u32_u24 v8, 40, v14
    v_and_b32 v15, 3, v13
    v_lshl_add_u32 v8, v15, 3, v8
    v_add_u32 v8, 0x20000, v8
    v_and_b32 v14, 15, v13
    v_lshrrev_b32 v15, 4, v13
    s_lshl_b32 s46, s30, 2
    v_add_u32 v15, s46, v15
    v_and_b32 v9, 7, v13
    v_xor_b32 v15, v15, v9
    v_lshlrev_b32 v15, 4, v15
    v_and_b32 v14, 7, v14
    v_lshl_add_u32 v9, v14, 8, v15
    v_add_u32 v9, 0x20000, v9
    v_bfe_u32 v14, v13, 2, 2
    v_lshlrev_b32 v14, 1, v14
    v_and_b32 v15, 1, v13
    v_add_u32 v14, v14, v15
    v_bfe_u32 v15, v13, 1, 1
    v_lshlrev_b32 v15, 2, v15
    v_lshrrev_b32 v10, 4, v13
    v_add_u32 v15, v15, v10
    v_xor_b32 v15, v15, v14
    v_lshlrev_b32 v15, 4, v15
    v_lshl_add_u32 v10, v14, 8, v15
    v_add_u32 v10, 0x20000, v10
    v_lshlrev_b32 v11, 4, v13
    s_lshl_b32 s46, s30, 15
    v_add_u32 v11, s46, v11
    v_mov_b32 v104, 0
    v_lshrrev_b32 v14, 2, v13
    v_lshlrev_b32 v105, 13, v14
    v_and_b32 v15, 3, v13
    v_lshl_add_u32 v105, v15, 4, v105
    v_lshlrev_b32 v106, 2, v15
    v_bfe_u32 v14, v13, 2, 1
    v_lshl_add_u32 v106, v14, 4, v106
    v_bfe_u32 v14, v13, 4, 1
    v_lshl_add_u32 v106, v14, 5, v106
    v_mov_b32 v107, 0
    ds_write_b128 v5, v[104:107] offset:29696
    v_and_b32 v14, 15, v13
    v_cmp_eq_u32 vcc, 0, v14
    v_mov_b32 v15, 0x3f80
    s_nop 0
    v_cndmask_b32 v108, 0, v15, vcc
    v_cmp_eq_u32 vcc, 1, v14
    v_mov_b32 v15, 0x3f800000
    s_nop 0
    v_cndmask_b32 v108, v108, v15, vcc
    v_cmp_eq_u32 vcc, 2, v14
    v_mov_b32 v15, 0x3f80
    s_nop 0
    v_cndmask_b32 v109, 0, v15, vcc
    v_cmp_eq_u32 vcc, 3, v14
    v_mov_b32 v15, 0x3f800000
    s_nop 0
    v_cndmask_b32 v109, v109, v15, vcc
    v_cmp_eq_u32 vcc, 4, v14
    v_mov_b32 v15, 0x3f80
    s_nop 0
    v_cndmask_b32 v110, 0, v15, vcc
    v_cmp_eq_u32 vcc, 5, v14
    v_mov_b32 v15, 0x3f800000
    s_nop 0
    v_cndmask_b32 v110, v110, v15, vcc
    v_cmp_eq_u32 vcc, 6, v14
    v_mov_b32 v15, 0x3f80
    s_nop 0
    v_cndmask_b32 v111, 0, v15, vcc
    v_cmp_eq_u32 vcc, 7, v14
    v_mov_b32 v15, 0x3f800000
    s_nop 0
    v_cndmask_b32 v111, v111, v15, vcc
    ds_write_b128 v5, v[108:111] offset:30720
    s_waitcnt lgkmcnt(0)
    s_mul_i32 s35, s32, 2097152
    s_add_u32 s35, s35, 2097152
    s_mov_b32 s50, 0x3e0293ee
    s_mov_b32 s52, 0xf0f0f0f0
    s_mov_b32 s53, 0xf0f0f0f0
    s_mov_b32 s56, 0x00ff00ff
    s_mov_b32 s57, 0
    s_add_u32 s46, s35, 1048576
    s_lshl_b32 s47, s30, 11
    s_add_u32 s60, s46, s47
    s_sub_u32 s60, s60, 131072
    s_lshr_b32 s47, s33, 2
    s_lshl_b32 s47, s47, 10
    s_add_u32 s61, s46, s47
    s_lshl_b32 s47, s30, 8
    s_add_u32 s61, s61, s47
    s_and_b32 s47, s33, 3
    s_lshl_b32 s47, s47, 6
    s_add_u32 s61, s61, s47
    s_lshl_b32 s47, s33, 13
    s_add_u32 s62, s35, s47
    s_lshl_b32 s47, s30, 11
    s_add_u32 s62, s62, s47
    s_sub_u32 s62, s62, 131072
    s_lshl_b32 s47, s33, 8
    s_add_u32 s63, s35, s47
    s_lshl_b32 s47, s30, 6
    s_add_u32 s63, s63, s47
    s_mul_i32 s40, s32, 0
    s_mul_i32 s47, s33, 24576
    s_add_u32 s40, s40, s47
    s_lshl_b32 s47, s30, 11
    s_add_u32 s40, s40, s47
    s_add_u32 s40, s40, 6168576
    s_add_u32 s51, s47, 131072
    s_mul_i32 s41, s32, 0
    s_lshl_b32 s47, s33, 13
    s_add_u32 s41, s41, s47
    s_lshl_b32 s47, s30, 10
    s_add_u32 s41, s41, s47
    s_add_u32 s41, s41, 56492032
    s_mul_i32 s46, s32, 393216
    s_lshl_b32 s47, s33, 7
    s_add_u32 s46, s46, s47
    s_add_u32 s42, s46, 128
    s_add_u32 s59, s46, 132
    s_add_u32 s43, s35, 1081344
    s_sub_u32 s66, s35, 131072
    s_cmp_eq_u32 s30, 0
    s_cselect_b32 s64, 1, 0
    s_mov_b32 s65, 0
    v_mov_b32 v72, -1
    v_mov_b32 v73, -1
    v_mov_b32 v74, -1
    v_mov_b32 v75, -1
    s_add_u32 s46, s62, 0
    buffer_store_dwordx4 v[72:75], v5, s[4:7], s46 offen offset:0
    buffer_store_dwordx4 v[72:75], v5, s[4:7], s46 offen offset:1024
    s_add_u32 s46, s62, 262144
    buffer_store_dwordx4 v[72:75], v5, s[4:7], s46 offen offset:0
    buffer_store_dwordx4 v[72:75], v5, s[4:7], s46 offen offset:1024
    s_waitcnt vmcnt(36)
    v_lshl_or_b32 v15, v125, 16, v124
    s_add_u32 s46, s61, 8192
    s_mov_b64 exec, s[56:57]
    buffer_store_dword v15, v106, s[4:7], s61 offen
    buffer_store_dword v72, v106, s[4:7], s46 offen
    s_mov_b64 exec, -1
    s_waitcnt vmcnt(28)
    ds_read_b64_tr_b16 a[0:1], v18 offset:0
    ds_read_b64_tr_b16 a[2:3], v18 offset:256
    ds_read_b64_tr_b16 a[4:5], v18 offset:2048
    ds_read_b64_tr_b16 a[6:7], v18 offset:2304
    ds_read_b64_tr_b16 a[8:9], v19 offset:0
    ds_read_b64_tr_b16 a[10:11], v19 offset:256
    ds_read_b64_tr_b16 a[12:13], v19 offset:2048
    ds_read_b64_tr_b16 a[14:15], v19 offset:2304
    s_waitcnt lgkmcnt(0)
    s_add_u32 s58, s30, 0
    s_and_b32 s58, s58, 3
    s_lshl_b32 s58, s58, 1
    s_lshl_b32 s58, s58, 19
    s_add_u32 s58, s58, s72
    s_add_u32 m0, s74, 0
    s_nop 0
    buffer_load_dwordx4 v16, s[16:19], s58 offen lds
    s_add_u32 s58, s58, 32768
    s_add_u32 m0, s74, 1024
    s_nop 0
    buffer_load_dwordx4 v16, s[16:19], s58 offen lds
    s_add_u32 s58, s58, 32768
    s_add_u32 m0, s74, 2048
    s_nop 0
    buffer_load_dwordx4 v16, s[16:19], s58 offen lds
    s_add_u32 s58, s58, 32768
    s_add_u32 m0, s74, 3072
    s_nop 0
    buffer_load_dwordx4 v16, s[16:19], s58 offen lds
    s_waitcnt vmcnt(28)
    ds_read_b64_tr_b16 a[16:17], v18 offset:4096
    ds_read_b64_tr_b16 a[18:19], v18 offset:4352
    ds_read_b64_tr_b16 a[20:21], v18 offset:6144
    ds_read_b64_tr_b16 a[22:23], v18 offset:6400
    ds_read_b64_tr_b16 a[24:25], v19 offset:4096
    ds_read_b64_tr_b16 a[26:27], v19 offset:4352
    ds_read_b64_tr_b16 a[28:29], v19 offset:6144
    ds_read_b64_tr_b16 a[30:31], v19 offset:6400
    s_waitcnt lgkmcnt(0)
    s_add_u32 s58, s30, 0
    s_and_b32 s58, s58, 3
    s_lshl_b32 s58, s58, 1
    s_add_u32 s58, s58, 1
    s_lshl_b32 s58, s58, 19
    s_add_u32 s58, s58, s72
    s_add_u32 m0, s74, 4096
    s_nop 0
    buffer_load_dwordx4 v16, s[16:19], s58 offen lds
    s_add_u32 s58, s58, 32768
    s_add_u32 m0, s74, 5120
    s_nop 0
    buffer_load_dwordx4 v16, s[16:19], s58 offen lds
    s_add_u32 s58, s58, 32768
    s_add_u32 m0, s74, 6144
    s_nop 0
    buffer_load_dwordx4 v16, s[16:19], s58 offen lds
    s_add_u32 s58, s58, 32768
    s_add_u32 m0, s74, 7168
    s_nop 0
    buffer_load_dwordx4 v16, s[16:19], s58 offen lds
    s_waitcnt vmcnt(28)
    ds_read_b64_tr_b16 a[32:33], v18 offset:8192
    ds_read_b64_tr_b16 a[34:35], v18 offset:8448
    ds_read_b64_tr_b16 a[36:37], v18 offset:10240
    ds_read_b64_tr_b16 a[38:39], v18 offset:10496
    ds_read_b64_tr_b16 a[40:41], v19 offset:8192
    ds_read_b64_tr_b16 a[42:43], v19 offset:8448
    ds_read_b64_tr_b16 a[44:45], v19 offset:10240
    ds_read_b64_tr_b16 a[46:47], v19 offset:10496
    s_waitcnt lgkmcnt(0)
    s_add_u32 s58, s30, 1
    s_and_b32 s58, s58, 3
    s_lshl_b32 s58, s58, 1
    s_lshl_b32 s58, s58, 19
    s_add_u32 s58, s58, s72
    s_add_u32 m0, s74, 8192
    s_nop 0
    buffer_load_dwordx4 v16, s[16:19], s58 offen lds
    s_add_u32 s58, s58, 32768
    s_add_u32 m0, s74, 9216
    s_nop 0
    buffer_load_dwordx4 v16, s[16:19], s58 offen lds
    s_add_u32 s58, s58, 32768
    s_add_u32 m0, s74, 10240
    s_nop 0
    buffer_load_dwordx4 v16, s[16:19], s58 offen lds
    s_add_u32 s58, s58, 32768
    s_add_u32 m0, s74, 11264
    s_nop 0
    buffer_load_dwordx4 v16, s[16:19], s58 offen lds
    s_waitcnt vmcnt(28)
    ds_read_b64_tr_b16 a[48:49], v18 offset:12288
    ds_read_b64_tr_b16 a[50:51], v18 offset:12544
    ds_read_b64_tr_b16 a[52:53], v18 offset:14336
    ds_read_b64_tr_b16 a[54:55], v18 offset:14592
    ds_read_b64_tr_b16 a[56:57], v19 offset:12288
    ds_read_b64_tr_b16 a[58:59], v19 offset:12544
    ds_read_b64_tr_b16 a[60:61], v19 offset:14336
    ds_read_b64_tr_b16 a[62:63], v19 offset:14592
    s_waitcnt lgkmcnt(0)
    s_add_u32 s58, s30, 1
    s_and_b32 s58, s58, 3
    s_lshl_b32 s58, s58, 1
    s_add_u32 s58, s58, 1
    s_lshl_b32 s58, s58, 19
    s_add_u32 s58, s58, s72
    s_add_u32 m0, s74, 12288
    s_nop 0
    buffer_load_dwordx4 v16, s[16:19], s58 offen lds
    s_add_u32 s58, s58, 32768
    s_add_u32 m0, s74, 13312
    s_nop 0
    buffer_load_dwordx4 v16, s[16:19], s58 offen lds
    s_add_u32 s58, s58, 32768
    s_add_u32 m0, s74, 14336
    s_nop 0
    buffer_load_dwordx4 v16, s[16:19], s58 offen lds
    s_add_u32 s58, s58, 32768
    s_add_u32 m0, s74, 15360
    s_nop 0
    buffer_load_dwordx4 v16, s[16:19], s58 offen lds
    s_waitcnt vmcnt(28)
    ds_read_b64_tr_b16 a[64:65], v18 offset:16384
    ds_read_b64_tr_b16 a[66:67], v18 offset:16640
    ds_read_b64_tr_b16 a[68:69], v18 offset:18432
    ds_read_b64_tr_b16 a[70:71], v18 offset:18688
    ds_read_b64_tr_b16 a[72:73], v19 offset:16384
    ds_read_b64_tr_b16 a[74:75], v19 offset:16640
    ds_read_b64_tr_b16 a[76:77], v19 offset:18432
    ds_read_b64_tr_b16 a[78:79], v19 offset:18688
    s_waitcnt lgkmcnt(0)
    s_add_u32 s58, s30, 2
    s_and_b32 s58, s58, 3
    s_lshl_b32 s58, s58, 1
    s_lshl_b32 s58, s58, 19
    s_add_u32 s58, s58, s72
    s_add_u32 m0, s74, 16384
    s_nop 0
    buffer_load_dwordx4 v16, s[16:19], s58 offen lds
    s_add_u32 s58, s58, 32768
    s_add_u32 m0, s74, 17408
    s_nop 0
    buffer_load_dwordx4 v16, s[16:19], s58 offen lds
    s_add_u32 s58, s58, 32768
    s_add_u32 m0, s74, 18432
    s_nop 0
    buffer_load_dwordx4 v16, s[16:19], s58 offen lds
    s_add_u32 s58, s58, 32768
    s_add_u32 m0, s74, 19456
    s_nop 0
    buffer_load_dwordx4 v16, s[16:19], s58 offen lds
    s_waitcnt vmcnt(28)
    ds_read_b64_tr_b16 a[80:81], v18 offset:20480
    ds_read_b64_tr_b16 a[82:83], v18 offset:20736
    ds_read_b64_tr_b16 a[84:85], v18 offset:22528
    ds_read_b64_tr_b16 a[86:87], v18 offset:22784
    ds_read_b64_tr_b16 a[88:89], v19 offset:20480
    ds_read_b64_tr_b16 a[90:91], v19 offset:20736
    ds_read_b64_tr_b16 a[92:93], v19 offset:22528
    ds_read_b64_tr_b16 a[94:95], v19 offset:22784
    s_waitcnt lgkmcnt(0)
    s_add_u32 s58, s30, 2
    s_and_b32 s58, s58, 3
    s_lshl_b32 s58, s58, 1
    s_add_u32 s58, s58, 1
    s_lshl_b32 s58, s58, 19
    s_add_u32 s58, s58, s72
    s_add_u32 m0, s74, 20480
    s_nop 0
    buffer_load_dwordx4 v16, s[16:19], s58 offen lds
    s_add_u32 s58, s58, 32768
    s_add_u32 m0, s74, 21504
    s_nop 0
    buffer_load_dwordx4 v16, s[16:19], s58 offen lds
    s_add_u32 s58, s58, 32768
    s_add_u32 m0, s74, 22528
    s_nop 0
    buffer_load_dwordx4 v16, s[16:19], s58 offen lds
    s_add_u32 s58, s58, 32768
    s_add_u32 m0, s74, 23552
    s_nop 0
    buffer_load_dwordx4 v16, s[16:19], s58 offen lds
    s_waitcnt vmcnt(28)
    ds_read_b64_tr_b16 a[96:97], v18 offset:24576
    ds_read_b64_tr_b16 a[98:99], v18 offset:24832
    ds_read_b64_tr_b16 a[100:101], v18 offset:26624
    ds_read_b64_tr_b16 a[102:103], v18 offset:26880
    ds_read_b64_tr_b16 a[104:105], v19 offset:24576
    ds_read_b64_tr_b16 a[106:107], v19 offset:24832
    ds_read_b64_tr_b16 a[108:109], v19 offset:26624
    ds_read_b64_tr_b16 a[110:111], v19 offset:26880
    s_waitcnt lgkmcnt(0)
    s_add_u32 s58, s30, 3
    s_and_b32 s58, s58, 3
    s_lshl_b32 s58, s58, 1
    s_lshl_b32 s58, s58, 19
    s_add_u32 s58, s58, s72
    s_add_u32 m0, s74, 24576
    s_nop 0
    buffer_load_dwordx4 v16, s[16:19], s58 offen lds
    s_add_u32 s58, s58, 32768
    s_add_u32 m0, s74, 25600
    s_nop 0
    buffer_load_dwordx4 v16, s[16:19], s58 offen lds
    s_add_u32 s58, s58, 32768
    s_add_u32 m0, s74, 26624
    s_nop 0
    buffer_load_dwordx4 v16, s[16:19], s58 offen lds
    s_add_u32 s58, s58, 32768
    s_add_u32 m0, s74, 27648
    s_nop 0
    buffer_load_dwordx4 v16, s[16:19], s58 offen lds
    s_waitcnt vmcnt(28)
    ds_read_b64_tr_b16 a[112:113], v18 offset:28672
    ds_read_b64_tr_b16 a[114:115], v18 offset:28928
    ds_read_b64_tr_b16 a[116:117], v18 offset:30720
    ds_read_b64_tr_b16 a[118:119], v18 offset:30976
    ds_read_b64_tr_b16 a[120:121], v19 offset:28672
    ds_read_b64_tr_b16 a[122:123], v19 offset:28928
    ds_read_b64_tr_b16 a[124:125], v19 offset:30720
    ds_read_b64_tr_b16 a[126:127], v19 offset:30976
    s_waitcnt lgkmcnt(0)
    s_add_u32 s58, s30, 3
    s_and_b32 s58, s58, 3
    s_lshl_b32 s58, s58, 1
    s_add_u32 s58, s58, 1
    s_lshl_b32 s58, s58, 19
    s_add_u32 s58, s58, s72
    s_add_u32 m0, s74, 28672
    s_nop 0
    buffer_load_dwordx4 v16, s[16:19], s58 offen lds
    s_add_u32 s58, s58, 32768
    s_add_u32 m0, s74, 29696
    s_nop 0
    buffer_load_dwordx4 v16, s[16:19], s58 offen lds
    s_add_u32 s58, s58, 32768
    s_add_u32 m0, s74, 30720
    s_nop 0
    buffer_load_dwordx4 v16, s[16:19], s58 offen lds
    s_add_u32 s58, s58, 32768
    s_add_u32 m0, s74, 31744
    s_nop 0
    buffer_load_dwordx4 v16, s[16:19], s58 offen lds
    s_waitcnt vmcnt(28)
    ds_read_b64_tr_b16 a[128:129], v18 offset:0
    ds_read_b64_tr_b16 a[130:131], v18 offset:256
    ds_read_b64_tr_b16 a[132:133], v18 offset:2048
    ds_read_b64_tr_b16 a[134:135], v18 offset:2304
    ds_read_b64_tr_b16 a[136:137], v19 offset:0
    ds_read_b64_tr_b16 a[138:139], v19 offset:256
    ds_read_b64_tr_b16 a[140:141], v19 offset:2048
    ds_read_b64_tr_b16 a[142:143], v19 offset:2304
    s_waitcnt lgkmcnt(0)
    s_add_u32 s58, s30, 0
    s_and_b32 s58, s58, 3
    s_lshl_b32 s58, s58, 1
    s_lshl_b32 s58, s58, 19
    s_add_u32 s58, s58, s72
    s_add_u32 m0, s74, 0
    s_nop 0
    buffer_load_dwordx4 v16, s[20:23], s58 offen lds
    s_add_u32 s58, s58, 32768
    s_add_u32 m0, s74, 1024
    s_nop 0
    buffer_load_dwordx4 v16, s[20:23], s58 offen lds
    s_add_u32 s58, s58, 32768
    s_add_u32 m0, s74, 2048
    s_nop 0
    buffer_load_dwordx4 v16, s[20:23], s58 offen lds
    s_add_u32 s58, s58, 32768
    s_add_u32 m0, s74, 3072
    s_nop 0
    buffer_load_dwordx4 v16, s[20:23], s58 offen lds
    s_waitcnt vmcnt(28)
    ds_read_b64_tr_b16 a[144:145], v18 offset:4096
    ds_read_b64_tr_b16 a[146:147], v18 offset:4352
    ds_read_b64_tr_b16 a[148:149], v18 offset:6144
    ds_read_b64_tr_b16 a[150:151], v18 offset:6400
    ds_read_b64_tr_b16 a[152:153], v19 offset:4096
    ds_read_b64_tr_b16 a[154:155], v19 offset:4352
    ds_read_b64_tr_b16 a[156:157], v19 offset:6144
    ds_read_b64_tr_b16 a[158:159], v19 offset:6400
    s_waitcnt lgkmcnt(0)
    s_add_u32 s58, s30, 0
    s_and_b32 s58, s58, 3
    s_lshl_b32 s58, s58, 1
    s_add_u32 s58, s58, 1
    s_lshl_b32 s58, s58, 19
    s_add_u32 s58, s58, s72
    s_add_u32 m0, s74, 4096
    s_nop 0
    buffer_load_dwordx4 v16, s[20:23], s58 offen lds
    s_add_u32 s58, s58, 32768
    s_add_u32 m0, s74, 5120
    s_nop 0
    buffer_load_dwordx4 v16, s[20:23], s58 offen lds
    s_add_u32 s58, s58, 32768
    s_add_u32 m0, s74, 6144
    s_nop 0
    buffer_load_dwordx4 v16, s[20:23], s58 offen lds
    s_add_u32 s58, s58, 32768
    s_add_u32 m0, s74, 7168
    s_nop 0
    buffer_load_dwordx4 v16, s[20:23], s58 offen lds
    s_waitcnt vmcnt(28)
    ds_read_b64_tr_b16 a[160:161], v18 offset:8192
    ds_read_b64_tr_b16 a[162:163], v18 offset:8448
    ds_read_b64_tr_b16 a[164:165], v18 offset:10240
    ds_read_b64_tr_b16 a[166:167], v18 offset:10496
    ds_read_b64_tr_b16 a[168:169], v19 offset:8192
    ds_read_b64_tr_b16 a[170:171], v19 offset:8448
    ds_read_b64_tr_b16 a[172:173], v19 offset:10240
    ds_read_b64_tr_b16 a[174:175], v19 offset:10496
    s_waitcnt lgkmcnt(0)
    s_add_u32 s58, s30, 1
    s_and_b32 s58, s58, 3
    s_lshl_b32 s58, s58, 1
    s_lshl_b32 s58, s58, 19
    s_add_u32 s58, s58, s72
    s_add_u32 m0, s74, 8192
    s_nop 0
    buffer_load_dwordx4 v16, s[20:23], s58 offen lds
    s_add_u32 s58, s58, 32768
    s_add_u32 m0, s74, 9216
    s_nop 0
    buffer_load_dwordx4 v16, s[20:23], s58 offen lds
    s_add_u32 s58, s58, 32768
    s_add_u32 m0, s74, 10240
    s_nop 0
    buffer_load_dwordx4 v16, s[20:23], s58 offen lds
    s_add_u32 s58, s58, 32768
    s_add_u32 m0, s74, 11264
    s_nop 0
    buffer_load_dwordx4 v16, s[20:23], s58 offen lds
    s_waitcnt vmcnt(28)
    ds_read_b64_tr_b16 a[176:177], v18 offset:12288
    ds_read_b64_tr_b16 a[178:179], v18 offset:12544
    ds_read_b64_tr_b16 a[180:181], v18 offset:14336
    ds_read_b64_tr_b16 a[182:183], v18 offset:14592
    ds_read_b64_tr_b16 a[184:185], v19 offset:12288
    ds_read_b64_tr_b16 a[186:187], v19 offset:12544
    ds_read_b64_tr_b16 a[188:189], v19 offset:14336
    ds_read_b64_tr_b16 a[190:191], v19 offset:14592
    s_waitcnt lgkmcnt(0)
    s_add_u32 s58, s30, 1
    s_and_b32 s58, s58, 3
    s_lshl_b32 s58, s58, 1
    s_add_u32 s58, s58, 1
    s_lshl_b32 s58, s58, 19
    s_add_u32 s58, s58, s72
    s_add_u32 m0, s74, 12288
    s_nop 0
    buffer_load_dwordx4 v16, s[20:23], s58 offen lds
    s_add_u32 s58, s58, 32768
    s_add_u32 m0, s74, 13312
    s_nop 0
    buffer_load_dwordx4 v16, s[20:23], s58 offen lds
    s_add_u32 s58, s58, 32768
    s_add_u32 m0, s74, 14336
    s_nop 0
    buffer_load_dwordx4 v16, s[20:23], s58 offen lds
    s_add_u32 s58, s58, 32768
    s_add_u32 m0, s74, 15360
    s_nop 0
    buffer_load_dwordx4 v16, s[20:23], s58 offen lds
    s_waitcnt vmcnt(28)
    ds_read_b64_tr_b16 a[192:193], v18 offset:16384
    ds_read_b64_tr_b16 a[194:195], v18 offset:16640
    ds_read_b64_tr_b16 a[196:197], v18 offset:18432
    ds_read_b64_tr_b16 a[198:199], v18 offset:18688
    ds_read_b64_tr_b16 a[200:201], v19 offset:16384
    ds_read_b64_tr_b16 a[202:203], v19 offset:16640
    ds_read_b64_tr_b16 a[204:205], v19 offset:18432
    ds_read_b64_tr_b16 a[206:207], v19 offset:18688
    s_waitcnt lgkmcnt(0)
    s_add_u32 s58, s73, 0
    s_add_u32 m0, s74, 16384
    s_nop 0
    buffer_load_dwordx4 v17, s[24:27], s58 offen lds
    s_add_u32 s58, s58, 4096
    s_add_u32 m0, s74, 17408
    s_nop 0
    buffer_load_dwordx4 v17, s[24:27], s58 offen lds
    s_add_u32 s58, s58, 4096
    s_add_u32 m0, s74, 18432
    s_nop 0
    buffer_load_dwordx4 v17, s[24:27], s58 offen lds
    s_add_u32 s58, s58, 4096
    s_add_u32 m0, s74, 19456
    s_nop 0
    buffer_load_dwordx4 v17, s[24:27], s58 offen lds
    s_waitcnt vmcnt(28)
    ds_read_b64_tr_b16 a[208:209], v18 offset:20480
    ds_read_b64_tr_b16 a[210:211], v18 offset:20736
    ds_read_b64_tr_b16 a[212:213], v18 offset:22528
    ds_read_b64_tr_b16 a[214:215], v18 offset:22784
    ds_read_b64_tr_b16 a[216:217], v19 offset:20480
    ds_read_b64_tr_b16 a[218:219], v19 offset:20736
    ds_read_b64_tr_b16 a[220:221], v19 offset:22528
    ds_read_b64_tr_b16 a[222:223], v19 offset:22784
    s_waitcnt lgkmcnt(0)
    s_add_u32 s58, s73, 65536
    s_add_u32 m0, s74, 20480
    s_nop 0
    buffer_load_dwordx4 v17, s[24:27], s58 offen lds
    s_add_u32 s58, s58, 4096
    s_add_u32 m0, s74, 21504
    s_nop 0
    buffer_load_dwordx4 v17, s[24:27], s58 offen lds
    s_add_u32 s58, s58, 4096
    s_add_u32 m0, s74, 22528
    s_nop 0
    buffer_load_dwordx4 v17, s[24:27], s58 offen lds
    s_add_u32 s58, s58, 4096
    s_add_u32 m0, s74, 23552
    s_nop 0
    buffer_load_dwordx4 v17, s[24:27], s58 offen lds
    s_waitcnt vmcnt(28)
    ds_read_b64_tr_b16 a[224:225], v18 offset:24576
    ds_read_b64_tr_b16 a[226:227], v18 offset:24832
    ds_read_b64_tr_b16 a[228:229], v18 offset:26624
    ds_read_b64_tr_b16 a[230:231], v18 offset:26880
    ds_read_b64_tr_b16 a[232:233], v19 offset:24576
    ds_read_b64_tr_b16 a[234:235], v19 offset:24832
    ds_read_b64_tr_b16 a[236:237], v19 offset:26624
    ds_read_b64_tr_b16 a[238:239], v19 offset:26880
    s_waitcnt lgkmcnt(0)
    s_add_u32 s58, s73, 64
    s_add_u32 m0, s74, 24576
    s_nop 0
    buffer_load_dwordx4 v17, s[24:27], s58 offen lds
    s_add_u32 s58, s58, 4096
    s_add_u32 m0, s74, 25600
    s_nop 0
    buffer_load_dwordx4 v17, s[24:27], s58 offen lds
    s_add_u32 s58, s58, 4096
    s_add_u32 m0, s74, 26624
    s_nop 0
    buffer_load_dwordx4 v17, s[24:27], s58 offen lds
    s_add_u32 s58, s58, 4096
    s_add_u32 m0, s74, 27648
    s_nop 0
    buffer_load_dwordx4 v17, s[24:27], s58 offen lds
    s_waitcnt vmcnt(28)
    ds_read_b64_tr_b16 a[240:241], v18 offset:28672
    ds_read_b64_tr_b16 a[242:243], v18 offset:28928
    ds_read_b64_tr_b16 a[244:245], v18 offset:30720
    ds_read_b64_tr_b16 a[246:247], v18 offset:30976
    ds_read_b64_tr_b16 a[248:249], v19 offset:28672
    ds_read_b64_tr_b16 a[250:251], v19 offset:28928
    ds_read_b64_tr_b16 a[252:253], v19 offset:30720
    ds_read_b64_tr_b16 a[254:255], v19 offset:30976
    s_waitcnt lgkmcnt(0)
    s_add_u32 s58, s73, 65600
    s_add_u32 m0, s74, 28672
    s_nop 0
    buffer_load_dwordx4 v17, s[24:27], s58 offen lds
    s_add_u32 s58, s58, 4096
    s_add_u32 m0, s74, 29696
    s_nop 0
    buffer_load_dwordx4 v17, s[24:27], s58 offen lds
    s_add_u32 s58, s58, 4096
    s_add_u32 m0, s74, 30720
    s_nop 0
    buffer_load_dwordx4 v17, s[24:27], s58 offen lds
    s_add_u32 s58, s58, 4096
    s_add_u32 m0, s74, 31744
    s_nop 0
    buffer_load_dwordx4 v17, s[24:27], s58 offen lds
    s_waitcnt vmcnt(28)
    ds_read_b64_tr_b16 v[128:129], v18 offset:0
    ds_read_b64_tr_b16 v[130:131], v18 offset:256
    ds_read_b64_tr_b16 v[132:133], v18 offset:2048
    ds_read_b64_tr_b16 v[134:135], v18 offset:2304
    ds_read_b64_tr_b16 v[136:137], v19 offset:0
    ds_read_b64_tr_b16 v[138:139], v19 offset:256
    ds_read_b64_tr_b16 v[140:141], v19 offset:2048
    ds_read_b64_tr_b16 v[142:143], v19 offset:2304
    s_waitcnt lgkmcnt(0)
    s_add_u32 s58, s30, 2
    s_and_b32 s58, s58, 3
    s_lshl_b32 s58, s58, 1
    s_lshl_b32 s58, s58, 19
    s_add_u32 s58, s58, s72
    s_add_u32 m0, s74, 0
    s_nop 0
    buffer_load_dwordx4 v16, s[20:23], s58 offen lds
    s_add_u32 s58, s58, 32768
    s_add_u32 m0, s74, 1024
    s_nop 0
    buffer_load_dwordx4 v16, s[20:23], s58 offen lds
    s_add_u32 s58, s58, 32768
    s_add_u32 m0, s74, 2048
    s_nop 0
    buffer_load_dwordx4 v16, s[20:23], s58 offen lds
    s_add_u32 s58, s58, 32768
    s_add_u32 m0, s74, 3072
    s_nop 0
    buffer_load_dwordx4 v16, s[20:23], s58 offen lds
    s_waitcnt vmcnt(28)
    ds_read_b64_tr_b16 v[144:145], v18 offset:4096
    ds_read_b64_tr_b16 v[146:147], v18 offset:4352
    ds_read_b64_tr_b16 v[148:149], v18 offset:6144
    ds_read_b64_tr_b16 v[150:151], v18 offset:6400
    ds_read_b64_tr_b16 v[152:153], v19 offset:4096
    ds_read_b64_tr_b16 v[154:155], v19 offset:4352
    ds_read_b64_tr_b16 v[156:157], v19 offset:6144
    ds_read_b64_tr_b16 v[158:159], v19 offset:6400
    s_waitcnt lgkmcnt(0)
    s_add_u32 s58, s30, 2
    s_and_b32 s58, s58, 3
    s_lshl_b32 s58, s58, 1
    s_add_u32 s58, s58, 1
    s_lshl_b32 s58, s58, 19
    s_add_u32 s58, s58, s72
    s_add_u32 m0, s74, 4096
    s_nop 0
    buffer_load_dwordx4 v16, s[20:23], s58 offen lds
    s_add_u32 s58, s58, 32768
    s_add_u32 m0, s74, 5120
    s_nop 0
    buffer_load_dwordx4 v16, s[20:23], s58 offen lds
    s_add_u32 s58, s58, 32768
    s_add_u32 m0, s74, 6144
    s_nop 0
    buffer_load_dwordx4 v16, s[20:23], s58 offen lds
    s_add_u32 s58, s58, 32768
    s_add_u32 m0, s74, 7168
    s_nop 0
    buffer_load_dwordx4 v16, s[20:23], s58 offen lds
    s_waitcnt vmcnt(28)
    ds_read_b64_tr_b16 v[160:161], v18 offset:8192
    ds_read_b64_tr_b16 v[162:163], v18 offset:8448
    ds_read_b64_tr_b16 v[164:165], v18 offset:10240
    ds_read_b64_tr_b16 v[166:167], v18 offset:10496
    ds_read_b64_tr_b16 v[168:169], v19 offset:8192
    ds_read_b64_tr_b16 v[170:171], v19 offset:8448
    ds_read_b64_tr_b16 v[172:173], v19 offset:10240
    ds_read_b64_tr_b16 v[174:175], v19 offset:10496
    s_waitcnt lgkmcnt(0)
    s_add_u32 s58, s30, 3
    s_and_b32 s58, s58, 3
    s_lshl_b32 s58, s58, 1
    s_lshl_b32 s58, s58, 19
    s_add_u32 s58, s58, s72
    s_add_u32 m0, s74, 8192
    s_nop 0
    buffer_load_dwordx4 v16, s[20:23], s58 offen lds
    s_add_u32 s58, s58, 32768
    s_add_u32 m0, s74, 9216
    s_nop 0
    buffer_load_dwordx4 v16, s[20:23], s58 offen lds
    s_add_u32 s58, s58, 32768
    s_add_u32 m0, s74, 10240
    s_nop 0
    buffer_load_dwordx4 v16, s[20:23], s58 offen lds
    s_add_u32 s58, s58, 32768
    s_add_u32 m0, s74, 11264
    s_nop 0
    buffer_load_dwordx4 v16, s[20:23], s58 offen lds
    s_waitcnt vmcnt(28)
    ds_read_b64_tr_b16 v[176:177], v18 offset:12288
    ds_read_b64_tr_b16 v[178:179], v18 offset:12544
    ds_read_b64_tr_b16 v[180:181], v18 offset:14336
    ds_read_b64_tr_b16 v[182:183], v18 offset:14592
    ds_read_b64_tr_b16 v[184:185], v19 offset:12288
    ds_read_b64_tr_b16 v[186:187], v19 offset:12544
    ds_read_b64_tr_b16 v[188:189], v19 offset:14336
    ds_read_b64_tr_b16 v[190:191], v19 offset:14592
    s_waitcnt lgkmcnt(0)
    s_add_u32 s58, s30, 3
    s_and_b32 s58, s58, 3
    s_lshl_b32 s58, s58, 1
    s_add_u32 s58, s58, 1
    s_lshl_b32 s58, s58, 19
    s_add_u32 s58, s58, s72
    s_add_u32 m0, s74, 12288
    s_nop 0
    buffer_load_dwordx4 v16, s[20:23], s58 offen lds
    s_add_u32 s58, s58, 32768
    s_add_u32 m0, s74, 13312
    s_nop 0
    buffer_load_dwordx4 v16, s[20:23], s58 offen lds
    s_add_u32 s58, s58, 32768
    s_add_u32 m0, s74, 14336
    s_nop 0
    buffer_load_dwordx4 v16, s[20:23], s58 offen lds
    s_add_u32 s58, s58, 32768
    s_add_u32 m0, s74, 15360
    s_nop 0
    buffer_load_dwordx4 v16, s[20:23], s58 offen lds
    s_waitcnt vmcnt(28)
    ds_read_b64_tr_b16 v[192:193], v18 offset:16384
    ds_read_b64_tr_b16 v[194:195], v18 offset:16640
    ds_read_b64_tr_b16 v[196:197], v18 offset:18432
    ds_read_b64_tr_b16 v[198:199], v18 offset:18688
    ds_read_b64_tr_b16 v[208:209], v19 offset:16384
    ds_read_b64_tr_b16 v[210:211], v19 offset:16640
    ds_read_b64_tr_b16 v[212:213], v19 offset:18432
    ds_read_b64_tr_b16 v[214:215], v19 offset:18688
    s_waitcnt lgkmcnt(0)
    s_add_u32 s58, s73, 128
    s_add_u32 m0, s74, 16384
    s_nop 0
    buffer_load_dwordx4 v17, s[24:27], s58 offen lds
    s_add_u32 s58, s58, 4096
    s_add_u32 m0, s74, 17408
    s_nop 0
    buffer_load_dwordx4 v17, s[24:27], s58 offen lds
    s_add_u32 s58, s58, 4096
    s_add_u32 m0, s74, 18432
    s_nop 0
    buffer_load_dwordx4 v17, s[24:27], s58 offen lds
    s_add_u32 s58, s58, 4096
    s_add_u32 m0, s74, 19456
    s_nop 0
    buffer_load_dwordx4 v17, s[24:27], s58 offen lds
    s_waitcnt vmcnt(28)
    ds_read_b64_tr_b16 v[200:201], v18 offset:20480
    ds_read_b64_tr_b16 v[202:203], v18 offset:20736
    ds_read_b64_tr_b16 v[204:205], v18 offset:22528
    ds_read_b64_tr_b16 v[206:207], v18 offset:22784
    ds_read_b64_tr_b16 v[216:217], v19 offset:20480
    ds_read_b64_tr_b16 v[218:219], v19 offset:20736
    ds_read_b64_tr_b16 v[220:221], v19 offset:22528
    ds_read_b64_tr_b16 v[222:223], v19 offset:22784
    s_waitcnt lgkmcnt(0)
    s_add_u32 s58, s73, 65664
    s_add_u32 m0, s74, 20480
    s_nop 0
    buffer_load_dwordx4 v17, s[24:27], s58 offen lds
    s_add_u32 s58, s58, 4096
    s_add_u32 m0, s74, 21504
    s_nop 0
    buffer_load_dwordx4 v17, s[24:27], s58 offen lds
    s_add_u32 s58, s58, 4096
    s_add_u32 m0, s74, 22528
    s_nop 0
    buffer_load_dwordx4 v17, s[24:27], s58 offen lds
    s_add_u32 s58, s58, 4096
    s_add_u32 m0, s74, 23552
    s_nop 0
    buffer_load_dwordx4 v17, s[24:27], s58 offen lds
    s_waitcnt vmcnt(28)
    ds_read_b64_tr_b16 v[224:225], v18 offset:24576
    ds_read_b64_tr_b16 v[226:227], v18 offset:24832
    ds_read_b64_tr_b16 v[228:229], v18 offset:26624
    ds_read_b64_tr_b16 v[230:231], v18 offset:26880
    ds_read_b64_tr_b16 v[240:241], v19 offset:24576
    ds_read_b64_tr_b16 v[242:243], v19 offset:24832
    ds_read_b64_tr_b16 v[244:245], v19 offset:26624
    ds_read_b64_tr_b16 v[246:247], v19 offset:26880
    s_waitcnt lgkmcnt(0)
    s_add_u32 s58, s73, 192
    s_add_u32 m0, s74, 24576
    s_nop 0
    buffer_load_dwordx4 v17, s[24:27], s58 offen lds
    s_add_u32 s58, s58, 4096
    s_add_u32 m0, s74, 25600
    s_nop 0
    buffer_load_dwordx4 v17, s[24:27], s58 offen lds
    s_add_u32 s58, s58, 4096
    s_add_u32 m0, s74, 26624
    s_nop 0
    buffer_load_dwordx4 v17, s[24:27], s58 offen lds
    s_add_u32 s58, s58, 4096
    s_add_u32 m0, s74, 27648
    s_nop 0
    buffer_load_dwordx4 v17, s[24:27], s58 offen lds
    s_waitcnt vmcnt(28)
    ds_read_b64_tr_b16 v[232:233], v18 offset:28672
    ds_read_b64_tr_b16 v[234:235], v18 offset:28928
    ds_read_b64_tr_b16 v[236:237], v18 offset:30720
    ds_read_b64_tr_b16 v[238:239], v18 offset:30976
    ds_read_b64_tr_b16 v[248:249], v19 offset:28672
    ds_read_b64_tr_b16 v[250:251], v19 offset:28928
    ds_read_b64_tr_b16 v[252:253], v19 offset:30720
    ds_read_b64_tr_b16 v[254:255], v19 offset:30976
    s_waitcnt lgkmcnt(0)
    s_add_u32 s58, s73, 65728
    s_add_u32 m0, s74, 28672
    s_nop 0
    buffer_load_dwordx4 v17, s[24:27], s58 offen lds
    s_add_u32 s58, s58, 4096
    s_add_u32 m0, s74, 29696
    s_nop 0
    buffer_load_dwordx4 v17, s[24:27], s58 offen lds
    s_add_u32 s58, s58, 4096
    s_add_u32 m0, s74, 30720
    s_nop 0
    buffer_load_dwordx4 v17, s[24:27], s58 offen lds
    s_add_u32 s58, s58, 4096
    s_add_u32 m0, s74, 31744
    s_nop 0
    buffer_load_dwordx4 v17, s[24:27], s58 offen lds
    s_waitcnt vmcnt(28)
    ds_read_b64_tr_b16 v[32:33], v18 offset:0
    ds_read_b64_tr_b16 v[34:35], v18 offset:256
    ds_read_b64_tr_b16 v[36:37], v18 offset:2048
    ds_read_b64_tr_b16 v[38:39], v18 offset:2304
    ds_read_b64_tr_b16 v[40:41], v19 offset:0
    ds_read_b64_tr_b16 v[42:43], v19 offset:256
    ds_read_b64_tr_b16 v[44:45], v19 offset:2048
    ds_read_b64_tr_b16 v[46:47], v19 offset:2304
    s_waitcnt lgkmcnt(0)
    ds_write_b128 v11, v[32:35] offset:0
    ds_write_b128 v11, v[36:39] offset:1024
    ds_write_b128 v11, v[40:43] offset:2048
    ds_write_b128 v11, v[44:47] offset:3072
    s_waitcnt lgkmcnt(0)
    s_waitcnt vmcnt(24)
    ds_read_b64_tr_b16 v[32:33], v18 offset:4096
    ds_read_b64_tr_b16 v[34:35], v18 offset:4352
    ds_read_b64_tr_b16 v[36:37], v18 offset:6144
    ds_read_b64_tr_b16 v[38:39], v18 offset:6400
    ds_read_b64_tr_b16 v[40:41], v19 offset:4096
    ds_read_b64_tr_b16 v[42:43], v19 offset:4352
    ds_read_b64_tr_b16 v[44:45], v19 offset:6144
    ds_read_b64_tr_b16 v[46:47], v19 offset:6400
    s_waitcnt lgkmcnt(0)
    ds_write_b128 v11, v[32:35] offset:4096
    ds_write_b128 v11, v[36:39] offset:5120
    ds_write_b128 v11, v[40:43] offset:6144
    ds_write_b128 v11, v[44:47] offset:7168
    s_waitcnt lgkmcnt(0)
    s_waitcnt vmcnt(20)
    ds_read_b64_tr_b16 v[32:33], v18 offset:8192
    ds_read_b64_tr_b16 v[34:35], v18 offset:8448
    ds_read_b64_tr_b16 v[36:37], v18 offset:10240
    ds_read_b64_tr_b16 v[38:39], v18 offset:10496
    ds_read_b64_tr_b16 v[40:41], v19 offset:8192
    ds_read_b64_tr_b16 v[42:43], v19 offset:8448
    ds_read_b64_tr_b16 v[44:45], v19 offset:10240
    ds_read_b64_tr_b16 v[46:47], v19 offset:10496
    s_waitcnt lgkmcnt(0)
    ds_write_b128 v11, v[32:35] offset:8192
    ds_write_b128 v11, v[36:39] offset:9216
    ds_write_b128 v11, v[40:43] offset:10240
    ds_write_b128 v11, v[44:47] offset:11264
    s_waitcnt lgkmcnt(0)
    s_waitcnt vmcnt(16)
    ds_read_b64_tr_b16 v[32:33], v18 offset:12288
    ds_read_b64_tr_b16 v[34:35], v18 offset:12544
    ds_read_b64_tr_b16 v[36:37], v18 offset:14336
    ds_read_b64_tr_b16 v[38:39], v18 offset:14592
    ds_read_b64_tr_b16 v[40:41], v19 offset:12288
    ds_read_b64_tr_b16 v[42:43], v19 offset:12544
    ds_read_b64_tr_b16 v[44:45], v19 offset:14336
    ds_read_b64_tr_b16 v[46:47], v19 offset:14592
    s_waitcnt lgkmcnt(0)
    ds_write_b128 v11, v[32:35] offset:12288
    ds_write_b128 v11, v[36:39] offset:13312
    ds_write_b128 v11, v[40:43] offset:14336
    ds_write_b128 v11, v[44:47] offset:15360
    s_waitcnt lgkmcnt(0)
    s_waitcnt vmcnt(12)
    ds_read_b64_tr_b16 v[32:33], v18 offset:16384
    ds_read_b64_tr_b16 v[34:35], v18 offset:16640
    ds_read_b64_tr_b16 v[36:37], v18 offset:18432
    ds_read_b64_tr_b16 v[38:39], v18 offset:18688
    ds_read_b64_tr_b16 v[40:41], v19 offset:16384
    ds_read_b64_tr_b16 v[42:43], v19 offset:16640
    ds_read_b64_tr_b16 v[44:45], v19 offset:18432
    ds_read_b64_tr_b16 v[46:47], v19 offset:18688
    s_waitcnt lgkmcnt(0)
    ds_write_b128 v11, v[32:35] offset:16384
    ds_write_b128 v11, v[36:39] offset:17408
    ds_write_b128 v11, v[40:43] offset:18432
    ds_write_b128 v11, v[44:47] offset:19456
    s_waitcnt lgkmcnt(0)
    s_waitcnt vmcnt(8)
    ds_read_b64_tr_b16 v[32:33], v18 offset:20480
    ds_read_b64_tr_b16 v[34:35], v18 offset:20736
    ds_read_b64_tr_b16 v[36:37], v18 offset:22528
    ds_read_b64_tr_b16 v[38:39], v18 offset:22784
    ds_read_b64_tr_b16 v[40:41], v19 offset:20480
    ds_read_b64_tr_b16 v[42:43], v19 offset:20736
    ds_read_b64_tr_b16 v[44:45], v19 offset:22528
    ds_read_b64_tr_b16 v[46:47], v19 offset:22784
    s_waitcnt lgkmcnt(0)
    ds_write_b128 v11, v[32:35] offset:20480
    ds_write_b128 v11, v[36:39] offset:21504
    ds_write_b128 v11, v[40:43] offset:22528
    ds_write_b128 v11, v[44:47] offset:23552
    s_waitcnt lgkmcnt(0)
    s_waitcnt vmcnt(4)
    ds_read_b64_tr_b16 v[32:33], v18 offset:24576
    ds_read_b64_tr_b16 v[34:35], v18 offset:24832
    ds_read_b64_tr_b16 v[36:37], v18 offset:26624
    ds_read_b64_tr_b16 v[38:39], v18 offset:26880
    ds_read_b64_tr_b16 v[40:41], v19 offset:24576
    ds_read_b64_tr_b16 v[42:43], v19 offset:24832
    ds_read_b64_tr_b16 v[44:45], v19 offset:26624
    ds_read_b64_tr_b16 v[46:47], v19 offset:26880
    s_waitcnt lgkmcnt(0)
    ds_write_b128 v11, v[32:35] offset:24576
    ds_write_b128 v11, v[36:39] offset:25600
    ds_write_b128 v11, v[40:43] offset:26624
    ds_write_b128 v11, v[44:47] offset:27648
    s_waitcnt lgkmcnt(0)
    s_waitcnt vmcnt(0)
    ds_read_b64_tr_b16 v[32:33], v18 offset:28672
    ds_read_b64_tr_b16 v[34:35], v18 offset:28928
    ds_read_b64_tr_b16 v[36:37], v18 offset:30720
    ds_read_b64_tr_b16 v[38:39], v18 offset:30976
    ds_read_b64_tr_b16 v[40:41], v19 offset:28672
    ds_read_b64_tr_b16 v[42:43], v19 offset:28928
    ds_read_b64_tr_b16 v[44:45], v19 offset:30720
    ds_read_b64_tr_b16 v[46:47], v19 offset:30976
    s_waitcnt lgkmcnt(0)
    ds_write_b128 v11, v[32:35] offset:28672
    ds_write_b128 v11, v[36:39] offset:29696
    ds_write_b128 v11, v[40:43] offset:30720
    ds_write_b128 v11, v[44:47] offset:31744
    s_waitcnt lgkmcnt(0)
    s_waitcnt vmcnt(0)
    s_barrier
    s_lshl_b32 s46, s32, 2
    s_add_u32 s46, s46, 192
    s_cmp_eq_u32 s30, 0
    s_cbranch_scc0 cb_5
    s_mov_b64 exec, 1
    v_mov_b32 v14, 1
    v_mov_b32 v15, s46
    buffer_atomic_add v14, v15, s[8:11], 0 offen
    s_mov_b64 exec, -1
cw_6:
    buffer_load_dword v14, v15, s[8:11], 0 offen sc1
    s_waitcnt vmcnt(0)
    v_readfirstlane_b32 s47, v14
    s_nop 3
    s_cmp_ge_u32 s47, 32
    s_cbranch_scc1 cwd_7
    s_add_u32 s31, s31, 1
    s_cmp_gt_u32 s31, 300000
    s_cbranch_scc1 cwd_7
    s_sleep 2
    s_branch cw_6
cwd_7:
cb_5:
    s_cmp_eq_u32 s30, 0
    s_cbranch_scc0 winitb_8
    v_mov_b32 v15, 64
    s_nop 1
wd_9:
    buffer_load_dword v14, v15, s[8:11], 0 offen sc1
    s_waitcnt vmcnt(0)
    v_cmp_le_u32 vcc, 0x80, v14
    s_nop 3
    s_cbranch_vccnz wdd_10
    s_add_u32 s31, s31, 1
    s_cmp_gt_u32 s31, 300000
    s_cbranch_scc1 wdd_10
    s_sleep 6
    s_branch wd_9
wdd_10:
winitb_8:
    s_barrier
    s_mov_b32 s68, 0x00ff00ff
    s_mov_b32 s69, 0x00ff00ff
    s_mov_b32 s34, 0
    s_mov_b32 s45, 0
    s_mov_b32 s36, s60
    s_add_u32 s37, s61, 8192
    s_mov_b32 s38, s62
    s_mov_b32 s39, s63
    ds_read_b128 v[104:107], v5 offset:29696
    s_waitcnt lgkmcnt(0)
poll_11:
    buffer_load_dword v14, v107, s[4:7], s42 offen offset:0 sc1
    s_waitcnt vmcnt(0)
    v_cmp_ne_u32 vcc, 0, v14
    s_nop 3
    s_cmp_eq_u64 vcc, -1
    s_cbranch_scc1 polld_12
    s_add_u32 s31, s31, 1
    s_cmp_gt_u32 s31, 300000
    s_cbranch_scc1 polld_12
    s_sleep 1
    s_branch poll_11
polld_12:
    s_mov_b32 m0, s51
    s_add_u32 s47, s40, 8192
    buffer_load_dwordx4 v5, s[4:7], s40 offen sc1 lds
    buffer_load_dwordx4 v5, s[4:7], s40 offen offset:1024 sc1 lds
    s_add_u32 m0, s51, 8192
    s_nop 0
    buffer_load_dwordx4 v5, s[4:7], s47 offen sc1 lds
    buffer_load_dwordx4 v5, s[4:7], s47 offen offset:1024 sc1 lds
    s_add_u32 s40, s40, 786432
    s_add_u32 s42, s42, 6144
    buffer_load_dword v12, v107, s[4:7], s42 offen sc1
    v_mov_b64 v[48:49], 0
    v_mov_b64 v[50:51], 0
    v_mov_b64 v[52:53], 0
    v_mov_b64 v[54:55], 0
    v_mov_b64 v[56:57], 0
    v_mov_b64 v[58:59], 0
    v_mov_b64 v[60:61], 0
    v_mov_b64 v[62:63], 0
    v_mov_b64 v[64:65], 0
    v_mov_b64 v[66:67], 0
    v_mov_b64 v[68:69], 0
    v_mov_b64 v[70:71], 0
    ds_read_b128 v[72:75], v11 offset:0
    ds_read_b128 v[76:79], v11 offset:1024
    ds_read_b128 v[80:83], v11 offset:2048
    ds_read_b128 v[84:87], v11 offset:3072
    ds_read_b128 v[88:91], v11 offset:4096
    ds_read_b128 v[92:95], v11 offset:5120
    ds_read_b128 v[96:99], v11 offset:6144
    ds_read_b128 v[100:103], v11 offset:7168
    ds_read_b128 v[112:115], v11 offset:8192
    ds_read_b128 v[116:119], v11 offset:9216
    ds_read_b128 v[120:123], v11 offset:10240
    ds_read_b128 v[124:127], v11 offset:11264
L_step:
mpoll_13:
    buffer_load_dwordx4 v[16:19], v5, s[4:7], s36 offen sc1
    buffer_load_dwordx4 v[20:23], v5, s[4:7], s36 offen offset:1024 sc1
    s_waitcnt vmcnt(0)
    v_max3_u32 v13, v16, v17, v18
    v_max3_u32 v14, v19, v20, v21
    v_max3_u32 v13, v13, v22, v23
    v_max_u32 v13, v13, v14
    v_cmp_eq_u32 vcc, -1, v13
    s_nop 3
    s_cbranch_vccnz mretry_15
mpolld_14:
    ds_write_b128 v1, v[16:19] offset:16384
    ds_write_b128 v1, v[20:23] offset:17408
    v_smfmac_f32_16x16x64_bf16 v[48:51], v[16:19], a[0:7], v0
    v_smfmac_f32_16x16x64_bf16 v[52:55], v[16:19], a[8:15], v0
    v_mov_b32 v13, 1
    v_smfmac_f32_16x16x64_bf16 v[56:59], v[16:19], a[128:135], v0
    v_smfmac_f32_16x16x64_bf16 v[60:63], v[16:19], a[136:143], v0
    v_smfmac_f32_16x16x64_bf16 v[48:51], v[20:23], a[16:23], v0
    v_smfmac_f32_16x16x64_bf16 v[52:55], v[20:23], a[24:31], v0
    s_waitcnt vmcnt(0) lgkmcnt(0)
    s_barrier
    ds_read_b128 v[24:27], v2 offset:16384
    ds_read_b128 v[28:31], v2 offset:17408
    v_smfmac_f32_16x16x64_bf16 v[56:59], v[20:23], a[144:151], v0
    ds_read_b128 v[32:35], v3 offset:16384
    v_smfmac_f32_16x16x64_bf16 v[60:63], v[20:23], a[152:159], v0
    ds_read_b128 v[36:39], v3 offset:17408
    v_smfmac_f32_16x16x64_bf16 v[64:67], v[16:19], v[128:135], v0
    ds_read_b128 v[40:43], v4 offset:16384
    v_smfmac_f32_16x16x64_bf16 v[68:71], v[16:19], v[136:143], v0
    ds_read_b128 v[44:47], v4 offset:17408
    v_smfmac_f32_16x16x64_bf16 v[64:67], v[20:23], v[144:151], v0
    buffer_load_dword v12, v107, s[4:7], s42 offen sc1
    v_smfmac_f32_16x16x64_bf16 v[68:71], v[20:23], v[152:159], v0
    s_mov_b64 exec, s[64:65]
    buffer_store_dword v13, v107, s[4:7], s43 offen sc1
    s_mov_b64 exec, -1
    s_mov_b32 s43, s59
    s_add_u32 s59, s59, 6144
    s_waitcnt lgkmcnt(5)
    v_smfmac_f32_16x16x64_bf16 v[48:51], v[24:27], a[32:39], v0
    v_smfmac_f32_16x16x64_bf16 v[52:55], v[24:27], a[40:47], v0
    s_waitcnt lgkmcnt(4)
    v_smfmac_f32_16x16x64_bf16 v[48:51], v[28:31], a[48:55], v0
    v_smfmac_f32_16x16x64_bf16 v[52:55], v[28:31], a[56:63], v0
    s_waitcnt lgkmcnt(3)
    v_smfmac_f32_16x16x64_bf16 v[48:51], v[32:35], a[64:71], v0
    v_smfmac_f32_16x16x64_bf16 v[52:55], v[32:35], a[72:79], v0
    v_smfmac_f32_16x16x64_bf16 v[64:67], v[32:35], v[72:79], v0
    v_smfmac_f32_16x16x64_bf16 v[68:71], v[32:35], v[80:87], v0
    s_waitcnt lgkmcnt(2)
    v_smfmac_f32_16x16x64_bf16 v[48:51], v[36:39], a[80:87], v0
    ds_read_b128 v[16:19], v11 offset:12288
    v_smfmac_f32_16x16x64_bf16 v[52:55], v[36:39], a[88:95], v0
    ds_read_b128 v[20:23], v11 offset:13312
    v_smfmac_f32_16x16x64_bf16 v[64:67], v[36:39], v[88:95], v0
    ds_read_b128 v[104:107], v11 offset:14336
    v_smfmac_f32_16x16x64_bf16 v[68:71], v[36:39], v[96:103], v0
    ds_read_b128 v[108:111], v11 offset:15360
    s_waitcnt lgkmcnt(4)
    v_smfmac_f32_16x16x64_bf16 v[48:51], v[40:43], a[96:103], v0
    ds_read_b128 v[72:75], v5 offset:0
    v_smfmac_f32_16x16x64_bf16 v[52:55], v[40:43], a[104:111], v0
    ds_read_b128 v[76:79], v5 offset:1024
    v_smfmac_f32_16x16x64_bf16 v[48:51], v[44:47], a[112:119], v0
    ds_read_b128 v[80:83], v5 offset:2048
    v_smfmac_f32_16x16x64_bf16 v[52:55], v[44:47], a[120:127], v0
    ds_read_b128 v[84:87], v5 offset:3072
    s_waitcnt lgkmcnt(4)
    v_smfmac_f32_16x16x64_bf16 v[64:67], v[40:43], v[112:119], v0
    ds_read_b128 v[88:91], v5 offset:4096
    v_smfmac_f32_16x16x64_bf16 v[68:71], v[40:43], v[120:127], v0
    ds_read_b128 v[92:95], v5 offset:5120
    v_smfmac_f32_16x16x64_bf16 v[64:67], v[44:47], v[16:23], v0
    ds_read_b128 v[96:99], v5 offset:6144
    v_smfmac_f32_16x16x64_bf16 v[68:71], v[44:47], v[104:111], v0
    ds_read_b128 v[100:103], v5 offset:7168
    v_smfmac_f32_16x16x64_bf16 v[56:59], v[24:27], a[160:167], v0
    v_add_f32 v48, v48, v50
    v_smfmac_f32_16x16x64_bf16 v[60:63], v[24:27], a[168:175], v0
    v_add_f32 v49, v49, v51
    v_smfmac_f32_16x16x64_bf16 v[56:59], v[28:31], a[176:183], v0
    v_add_f32 v52, v52, v54
    v_smfmac_f32_16x16x64_bf16 v[60:63], v[28:31], a[184:191], v0
    v_add_f32 v53, v53, v55
    v_smfmac_f32_16x16x64_bf16 v[56:59], v[32:35], a[192:199], v0
    v_cvt_pk_bf16_f32 v48, v48, v49
    v_smfmac_f32_16x16x64_bf16 v[60:63], v[32:35], a[200:207], v0
    v_cvt_pk_bf16_f32 v52, v52, v53
    v_smfmac_f32_16x16x64_bf16 v[56:59], v[36:39], a[208:215], v0
    ds_write2_b32 v6, v48, v52 offset0:0 offset1:160
    v_smfmac_f32_16x16x64_bf16 v[60:63], v[36:39], a[216:223], v0
    ds_read_b128 v[120:123], v1 offset:8192
    v_smfmac_f32_16x16x64_bf16 v[56:59], v[40:43], a[224:231], v0
    s_waitcnt lgkmcnt(1)
    s_barrier
    v_smfmac_f32_16x16x64_bf16 v[60:63], v[40:43], a[232:239], v0
    ds_read_b64_tr_b16 v[104:105], v8 offset:24576
    ds_read_b64_tr_b16 v[106:107], v8 offset:24896
    ds_read_b64_tr_b16 v[108:109], v8 offset:25856
    v_smfmac_f32_16x16x64_bf16 v[56:59], v[44:47], a[240:247], v0
    ds_read_b64_tr_b16 v[110:111], v8 offset:26176
    ds_read_b64_tr_b16 v[112:113], v8 offset:27136
    ds_read_b64_tr_b16 v[114:115], v8 offset:27456
    v_smfmac_f32_16x16x64_bf16 v[60:63], v[44:47], a[248:255], v0
    ds_read_b64_tr_b16 v[116:117], v8 offset:28416
    ds_read_b64_tr_b16 v[118:119], v8 offset:28736
    s_mul_i32 s46, s30, 1280
    v_smfmac_f32_16x16x64_bf16 v[64:67], v[24:27], v[160:167], v0
    ds_read_b128 v[124:127], v1 offset:9216
    v_smfmac_f32_16x16x64_bf16 v[68:71], v[24:27], v[168:175], v0
    v_add_u32 v15, s46, v8
    v_smfmac_f32_16x16x64_bf16 v[64:67], v[28:31], v[176:183], v0
    v_smfmac_f32_16x16x64_bf16 v[68:71], v[28:31], v[184:191], v0
    s_waitcnt lgkmcnt(0)
    v_mfma_f32_16x16x32_bf16 v[16:19], v[72:75], v[104:107], 0
    v_add_f32 v56, v56, v58
    v_add_f32 v57, v57, v59
    v_mfma_f32_16x16x32_bf16 v[20:23], v[88:91], v[104:107], 0
    v_add_f32 v60, v60, v62
    v_add_f32 v61, v61, v63
    v_mfma_f32_16x16x32_bf16 v[16:19], v[76:79], v[108:111], v[16:19]
    v_cvt_pk_bf16_f32 v56, v56, v57
    v_cvt_pk_bf16_f32 v60, v60, v61
    v_mfma_f32_16x16x32_bf16 v[20:23], v[92:95], v[108:111], v[20:23]
    ds_write2_b32 v7, v56, v56 offset0:0 offset1:1
    ds_write2_b32 v7, v60, v60 offset0:160 offset1:161
    s_waitcnt vmcnt(1)
    v_cmp_ne_u32 vcc, 0, v12
    v_mfma_f32_16x16x32_bf16 v[16:19], v[80:83], v[112:115], v[16:19]
    s_nop 2
    s_cmp_eq_u64 vcc, -1
    s_cselect_b32 s44, 1, 0
    s_cselect_b32 s49, s40, s66
    v_mfma_f32_16x16x32_bf16 v[20:23], v[96:99], v[112:115], v[20:23]
    s_mov_b32 m0, s51
    s_add_u32 s47, s49, 8192
    buffer_load_dwordx4 v5, s[4:7], s49 offen sc1 lds
    v_mfma_f32_16x16x32_bf16 v[16:19], v[84:87], v[116:119], v[16:19]
    buffer_load_dwordx4 v5, s[4:7], s49 offen offset:1024 sc1 lds
    s_add_u32 m0, s51, 8192
    s_nop 0
    buffer_load_dwordx4 v5, s[4:7], s47 offen sc1 lds
    v_mfma_f32_16x16x32_bf16 v[20:23], v[100:103], v[116:119], v[20:23]
    buffer_load_dwordx4 v5, s[4:7], s47 offen offset:1024 sc1 lds
    s_waitcnt lgkmcnt(0)
    s_barrier
    ds_read_b64_tr_b16 v[48:49], v8 offset:16384
    ds_read_b64_tr_b16 v[50:51], v8 offset:16704
    ds_read_b64_tr_b16 v[52:53], v8 offset:17664
    ds_read_b64_tr_b16 v[54:55], v8 offset:17984
    ds_read_b64_tr_b16 v[56:57], v8 offset:18944
    ds_read_b64_tr_b16 v[58:59], v8 offset:19264
    ds_read_b64_tr_b16 v[60:61], v8 offset:20224
    ds_read_b64_tr_b16 v[62:63], v8 offset:20544
    ds_read_b64_tr_b16 v[40:41], v15 offset:16384
    ds_read_b64_tr_b16 v[42:43], v15 offset:16704
    ds_read_b128 v[72:75], v11 offset:16384
    ds_read_b128 v[76:79], v11 offset:17408
    ds_read_b128 v[80:83], v11 offset:20480
    ds_read_b128 v[84:87], v11 offset:21504
    v_cvt_pk_bf16_f32 v64, v64, v65
    v_cvt_pk_bf16_f32 v65, v66, v67
    v_cvt_pk_bf16_f32 v66, v68, v69
    v_cvt_pk_bf16_f32 v67, v70, v71
    s_add_u32 s46, s41, 4096
    buffer_store_dwordx4 v[64:67], v5, s[4:7], s46 offen sc1
    s_waitcnt lgkmcnt(12)
    v_mfma_f32_16x16x32_bf16 v[24:27], v[48:51], v[104:107], 0
    s_waitcnt lgkmcnt(10)
    v_mfma_f32_16x16x32_bf16 v[24:27], v[52:55], v[108:111], v[24:27]
    s_waitcnt lgkmcnt(8)
    v_mfma_f32_16x16x32_bf16 v[24:27], v[56:59], v[112:115], v[24:27]
    s_waitcnt lgkmcnt(6)
    v_mfma_f32_16x16x32_bf16 v[24:27], v[60:63], v[116:119], v[24:27]
    v_max3_f32 v44, v17, v18, v19
    v_max3_f32 v34, v16, v20, v21
    s_waitcnt lgkmcnt(4)
    buffer_store_dwordx4 v[40:43], v5, s[4:7], s41 offen sc1
    v_max3_f32 v44, v44, v22, v23
    s_cmp_eq_u32 s34, 63
    s_nop 0
    s_cbranch_scc1 L_chain_end
    v_max3_f32 v34, v34, v24, v25
    v_max_f32 v34, v34, v44
    v_mov_b32 v44, v34
    ds_read_b128 v[88:91], v11 offset:18432
    ds_read_b128 v[92:95], v11 offset:19456
    v_permlane16_swap_b32 v34, v44
    v_max_f32 v34, v34, v44
    v_mov_b32 v44, v34
    ds_read_b128 v[96:99], v11 offset:22528
    ds_read_b128 v[100:103], v11 offset:23552
    v_permlane32_swap_b32 v34, v44
    v_max_f32 v34, v34, v44
    v_mul_f32 v44, s50, v34
    v_fma_f32 v24, v24, s50, -v44
    v_fma_f32 v25, v25, s50, -v44
    v_fma_f32 v16, v16, s50, -v44
    v_fma_f32 v17, v17, s50, -v44
    v_fma_f32 v18, v18, s50, -v44
    v_fma_f32 v19, v19, s50, -v44
    v_fma_f32 v20, v20, s50, -v44
    v_fma_f32 v21, v21, s50, -v44
    v_fma_f32 v22, v22, s50, -v44
    v_fma_f32 v23, v23, s50, -v44
    ds_read_b128 v[48:51], v11 offset:24576
    ds_read_b128 v[52:55], v11 offset:25600
    v_exp_f32 v24, v24
    v_exp_f32 v25, v25
    v_exp_f32 v16, v16
    v_exp_f32 v17, v17
    ds_read_b128 v[56:59], v11 offset:28672
    ds_read_b128 v[60:63], v11 offset:29696
    v_exp_f32 v18, v18
    v_exp_f32 v19, v19
    v_exp_f32 v20, v20
    v_exp_f32 v21, v21
    v_exp_f32 v22, v22
    v_exp_f32 v23, v23
    v_cvt_pk_bf16_f32 v32, v24, v25
    v_cvt_pk_bf16_f32 v33, v24, v25
    v_cvt_pk_bf16_f32 v28, v16, v17
    v_cvt_pk_bf16_f32 v29, v18, v19
    v_mfma_f32_16x16x16_bf16 v[104:107], v[64:65], v[32:33], 0
    v_cvt_pk_bf16_f32 v30, v20, v21
    v_cvt_pk_bf16_f32 v31, v22, v23
    v_mfma_f32_16x16x16_bf16 v[108:111], v[66:67], v[32:33], 0
    v_add_f32 v35, v24, v25
    v_add_f32 v44, v16, v17
    v_mfma_f32_16x16x32_bf16 v[104:107], v[120:123], v[28:31], v[104:107]
    v_add_f32 v45, v18, v19
    v_add_f32 v35, v35, v44
    v_mfma_f32_16x16x32_bf16 v[108:111], v[124:127], v[28:31], v[108:111]
    v_add_f32 v44, v20, v21
    v_add_f32 v35, v35, v45
    v_add_f32 v45, v22, v23
    v_add_f32 v35, v35, v44
    v_add_f32 v35, v35, v45
    v_mov_b32 v44, v35
    ds_read_b128 v[112:115], v11 offset:26624
    ds_read_b128 v[116:119], v11 offset:27648
    v_permlane16_swap_b32 v35, v44
    v_add_f32 v35, v35, v44
    v_mov_b32 v44, v35
    ds_read_b128 v[64:67], v11 offset:30720
    ds_read_b128 v[68:71], v11 offset:31744
    v_permlane32_swap_b32 v35, v44
    v_add_f32 v35, v35, v44
    v_rcp_f32 v45, v35
    v_mov_b64 v[16:17], 0
    v_mul_f32 v104, v104, v45
    v_mul_f32 v105, v105, v45
    v_mul_f32 v106, v106, v45
    v_mul_f32 v107, v107, v45
    v_mul_f32 v108, v108, v45
    v_mul_f32 v109, v109, v45
    v_mul_f32 v110, v110, v45
    v_mul_f32 v111, v111, v45
    v_cvt_pk_bf16_f32 v36, v104, v105
    v_cvt_pk_bf16_f32 v37, v106, v107
    v_cvt_pk_bf16_f32 v38, v108, v109
    v_cvt_pk_bf16_f32 v39, v110, v111
    s_mov_b64 exec, s[68:69]
    ds_write_b128 v9, v[36:39] offset:21504
    s_mov_b64 exec, -1
    v_mov_b64 v[18:19], 0
    v_mov_b64 v[20:21], 0
    v_mov_b64 v[22:23], 0
    v_mov_b64 v[24:25], 0
    v_mov_b64 v[26:27], 0
    v_mov_b64 v[28:29], 0
    v_mov_b64 v[30:31], 0
    v_mov_b64 v[32:33], 0
    v_mov_b64 v[34:35], 0
    s_waitcnt lgkmcnt(0)
    s_barrier
    ds_read_b128 v[120:123], v10 offset:21504
    ds_read_b128 v[124:127], v10 offset:21632
    ds_read_b128 v[104:107], v5 offset:29696
    ds_read_b128 v[108:111], v5 offset:30720
    v_mov_b64 v[36:37], 0
    v_mov_b64 v[38:39], 0
    v_mov_b64 v[40:41], 0
    v_mov_b64 v[42:43], 0
    v_mov_b64 v[44:45], 0
    v_mov_b64 v[46:47], 0
    s_waitcnt lgkmcnt(2)
    v_smfmac_f32_16x16x64_bf16 v[16:19], v[120:123], v[192:199], v0
    v_smfmac_f32_16x16x64_bf16 v[20:23], v[120:123], v[208:215], v0
    v_smfmac_f32_16x16x64_bf16 v[16:19], v[124:127], v[200:207], v0
    v_smfmac_f32_16x16x64_bf16 v[20:23], v[124:127], v[216:223], v0
    v_smfmac_f32_16x16x64_bf16 v[24:27], v[120:123], v[224:231], v0
    v_smfmac_f32_16x16x64_bf16 v[28:31], v[120:123], v[240:247], v0
    v_smfmac_f32_16x16x64_bf16 v[24:27], v[124:127], v[232:239], v0
    v_smfmac_f32_16x16x64_bf16 v[28:31], v[124:127], v[248:255], v0
    v_smfmac_f32_16x16x64_bf16 v[32:35], v[120:123], v[72:79], v0
    s_nop 1
    v_add_f32 v16, v16, v18
    v_smfmac_f32_16x16x64_bf16 v[36:39], v[120:123], v[88:95], v0
    v_add_f32 v17, v17, v19
    v_smfmac_f32_16x16x64_bf16 v[32:35], v[124:127], v[80:87], v0
    v_cvt_pk_bf16_f32 v72, v16, v17
    v_add_f32 v20, v20, v22
    v_smfmac_f32_16x16x64_bf16 v[36:39], v[124:127], v[96:103], v0
    v_add_f32 v21, v21, v23
    v_cvt_pk_bf16_f32 v73, v20, v21
    v_smfmac_f32_16x16x64_bf16 v[40:43], v[120:123], v[48:55], v0
    v_add_f32 v24, v24, v26
    v_add_f32 v25, v25, v27
    v_smfmac_f32_16x16x64_bf16 v[44:47], v[120:123], v[112:119], v0
    v_cvt_pk_bf16_f32 v74, v24, v25
    v_add_f32 v28, v28, v30
    v_smfmac_f32_16x16x64_bf16 v[40:43], v[124:127], v[56:63], v0
    v_add_f32 v29, v29, v31
    v_cvt_pk_bf16_f32 v75, v28, v29
    v_smfmac_f32_16x16x64_bf16 v[44:47], v[124:127], v[64:71], v0
    buffer_store_dwordx4 v[72:75], v5, s[4:7], s38 offen
    v_add_f32 v32, v32, v34
    v_add_f32 v33, v33, v35
    v_cvt_pk_bf16_f32 v76, v32, v33
    v_add_f32 v36, v36, v38
    v_add_f32 v37, v37, v39
    v_cvt_pk_bf16_f32 v77, v36, v37
    v_add_f32 v40, v40, v42
    v_add_f32 v41, v41, v43
    v_cvt_pk_bf16_f32 v78, v40, v41
    v_add_f32 v44, v44, v46
    v_add_f32 v45, v45, v47
    v_cvt_pk_bf16_f32 v79, v44, v45
    buffer_store_dwordx4 v[76:79], v5, s[4:7], s38 offen offset:1024
    v_mov_b64 v[48:49], 0
    v_mov_b64 v[50:51], 0
    v_mov_b64 v[52:53], 0
    v_mov_b64 v[54:55], 0
    v_mov_b64 v[56:57], 0
    v_mov_b64 v[58:59], 0
    v_mov_b64 v[60:61], 0
    v_mov_b64 v[62:63], 0
    v_mov_b64 v[64:65], 0
    v_mov_b64 v[66:67], 0
    v_mov_b64 v[68:69], 0
    v_mov_b64 v[70:71], 0
    s_add_u32 s47, s39, 0x20000
    s_sleep 5
ppoll_17:
    buffer_load_dwordx4 v[80:83], v105, s[4:7], s39 offen sc1
    buffer_load_dwordx4 v[84:87], v105, s[4:7], s47 offen sc1
    s_waitcnt vmcnt(0)
    v_max3_u32 v13, v80, v81, v82
    v_max3_u32 v14, v83, v84, v85
    v_max3_u32 v13, v13, v86, v87
    v_max_u32 v13, v13, v14
    v_cmp_eq_u32 vcc, -1, v13
    s_nop 3
    s_cbranch_vccnz pretry_19
ppolld_18:
    v_mfma_f32_16x16x32_bf16 v[88:91], v[108:111], v[80:83], 0
    v_mfma_f32_16x16x32_bf16 v[88:91], v[108:111], v[84:87], v[88:91]
    s_add_u32 s45, s45, 1
    s_cmp_eq_u32 s45, 3
    s_cselect_b32 s45, 0, s45
    s_lshl_b32 s46, s45, 13
    s_add_u32 s36, s60, s46
    s_lshl_b32 s47, s45, 18
    v_mov_b64 v[44:45], -1
    v_mov_b64 v[46:47], -1
    v_add_f32_dpp v88, v88, v88 row_ror:8 row_mask:0xf bank_mask:0xf
    v_add_f32_dpp v89, v89, v89 row_ror:8 row_mask:0xf bank_mask:0xf
    v_add_f32_dpp v90, v90, v90 row_ror:8 row_mask:0xf bank_mask:0xf
    v_add_f32_dpp v91, v91, v91 row_ror:8 row_mask:0xf bank_mask:0xf
    v_add_f32_dpp v88, v88, v88 row_ror:4 row_mask:0xf bank_mask:0xf
    v_add_f32_dpp v89, v89, v89 row_ror:4 row_mask:0xf bank_mask:0xf
    v_add_f32_dpp v90, v90, v90 row_ror:4 row_mask:0xf bank_mask:0xf
    v_add_f32_dpp v91, v91, v91 row_ror:4 row_mask:0xf bank_mask:0xf
    v_cndmask_b32 v88, v88, v89, s[52:53]
    v_cndmask_b32 v90, v90, v91, s[52:53]
    v_cvt_pk_bf16_f32 v88, v88, v90
    s_mov_b64 exec, s[56:57]
    buffer_store_dword v88, v106, s[4:7], s37 offen
    s_mov_b64 exec, -1
    s_add_u32 s38, s62, s47
    s_add_u32 s39, s63, s47
    s_add_u32 s48, s45, 1
    s_cmp_eq_u32 s48, 3
    s_cselect_b32 s48, 0, s48
    s_lshl_b32 s46, s48, 13
    s_add_u32 s37, s61, s46
    s_lshl_b32 s46, s48, 18
    s_add_u32 s46, s62, s46
    buffer_store_dwordx4 v[44:47], v5, s[4:7], s46 offen
    buffer_store_dwordx4 v[44:47], v5, s[4:7], s46 offen offset:1024
    s_mov_b64 exec, s[56:57]
    buffer_store_dword v44, v106, s[4:7], s37 offen
    s_mov_b64 exec, -1
    s_waitcnt vmcnt(4)
    ds_read_b128 v[72:75], v11 offset:0
    ds_read_b128 v[76:79], v11 offset:1024
    ds_read_b128 v[80:83], v11 offset:2048
    ds_read_b128 v[84:87], v11 offset:3072
    ds_read_b128 v[88:91], v11 offset:4096
    ds_read_b128 v[92:95], v11 offset:5120
    ds_read_b128 v[96:99], v11 offset:6144
    ds_read_b128 v[100:103], v11 offset:7168
    ds_read_b128 v[112:115], v11 offset:8192
    ds_read_b128 v[116:119], v11 offset:9216
    ds_read_b128 v[120:123], v11 offset:10240
    ds_read_b128 v[124:127], v11 offset:11264
    s_cmp_ge_u32 s34, 62
    s_cbranch_scc1 kvok_21
    s_cmp_eq_u32 s44, 1
    s_cbranch_scc1 kvok_21
poll_22:
    buffer_load_dword v14, v107, s[4:7], s42 offen offset:0 sc1
    s_waitcnt vmcnt(0)
    v_cmp_ne_u32 vcc, 0, v14
    s_nop 3
    s_cmp_eq_u64 vcc, -1
    s_cbranch_scc1 polld_23
    s_add_u32 s31, s31, 1
    s_cmp_gt_u32 s31, 300000
    s_cbranch_scc1 polld_23
    s_sleep 1
    s_branch poll_22
polld_23:
    s_mov_b32 m0, s51
    s_add_u32 s47, s40, 8192
    buffer_load_dwordx4 v5, s[4:7], s40 offen sc1 lds
    buffer_load_dwordx4 v5, s[4:7], s40 offen offset:1024 sc1 lds
    s_add_u32 m0, s51, 8192
    s_nop 0
    buffer_load_dwordx4 v5, s[4:7], s47 offen sc1 lds
    buffer_load_dwordx4 v5, s[4:7], s47 offen offset:1024 sc1 lds
kvok_21:
    s_add_u32 s34, s34, 1
    s_add_u32 s40, s40, 786432
    s_add_u32 s41, s41, 262144
    s_add_u32 s42, s42, 6144
    s_sleep 2
    s_branch L_step
mretry_15:
    s_add_u32 s31, s31, 1
    s_cmp_gt_u32 s31, 300000
    s_cbranch_scc0 mpoll_13
    s_branch mpolld_14
pretry_19:
    s_add_u32 s31, s31, 1
    s_cmp_gt_u32 s31, 300000
    s_cbranch_scc0 ppoll_17
    s_branch ppolld_18
L_chain_end:
    s_waitcnt vmcnt(0)
    s_barrier
    v_mov_b32 v13, 1
    v_mov_b32 v14, 0
    s_mov_b64 exec, s[64:65]
    buffer_store_dword v13, v14, s[4:7], s43 offen sc1
    s_mov_b64 exec, -1
    s_waitcnt vmcnt(0)
    s_branch L_exit
L_s1j:
    s_sub_u32 s40, s28, 2
    s_mov_b32 s32, s40
    s_mov_b32 s34, 0
    s_mov_b32 s35, 0
    s_mov_b32 s38, 32
    s_mov_b32 s39, 14
    s_mov_b32 s33, s29
    s_load_dwordx2 s[12:13], s[0:1], 16
    s_load_dwordx2 s[16:17], s[0:1], 24
    s_load_dwordx2 s[20:21], s[0:1], 32
    s_waitcnt lgkmcnt(0)
    s_mov_b32 s14, 0x400000
    s_mov_b32 s15, 0x20000
    s_mov_b32 s18, 0x400000
    s_mov_b32 s19, 0x20000
    s_mov_b32 s22, 0x400000
    s_mov_b32 s23, 0x20000
    s_lshl_b32 s51, s30, 15
    v_lshrrev_b32 v13, 5, v0
    v_lshlrev_b32 v13, 3, v13
    v_bfe_u32 v14, v0, 2, 2
    v_add_u32 v13, v13, v14
    v_lshlrev_b32 v13, 6, v13
    v_bfe_u32 v14, v0, 4, 1
    v_lshl_add_u32 v13, v14, 5, v13
    v_and_b32 v14, 3, v0
    v_lshl_add_u32 v13, v14, 3, v13
    v_add_u32 v21, s51, v13
    v_lshrrev_b32 v13, 2, v0
    v_and_b32 v14, 3, v0
    v_lshlrev_b32 v14, 4, v14
    v_lshl_add_u32 v20, v13, 13, v14
    s_lshl_b32 s52, s33, 8
    s_lshl_b32 s40, s30, 6
    s_add_u32 s52, s52, s40
    s_waitcnt vmcnt(0)
    s_add_u32 s50, s52, 0
    s_add_u32 m0, s51, 0
    s_nop 0
    buffer_load_dwordx4 v20, s[16:19], s50 offen lds
    s_add_u32 s50, s52, 131072
    s_add_u32 m0, s51, 1024
    s_nop 0
    buffer_load_dwordx4 v20, s[16:19], s50 offen lds
    s_add_u32 s50, s52, 262144
    s_add_u32 m0, s51, 2048
    s_nop 0
    buffer_load_dwordx4 v20, s[16:19], s50 offen lds
    s_add_u32 s50, s52, 393216
    s_add_u32 m0, s51, 3072
    s_nop 0
    buffer_load_dwordx4 v20, s[16:19], s50 offen lds
    s_add_u32 s50, s52, 524288
    s_add_u32 m0, s51, 4096
    s_nop 0
    buffer_load_dwordx4 v20, s[16:19], s50 offen lds
    s_add_u32 s50, s52, 655360
    s_add_u32 m0, s51, 5120
    s_nop 0
    buffer_load_dwordx4 v20, s[16:19], s50 offen lds
    s_add_u32 s50, s52, 786432
    s_add_u32 m0, s51, 6144
    s_nop 0
    buffer_load_dwordx4 v20, s[16:19], s50 offen lds
    s_add_u32 s50, s52, 917504
    s_add_u32 m0, s51, 7168
    s_nop 0
    buffer_load_dwordx4 v20, s[16:19], s50 offen lds
    s_add_u32 s50, s52, 1048576
    s_add_u32 m0, s51, 8192
    s_nop 0
    buffer_load_dwordx4 v20, s[16:19], s50 offen lds
    s_add_u32 s50, s52, 1179648
    s_add_u32 m0, s51, 9216
    s_nop 0
    buffer_load_dwordx4 v20, s[16:19], s50 offen lds
    s_add_u32 s50, s52, 1310720
    s_add_u32 m0, s51, 10240
    s_nop 0
    buffer_load_dwordx4 v20, s[16:19], s50 offen lds
    s_add_u32 s50, s52, 1441792
    s_add_u32 m0, s51, 11264
    s_nop 0
    buffer_load_dwordx4 v20, s[16:19], s50 offen lds
    s_add_u32 s50, s52, 1572864
    s_add_u32 m0, s51, 12288
    s_nop 0
    buffer_load_dwordx4 v20, s[16:19], s50 offen lds
    s_add_u32 s50, s52, 1703936
    s_add_u32 m0, s51, 13312
    s_nop 0
    buffer_load_dwordx4 v20, s[16:19], s50 offen lds
    s_add_u32 s50, s52, 1835008
    s_add_u32 m0, s51, 14336
    s_nop 0
    buffer_load_dwordx4 v20, s[16:19], s50 offen lds
    s_add_u32 s50, s52, 1966080
    s_add_u32 m0, s51, 15360
    s_nop 0
    buffer_load_dwordx4 v20, s[16:19], s50 offen lds
    s_add_u32 s50, s52, 2097152
    s_add_u32 m0, s51, 16384
    s_nop 0
    buffer_load_dwordx4 v20, s[16:19], s50 offen lds
    s_add_u32 s50, s52, 2228224
    s_add_u32 m0, s51, 17408
    s_nop 0
    buffer_load_dwordx4 v20, s[16:19], s50 offen lds
    s_add_u32 s50, s52, 2359296
    s_add_u32 m0, s51, 18432
    s_nop 0
    buffer_load_dwordx4 v20, s[16:19], s50 offen lds
    s_add_u32 s50, s52, 2490368
    s_add_u32 m0, s51, 19456
    s_nop 0
    buffer_load_dwordx4 v20, s[16:19], s50 offen lds
    s_add_u32 s50, s52, 2621440
    s_add_u32 m0, s51, 20480
    s_nop 0
    buffer_load_dwordx4 v20, s[16:19], s50 offen lds
    s_add_u32 s50, s52, 2752512
    s_add_u32 m0, s51, 21504
    s_nop 0
    buffer_load_dwordx4 v20, s[16:19], s50 offen lds
    s_add_u32 s50, s52, 2883584
    s_add_u32 m0, s51, 22528
    s_nop 0
    buffer_load_dwordx4 v20, s[16:19], s50 offen lds
    s_add_u32 s50, s52, 3014656
    s_add_u32 m0, s51, 23552
    s_nop 0
    buffer_load_dwordx4 v20, s[16:19], s50 offen lds
    s_add_u32 s50, s52, 3145728
    s_add_u32 m0, s51, 24576
    s_nop 0
    buffer_load_dwordx4 v20, s[16:19], s50 offen lds
    s_add_u32 s50, s52, 3276800
    s_add_u32 m0, s51, 25600
    s_nop 0
    buffer_load_dwordx4 v20, s[16:19], s50 offen lds
    s_add_u32 s50, s52, 3407872
    s_add_u32 m0, s51, 26624
    s_nop 0
    buffer_load_dwordx4 v20, s[16:19], s50 offen lds
    s_add_u32 s50, s52, 3538944
    s_add_u32 m0, s51, 27648
    s_nop 0
    buffer_load_dwordx4 v20, s[16:19], s50 offen lds
    s_add_u32 s50, s52, 3670016
    s_add_u32 m0, s51, 28672
    s_nop 0
    buffer_load_dwordx4 v20, s[16:19], s50 offen lds
    s_add_u32 s50, s52, 3801088
    s_add_u32 m0, s51, 29696
    s_nop 0
    buffer_load_dwordx4 v20, s[16:19], s50 offen lds
    s_add_u32 s50, s52, 3932160
    s_add_u32 m0, s51, 30720
    s_nop 0
    buffer_load_dwordx4 v20, s[16:19], s50 offen lds
    s_add_u32 s50, s52, 4063232
    s_add_u32 m0, s51, 31744
    s_nop 0
    buffer_load_dwordx4 v20, s[16:19], s50 offen lds
    s_waitcnt vmcnt(28)
    ds_read_b64_tr_b16 a[128:129], v21 offset:0
    ds_read_b64_tr_b16 a[130:131], v21 offset:256
    ds_read_b64_tr_b16 a[132:133], v21 offset:1024
    ds_read_b64_tr_b16 a[134:135], v21 offset:1280
    ds_read_b64_tr_b16 a[136:137], v21 offset:2048
    ds_read_b64_tr_b16 a[138:139], v21 offset:2304
    ds_read_b64_tr_b16 a[140:141], v21 offset:3072
    ds_read_b64_tr_b16 a[142:143], v21 offset:3328
    s_waitcnt lgkmcnt(0)
    s_add_u32 s50, s52, 0
    s_add_u32 m0, s51, 0
    s_nop 0
    buffer_load_dwordx4 v20, s[20:23], s50 offen lds
    s_add_u32 s50, s52, 131072
    s_add_u32 m0, s51, 1024
    s_nop 0
    buffer_load_dwordx4 v20, s[20:23], s50 offen lds
    s_add_u32 s50, s52, 262144
    s_add_u32 m0, s51, 2048
    s_nop 0
    buffer_load_dwordx4 v20, s[20:23], s50 offen lds
    s_add_u32 s50, s52, 393216
    s_add_u32 m0, s51, 3072
    s_nop 0
    buffer_load_dwordx4 v20, s[20:23], s50 offen lds
    s_waitcnt vmcnt(28)
    ds_read_b64_tr_b16 a[144:145], v21 offset:4096
    ds_read_b64_tr_b16 a[146:147], v21 offset:4352
    ds_read_b64_tr_b16 a[148:149], v21 offset:5120
    ds_read_b64_tr_b16 a[150:151], v21 offset:5376
    ds_read_b64_tr_b16 a[152:153], v21 offset:6144
    ds_read_b64_tr_b16 a[154:155], v21 offset:6400
    ds_read_b64_tr_b16 a[156:157], v21 offset:7168
    ds_read_b64_tr_b16 a[158:159], v21 offset:7424
    s_waitcnt lgkmcnt(0)
    s_add_u32 s50, s52, 524288
    s_add_u32 m0, s51, 4096
    s_nop 0
    buffer_load_dwordx4 v20, s[20:23], s50 offen lds
    s_add_u32 s50, s52, 655360
    s_add_u32 m0, s51, 5120
    s_nop 0
    buffer_load_dwordx4 v20, s[20:23], s50 offen lds
    s_add_u32 s50, s52, 786432
    s_add_u32 m0, s51, 6144
    s_nop 0
    buffer_load_dwordx4 v20, s[20:23], s50 offen lds
    s_add_u32 s50, s52, 917504
    s_add_u32 m0, s51, 7168
    s_nop 0
    buffer_load_dwordx4 v20, s[20:23], s50 offen lds
    s_waitcnt vmcnt(28)
    ds_read_b64_tr_b16 a[160:161], v21 offset:8192
    ds_read_b64_tr_b16 a[162:163], v21 offset:8448
    ds_read_b64_tr_b16 a[164:165], v21 offset:9216
    ds_read_b64_tr_b16 a[166:167], v21 offset:9472
    ds_read_b64_tr_b16 a[168:169], v21 offset:10240
    ds_read_b64_tr_b16 a[170:171], v21 offset:10496
    ds_read_b64_tr_b16 a[172:173], v21 offset:11264
    ds_read_b64_tr_b16 a[174:175], v21 offset:11520
    s_waitcnt lgkmcnt(0)
    s_add_u32 s50, s52, 1048576
    s_add_u32 m0, s51, 8192
    s_nop 0
    buffer_load_dwordx4 v20, s[20:23], s50 offen lds
    s_add_u32 s50, s52, 1179648
    s_add_u32 m0, s51, 9216
    s_nop 0
    buffer_load_dwordx4 v20, s[20:23], s50 offen lds
    s_add_u32 s50, s52, 1310720
    s_add_u32 m0, s51, 10240
    s_nop 0
    buffer_load_dwordx4 v20, s[20:23], s50 offen lds
    s_add_u32 s50, s52, 1441792
    s_add_u32 m0, s51, 11264
    s_nop 0
    buffer_load_dwordx4 v20, s[20:23], s50 offen lds
    s_waitcnt vmcnt(28)
    ds_read_b64_tr_b16 a[176:177], v21 offset:12288
    ds_read_b64_tr_b16 a[178:179], v21 offset:12544
    ds_read_b64_tr_b16 a[180:181], v21 offset:13312
    ds_read_b64_tr_b16 a[182:183], v21 offset:13568
    ds_read_b64_tr_b16 a[184:185], v21 offset:14336
    ds_read_b64_tr_b16 a[186:187], v21 offset:14592
    ds_read_b64_tr_b16 a[188:189], v21 offset:15360
    ds_read_b64_tr_b16 a[190:191], v21 offset:15616
    s_waitcnt lgkmcnt(0)
    s_add_u32 s50, s52, 1572864
    s_add_u32 m0, s51, 12288
    s_nop 0
    buffer_load_dwordx4 v20, s[20:23], s50 offen lds
    s_add_u32 s50, s52, 1703936
    s_add_u32 m0, s51, 13312
    s_nop 0
    buffer_load_dwordx4 v20, s[20:23], s50 offen lds
    s_add_u32 s50, s52, 1835008
    s_add_u32 m0, s51, 14336
    s_nop 0
    buffer_load_dwordx4 v20, s[20:23], s50 offen lds
    s_add_u32 s50, s52, 1966080
    s_add_u32 m0, s51, 15360
    s_nop 0
    buffer_load_dwordx4 v20, s[20:23], s50 offen lds
    s_waitcnt vmcnt(28)
    ds_read_b64_tr_b16 a[192:193], v21 offset:16384
    ds_read_b64_tr_b16 a[194:195], v21 offset:16640
    ds_read_b64_tr_b16 a[196:197], v21 offset:17408
    ds_read_b64_tr_b16 a[198:199], v21 offset:17664
    ds_read_b64_tr_b16 a[200:201], v21 offset:18432
    ds_read_b64_tr_b16 a[202:203], v21 offset:18688
    ds_read_b64_tr_b16 a[204:205], v21 offset:19456
    ds_read_b64_tr_b16 a[206:207], v21 offset:19712
    s_waitcnt lgkmcnt(0)
    s_add_u32 s50, s52, 2097152
    s_add_u32 m0, s51, 16384
    s_nop 0
    buffer_load_dwordx4 v20, s[20:23], s50 offen lds
    s_add_u32 s50, s52, 2228224
    s_add_u32 m0, s51, 17408
    s_nop 0
    buffer_load_dwordx4 v20, s[20:23], s50 offen lds
    s_add_u32 s50, s52, 2359296
    s_add_u32 m0, s51, 18432
    s_nop 0
    buffer_load_dwordx4 v20, s[20:23], s50 offen lds
    s_add_u32 s50, s52, 2490368
    s_add_u32 m0, s51, 19456
    s_nop 0
    buffer_load_dwordx4 v20, s[20:23], s50 offen lds
    s_waitcnt vmcnt(28)
    ds_read_b64_tr_b16 a[208:209], v21 offset:20480
    ds_read_b64_tr_b16 a[210:211], v21 offset:20736
    ds_read_b64_tr_b16 a[212:213], v21 offset:21504
    ds_read_b64_tr_b16 a[214:215], v21 offset:21760
    ds_read_b64_tr_b16 a[216:217], v21 offset:22528
    ds_read_b64_tr_b16 a[218:219], v21 offset:22784
    ds_read_b64_tr_b16 a[220:221], v21 offset:23552
    ds_read_b64_tr_b16 a[222:223], v21 offset:23808
    s_waitcnt lgkmcnt(0)
    s_add_u32 s50, s52, 2621440
    s_add_u32 m0, s51, 20480
    s_nop 0
    buffer_load_dwordx4 v20, s[20:23], s50 offen lds
    s_add_u32 s50, s52, 2752512
    s_add_u32 m0, s51, 21504
    s_nop 0
    buffer_load_dwordx4 v20, s[20:23], s50 offen lds
    s_add_u32 s50, s52, 2883584
    s_add_u32 m0, s51, 22528
    s_nop 0
    buffer_load_dwordx4 v20, s[20:23], s50 offen lds
    s_add_u32 s50, s52, 3014656
    s_add_u32 m0, s51, 23552
    s_nop 0
    buffer_load_dwordx4 v20, s[20:23], s50 offen lds
    s_waitcnt vmcnt(28)
    ds_read_b64_tr_b16 a[224:225], v21 offset:24576
    ds_read_b64_tr_b16 a[226:227], v21 offset:24832
    ds_read_b64_tr_b16 a[228:229], v21 offset:25600
    ds_read_b64_tr_b16 a[230:231], v21 offset:25856
    ds_read_b64_tr_b16 a[232:233], v21 offset:26624
    ds_read_b64_tr_b16 a[234:235], v21 offset:26880
    ds_read_b64_tr_b16 a[236:237], v21 offset:27648
    ds_read_b64_tr_b16 a[238:239], v21 offset:27904
    s_waitcnt lgkmcnt(0)
    s_add_u32 s50, s52, 3145728
    s_add_u32 m0, s51, 24576
    s_nop 0
    buffer_load_dwordx4 v20, s[20:23], s50 offen lds
    s_add_u32 s50, s52, 3276800
    s_add_u32 m0, s51, 25600
    s_nop 0
    buffer_load_dwordx4 v20, s[20:23], s50 offen lds
    s_add_u32 s50, s52, 3407872
    s_add_u32 m0, s51, 26624
    s_nop 0
    buffer_load_dwordx4 v20, s[20:23], s50 offen lds
    s_add_u32 s50, s52, 3538944
    s_add_u32 m0, s51, 27648
    s_nop 0
    buffer_load_dwordx4 v20, s[20:23], s50 offen lds
    s_waitcnt vmcnt(28)
    ds_read_b64_tr_b16 a[240:241], v21 offset:28672
    ds_read_b64_tr_b16 a[242:243], v21 offset:28928
    ds_read_b64_tr_b16 a[244:245], v21 offset:29696
    ds_read_b64_tr_b16 a[246:247], v21 offset:29952
    ds_read_b64_tr_b16 a[248:249], v21 offset:30720
    ds_read_b64_tr_b16 a[250:251], v21 offset:30976
    ds_read_b64_tr_b16 a[252:253], v21 offset:31744
    ds_read_b64_tr_b16 a[254:255], v21 offset:32000
    s_waitcnt lgkmcnt(0)
    s_add_u32 s50, s52, 3670016
    s_add_u32 m0, s51, 28672
    s_nop 0
    buffer_load_dwordx4 v20, s[20:23], s50 offen lds
    s_add_u32 s50, s52, 3801088
    s_add_u32 m0, s51, 29696
    s_nop 0
    buffer_load_dwordx4 v20, s[20:23], s50 offen lds
    s_add_u32 s50, s52, 3932160
    s_add_u32 m0, s51, 30720
    s_nop 0
    buffer_load_dwordx4 v20, s[20:23], s50 offen lds
    s_add_u32 s50, s52, 4063232
    s_add_u32 m0, s51, 31744
    s_nop 0
    buffer_load_dwordx4 v20, s[20:23], s50 offen lds
    s_waitcnt vmcnt(28)
    ds_read_b64_tr_b16 v[128:129], v21 offset:0
    ds_read_b64_tr_b16 v[130:131], v21 offset:256
    ds_read_b64_tr_b16 v[132:133], v21 offset:1024
    ds_read_b64_tr_b16 v[134:135], v21 offset:1280
    ds_read_b64_tr_b16 v[136:137], v21 offset:2048
    ds_read_b64_tr_b16 v[138:139], v21 offset:2304
    ds_read_b64_tr_b16 v[140:141], v21 offset:3072
    ds_read_b64_tr_b16 v[142:143], v21 offset:3328
    s_waitcnt lgkmcnt(0)
    s_add_u32 s50, s52, 0
    s_add_u32 m0, s51, 0
    s_nop 0
    buffer_load_dwordx4 v20, s[12:15], s50 offen lds
    s_add_u32 s50, s52, 131072
    s_add_u32 m0, s51, 1024
    s_nop 0
    buffer_load_dwordx4 v20, s[12:15], s50 offen lds
    s_add_u32 s50, s52, 262144
    s_add_u32 m0, s51, 2048
    s_nop 0
    buffer_load_dwordx4 v20, s[12:15], s50 offen lds
    s_add_u32 s50, s52, 393216
    s_add_u32 m0, s51, 3072
    s_nop 0
    buffer_load_dwordx4 v20, s[12:15], s50 offen lds
    s_waitcnt vmcnt(28)
    ds_read_b64_tr_b16 v[144:145], v21 offset:4096
    ds_read_b64_tr_b16 v[146:147], v21 offset:4352
    ds_read_b64_tr_b16 v[148:149], v21 offset:5120
    ds_read_b64_tr_b16 v[150:151], v21 offset:5376
    ds_read_b64_tr_b16 v[152:153], v21 offset:6144
    ds_read_b64_tr_b16 v[154:155], v21 offset:6400
    ds_read_b64_tr_b16 v[156:157], v21 offset:7168
    ds_read_b64_tr_b16 v[158:159], v21 offset:7424
    s_waitcnt lgkmcnt(0)
    s_add_u32 s50, s52, 524288
    s_add_u32 m0, s51, 4096
    s_nop 0
    buffer_load_dwordx4 v20, s[12:15], s50 offen lds
    s_add_u32 s50, s52, 655360
    s_add_u32 m0, s51, 5120
    s_nop 0
    buffer_load_dwordx4 v20, s[12:15], s50 offen lds
    s_add_u32 s50, s52, 786432
    s_add_u32 m0, s51, 6144
    s_nop 0
    buffer_load_dwordx4 v20, s[12:15], s50 offen lds
    s_add_u32 s50, s52, 917504
    s_add_u32 m0, s51, 7168
    s_nop 0
    buffer_load_dwordx4 v20, s[12:15], s50 offen lds
    s_waitcnt vmcnt(28)
    ds_read_b64_tr_b16 v[160:161], v21 offset:8192
    ds_read_b64_tr_b16 v[162:163], v21 offset:8448
    ds_read_b64_tr_b16 v[164:165], v21 offset:9216
    ds_read_b64_tr_b16 v[166:167], v21 offset:9472
    ds_read_b64_tr_b16 v[168:169], v21 offset:10240
    ds_read_b64_tr_b16 v[170:171], v21 offset:10496
    ds_read_b64_tr_b16 v[172:173], v21 offset:11264
    ds_read_b64_tr_b16 v[174:175], v21 offset:11520
    s_waitcnt lgkmcnt(0)
    s_add_u32 s50, s52, 1048576
    s_add_u32 m0, s51, 8192
    s_nop 0
    buffer_load_dwordx4 v20, s[12:15], s50 offen lds
    s_add_u32 s50, s52, 1179648
    s_add_u32 m0, s51, 9216
    s_nop 0
    buffer_load_dwordx4 v20, s[12:15], s50 offen lds
    s_add_u32 s50, s52, 1310720
    s_add_u32 m0, s51, 10240
    s_nop 0
    buffer_load_dwordx4 v20, s[12:15], s50 offen lds
    s_add_u32 s50, s52, 1441792
    s_add_u32 m0, s51, 11264
    s_nop 0
    buffer_load_dwordx4 v20, s[12:15], s50 offen lds
    s_waitcnt vmcnt(28)
    ds_read_b64_tr_b16 v[176:177], v21 offset:12288
    ds_read_b64_tr_b16 v[178:179], v21 offset:12544
    ds_read_b64_tr_b16 v[180:181], v21 offset:13312
    ds_read_b64_tr_b16 v[182:183], v21 offset:13568
    ds_read_b64_tr_b16 v[184:185], v21 offset:14336
    ds_read_b64_tr_b16 v[186:187], v21 offset:14592
    ds_read_b64_tr_b16 v[188:189], v21 offset:15360
    ds_read_b64_tr_b16 v[190:191], v21 offset:15616
    s_waitcnt lgkmcnt(0)
    s_add_u32 s50, s52, 1572864
    s_add_u32 m0, s51, 12288
    s_nop 0
    buffer_load_dwordx4 v20, s[12:15], s50 offen lds
    s_add_u32 s50, s52, 1703936
    s_add_u32 m0, s51, 13312
    s_nop 0
    buffer_load_dwordx4 v20, s[12:15], s50 offen lds
    s_add_u32 s50, s52, 1835008
    s_add_u32 m0, s51, 14336
    s_nop 0
    buffer_load_dwordx4 v20, s[12:15], s50 offen lds
    s_add_u32 s50, s52, 1966080
    s_add_u32 m0, s51, 15360
    s_nop 0
    buffer_load_dwordx4 v20, s[12:15], s50 offen lds
    s_waitcnt vmcnt(28)
    ds_read_b64_tr_b16 v[192:193], v21 offset:16384
    ds_read_b64_tr_b16 v[194:195], v21 offset:16640
    ds_read_b64_tr_b16 v[196:197], v21 offset:17408
    ds_read_b64_tr_b16 v[198:199], v21 offset:17664
    ds_read_b64_tr_b16 v[200:201], v21 offset:18432
    ds_read_b64_tr_b16 v[202:203], v21 offset:18688
    ds_read_b64_tr_b16 v[204:205], v21 offset:19456
    ds_read_b64_tr_b16 v[206:207], v21 offset:19712
    s_waitcnt lgkmcnt(0)
    s_add_u32 s50, s52, 2097152
    s_add_u32 m0, s51, 16384
    s_nop 0
    buffer_load_dwordx4 v20, s[12:15], s50 offen lds
    s_add_u32 s50, s52, 2228224
    s_add_u32 m0, s51, 17408
    s_nop 0
    buffer_load_dwordx4 v20, s[12:15], s50 offen lds
    s_add_u32 s50, s52, 2359296
    s_add_u32 m0, s51, 18432
    s_nop 0
    buffer_load_dwordx4 v20, s[12:15], s50 offen lds
    s_add_u32 s50, s52, 2490368
    s_add_u32 m0, s51, 19456
    s_nop 0
    buffer_load_dwordx4 v20, s[12:15], s50 offen lds
    s_waitcnt vmcnt(28)
    ds_read_b64_tr_b16 v[208:209], v21 offset:20480
    ds_read_b64_tr_b16 v[210:211], v21 offset:20736
    ds_read_b64_tr_b16 v[212:213], v21 offset:21504
    ds_read_b64_tr_b16 v[214:215], v21 offset:21760
    ds_read_b64_tr_b16 v[216:217], v21 offset:22528
    ds_read_b64_tr_b16 v[218:219], v21 offset:22784
    ds_read_b64_tr_b16 v[220:221], v21 offset:23552
    ds_read_b64_tr_b16 v[222:223], v21 offset:23808
    s_waitcnt lgkmcnt(0)
    s_add_u32 s50, s52, 2621440
    s_add_u32 m0, s51, 20480
    s_nop 0
    buffer_load_dwordx4 v20, s[12:15], s50 offen lds
    s_add_u32 s50, s52, 2752512
    s_add_u32 m0, s51, 21504
    s_nop 0
    buffer_load_dwordx4 v20, s[12:15], s50 offen lds
    s_add_u32 s50, s52, 2883584
    s_add_u32 m0, s51, 22528
    s_nop 0
    buffer_load_dwordx4 v20, s[12:15], s50 offen lds
    s_add_u32 s50, s52, 3014656
    s_add_u32 m0, s51, 23552
    s_nop 0
    buffer_load_dwordx4 v20, s[12:15], s50 offen lds
    s_waitcnt vmcnt(28)
    ds_read_b64_tr_b16 v[224:225], v21 offset:24576
    ds_read_b64_tr_b16 v[226:227], v21 offset:24832
    ds_read_b64_tr_b16 v[228:229], v21 offset:25600
    ds_read_b64_tr_b16 v[230:231], v21 offset:25856
    ds_read_b64_tr_b16 v[232:233], v21 offset:26624
    ds_read_b64_tr_b16 v[234:235], v21 offset:26880
    ds_read_b64_tr_b16 v[236:237], v21 offset:27648
    ds_read_b64_tr_b16 v[238:239], v21 offset:27904
    s_waitcnt lgkmcnt(0)
    s_add_u32 s50, s52, 3145728
    s_add_u32 m0, s51, 24576
    s_nop 0
    buffer_load_dwordx4 v20, s[12:15], s50 offen lds
    s_add_u32 s50, s52, 3276800
    s_add_u32 m0, s51, 25600
    s_nop 0
    buffer_load_dwordx4 v20, s[12:15], s50 offen lds
    s_add_u32 s50, s52, 3407872
    s_add_u32 m0, s51, 26624
    s_nop 0
    buffer_load_dwordx4 v20, s[12:15], s50 offen lds
    s_add_u32 s50, s52, 3538944
    s_add_u32 m0, s51, 27648
    s_nop 0
    buffer_load_dwordx4 v20, s[12:15], s50 offen lds
    s_waitcnt vmcnt(28)
    ds_read_b64_tr_b16 v[240:241], v21 offset:28672
    ds_read_b64_tr_b16 v[242:243], v21 offset:28928
    ds_read_b64_tr_b16 v[244:245], v21 offset:29696
    ds_read_b64_tr_b16 v[246:247], v21 offset:29952
    ds_read_b64_tr_b16 v[248:249], v21 offset:30720
    ds_read_b64_tr_b16 v[250:251], v21 offset:30976
    ds_read_b64_tr_b16 v[252:253], v21 offset:31744
    ds_read_b64_tr_b16 v[254:255], v21 offset:32000
    s_waitcnt lgkmcnt(0)
    s_add_u32 s50, s52, 3670016
    s_add_u32 m0, s51, 28672
    s_nop 0
    buffer_load_dwordx4 v20, s[12:15], s50 offen lds
    s_add_u32 s50, s52, 3801088
    s_add_u32 m0, s51, 29696
    s_nop 0
    buffer_load_dwordx4 v20, s[12:15], s50 offen lds
    s_add_u32 s50, s52, 3932160
    s_add_u32 m0, s51, 30720
    s_nop 0
    buffer_load_dwordx4 v20, s[12:15], s50 offen lds
    s_add_u32 s50, s52, 4063232
    s_add_u32 m0, s51, 31744
    s_nop 0
    buffer_load_dwordx4 v20, s[12:15], s50 offen lds
    s_waitcnt vmcnt(28)
    ds_read_b64_tr_b16 a[0:1], v21 offset:0
    ds_read_b64_tr_b16 a[2:3], v21 offset:256
    ds_read_b64_tr_b16 a[4:5], v21 offset:1024
    ds_read_b64_tr_b16 a[6:7], v21 offset:1280
    ds_read_b64_tr_b16 a[8:9], v21 offset:2048
    ds_read_b64_tr_b16 a[10:11], v21 offset:2304
    ds_read_b64_tr_b16 a[12:13], v21 offset:3072
    ds_read_b64_tr_b16 a[14:15], v21 offset:3328
    s_waitcnt lgkmcnt(0)
    s_waitcnt vmcnt(24)
    ds_read_b64_tr_b16 a[16:17], v21 offset:4096
    ds_read_b64_tr_b16 a[18:19], v21 offset:4352
    ds_read_b64_tr_b16 a[20:21], v21 offset:5120
    ds_read_b64_tr_b16 a[22:23], v21 offset:5376
    ds_read_b64_tr_b16 a[24:25], v21 offset:6144
    ds_read_b64_tr_b16 a[26:27], v21 offset:6400
    ds_read_b64_tr_b16 a[28:29], v21 offset:7168
    ds_read_b64_tr_b16 a[30:31], v21 offset:7424
    s_waitcnt lgkmcnt(0)
    s_waitcnt vmcnt(20)
    ds_read_b64_tr_b16 a[32:33], v21 offset:8192
    ds_read_b64_tr_b16 a[34:35], v21 offset:8448
    ds_read_b64_tr_b16 a[36:37], v21 offset:9216
    ds_read_b64_tr_b16 a[38:39], v21 offset:9472
    ds_read_b64_tr_b16 a[40:41], v21 offset:10240
    ds_read_b64_tr_b16 a[42:43], v21 offset:10496
    ds_read_b64_tr_b16 a[44:45], v21 offset:11264
    ds_read_b64_tr_b16 a[46:47], v21 offset:11520
    s_waitcnt lgkmcnt(0)
    s_waitcnt vmcnt(16)
    ds_read_b64_tr_b16 a[48:49], v21 offset:12288
    ds_read_b64_tr_b16 a[50:51], v21 offset:12544
    ds_read_b64_tr_b16 a[52:53], v21 offset:13312
    ds_read_b64_tr_b16 a[54:55], v21 offset:13568
    ds_read_b64_tr_b16 a[56:57], v21 offset:14336
    ds_read_b64_tr_b16 a[58:59], v21 offset:14592
    ds_read_b64_tr_b16 a[60:61], v21 offset:15360
    ds_read_b64_tr_b16 a[62:63], v21 offset:15616
    s_waitcnt lgkmcnt(0)
    s_waitcnt vmcnt(12)
    ds_read_b64_tr_b16 a[64:65], v21 offset:16384
    ds_read_b64_tr_b16 a[66:67], v21 offset:16640
    ds_read_b64_tr_b16 a[68:69], v21 offset:17408
    ds_read_b64_tr_b16 a[70:71], v21 offset:17664
    ds_read_b64_tr_b16 a[72:73], v21 offset:18432
    ds_read_b64_tr_b16 a[74:75], v21 offset:18688
    ds_read_b64_tr_b16 a[76:77], v21 offset:19456
    ds_read_b64_tr_b16 a[78:79], v21 offset:19712
    s_waitcnt lgkmcnt(0)
    s_waitcnt vmcnt(8)
    ds_read_b64_tr_b16 a[80:81], v21 offset:20480
    ds_read_b64_tr_b16 a[82:83], v21 offset:20736
    ds_read_b64_tr_b16 a[84:85], v21 offset:21504
    ds_read_b64_tr_b16 a[86:87], v21 offset:21760
    ds_read_b64_tr_b16 a[88:89], v21 offset:22528
    ds_read_b64_tr_b16 a[90:91], v21 offset:22784
    ds_read_b64_tr_b16 a[92:93], v21 offset:23552
    ds_read_b64_tr_b16 a[94:95], v21 offset:23808
    s_waitcnt lgkmcnt(0)
    s_waitcnt vmcnt(4)
    ds_read_b64_tr_b16 a[96:97], v21 offset:24576
    ds_read_b64_tr_b16 a[98:99], v21 offset:24832
    ds_read_b64_tr_b16 a[100:101], v21 offset:25600
    ds_read_b64_tr_b16 a[102:103], v21 offset:25856
    ds_read_b64_tr_b16 a[104:105], v21 offset:26624
    ds_read_b64_tr_b16 a[106:107], v21 offset:26880
    ds_read_b64_tr_b16 a[108:109], v21 offset:27648
    ds_read_b64_tr_b16 a[110:111], v21 offset:27904
    s_waitcnt lgkmcnt(0)
    s_waitcnt vmcnt(0)
    ds_read_b64_tr_b16 a[112:113], v21 offset:28672
    ds_read_b64_tr_b16 a[114:115], v21 offset:28928
    ds_read_b64_tr_b16 a[116:117], v21 offset:29696
    ds_read_b64_tr_b16 a[118:119], v21 offset:29952
    ds_read_b64_tr_b16 a[120:121], v21 offset:30720
    ds_read_b64_tr_b16 a[122:123], v21 offset:30976
    ds_read_b64_tr_b16 a[124:125], v21 offset:31744
    ds_read_b64_tr_b16 a[126:127], v21 offset:32000
    s_waitcnt lgkmcnt(0)
    v_and_b32 v13, 31, v0
    v_lshrrev_b32 v14, 5, v0
    v_and_b32 v15, 15, v0
    v_add_u32 v2, 0, v14
    v_xor_b32 v2, v2, v15
    v_lshlrev_b32 v2, 4, v2
    v_lshl_add_u32 v2, v13, 8, v2
    v_add_u32 v3, 2, v14
    v_xor_b32 v3, v3, v15
    v_lshlrev_b32 v3, 4, v3
    v_lshl_add_u32 v3, v13, 8, v3
    v_add_u32 v4, 4, v14
    v_xor_b32 v4, v4, v15
    v_lshlrev_b32 v4, 4, v4
    v_lshl_add_u32 v4, v13, 8, v4
    v_add_u32 v5, 6, v14
    v_xor_b32 v5, v5, v15
    v_lshlrev_b32 v5, 4, v5
    v_lshl_add_u32 v5, v13, 8, v5
    v_add_u32 v6, 8, v14
    v_xor_b32 v6, v6, v15
    v_lshlrev_b32 v6, 4, v6
    v_lshl_add_u32 v6, v13, 8, v6
    v_add_u32 v7, 10, v14
    v_xor_b32 v7, v7, v15
    v_lshlrev_b32 v7, 4, v7
    v_lshl_add_u32 v7, v13, 8, v7
    v_add_u32 v8, 12, v14
    v_xor_b32 v8, v8, v15
    v_lshlrev_b32 v8, 4, v8
    v_lshl_add_u32 v8, v13, 8, v8
    v_add_u32 v9, 14, v14
    v_xor_b32 v9, v9, v15
    v_lshlrev_b32 v9, 4, v9
    v_lshl_add_u32 v9, v13, 8, v9
    v_lshrrev_b32 v13, 4, v0
    v_add_u32 v13, 0, v13
    s_lshl_b32 s40, s30, 3
    v_add_u32 v14, s40, v13
    v_and_b32 v14, 15, v14
    v_xor_b32 v14, v14, v15
    v_lshlrev_b32 v14, 4, v14
    v_lshl_add_u32 v10, v13, 10, v14
    v_lshrrev_b32 v13, 4, v0
    v_add_u32 v13, 4, v13
    s_lshl_b32 s40, s30, 3
    v_add_u32 v14, s40, v13
    v_and_b32 v14, 15, v14
    v_xor_b32 v14, v14, v15
    v_lshlrev_b32 v14, 4, v14
    v_lshl_add_u32 v11, v13, 10, v14
    v_bfe_u32 v13, v0, 4, 1
    v_lshrrev_b32 v14, 5, v0
    v_and_b32 v15, 15, v0
    v_lshlrev_b32 v15, 4, v15
    v_lshl_add_u32 v15, v14, 8, v15
    v_lshl_add_u32 v12, v13, 12, v15
    v_lshl_add_u32 v1, v13, 10, v15
    v_mov_b32 v104, 0
    s_cmp_eq_u32 s30, 0
    s_cbranch_scc0 winitb_24
    v_mov_b32 v14, 64
    s_nop 1
wd_25:
    buffer_load_dword v13, v14, s[8:11], 0 offen sc1
    s_waitcnt vmcnt(0)
    v_cmp_le_u32 vcc, 0x80, v13
    s_nop 3
    s_cbranch_vccnz wdd_26
    s_add_u32 s31, s31, 1
    s_cmp_gt_u32 s31, 300000
    s_cbranch_scc1 wdd_26
    s_sleep 6
    s_branch wd_25
wdd_26:
winitb_24:
    s_barrier
    s_barrier
    s_mov_b32 s60, 0
    s_mov_b32 s81, 0
    s_mov_b32 s78, 5505024
    s_mov_b64 s[86:87], 0
    s_mov_b32 s61, 0
    s_cmp_eq_u32 s30, 0
    s_cselect_b32 s74, 1, 0
    s_mov_b32 s73, 0
    s_cmp_eq_u32 s30, 0
    s_cbranch_scc0 s1bp_32
    s_mul_i32 s40, s34, 2
    s_add_u32 s40, s40, s32
    s_min_u32 s40, s40, 63
    s_mul_i32 s40, s40, 6144
    s_add_u32 s65, s40, 5376
    s_mul_i32 s40, s35, 2
    s_add_u32 s40, s40, s32
    s_min_u32 s40, s40, 63
    s_add_u32 s40, s40, 64
    s_mul_i32 s40, s40, 6144
    s_add_u32 s66, s40, 5376
s1bpl_33:
    buffer_load_dword v105, v104, s[4:7], s65 offen sc1
    buffer_load_dword v106, v104, s[4:7], s66 offen sc1
    s_waitcnt vmcnt(0)
    v_readfirstlane_b32 s40, v105
    v_readfirstlane_b32 s41, v106
    s_nop 2
    s_cmp_ge_u32 s40, 8
    s_cselect_b32 s40, 1, 0
    s_cmp_lt_u32 s34, s38
    s_cselect_b32 s40, s40, 0
    s_cmp_ge_u32 s41, 8
    s_cselect_b32 s41, 2, 0
    s_cmp_lt_u32 s35, s38
    s_cselect_b32 s41, s41, 0
    s_cmp_lg_u32 s41, 0
    s_cselect_b32 s67, s41, s40
    s_add_u32 s42, s34, s35
    s_lshl_b32 s43, s38, 1
    s_cmp_ge_u32 s42, s43
    s_cselect_b32 s67, 3, s67
    s_cmp_lg_u32 s67, 0
    s_cbranch_scc1 s1bpd_34
    s_add_u32 s31, s31, 1
    s_cmp_gt_u32 s31, 300000
    s_cselect_b32 s67, 3, 0
    s_cbranch_scc1 s1bpd_34
    s_sleep 1
    s_branch s1bpl_33
s1bpd_34:
    v_mov_b32 v13, 163792
    v_mov_b32 v14, s67
    ds_write_b32 v13, v14
    s_waitcnt lgkmcnt(0)
s1bp_32:
    s_barrier
    v_mov_b32 v13, 163792
    ds_read_b32 v14, v13
    s_waitcnt lgkmcnt(0)
    v_readfirstlane_b32 s67, v14
    s_nop 3
    s_cmp_eq_u32 s67, 3
    s_cbranch_scc1 s1fin_31
    s_sub_u32 s36, s67, 1
    s_cmp_eq_u32 s36, 0
    s_cselect_b32 s40, s34, s35
    s_mul_i32 s37, s40, 2
    s_add_u32 s37, s37, s32
    s_xor_b32 s40, s36, 1
    s_add_u32 s34, s34, s40
    s_add_u32 s35, s35, s36
    s_lshl_b32 s40, s36, 6
    s_add_u32 s40, s40, s37
    s_mul_i32 s47, s40, 6144
    s_mul_i32 s71, s37, 32768
    s_add_u32 s71, s71, 126877696
    s_lshl_b32 s77, s30, 13
    s_add_u32 s77, s77, s71
    s_lshl_b32 s76, s30, 11
    s_add_u32 s76, s76, s61
    s_add_u32 m0, s76, 0
    s_nop 0
    buffer_load_dwordx4 v10, s[4:7], s77 offen sc1 lds
    s_add_u32 m0, s76, 1024
    s_nop 0
    buffer_load_dwordx4 v11, s[4:7], s77 offen sc1 lds
    s_add_u32 s77, s77, 256
    s_add_u32 m0, s76, 8192
    s_nop 0
    buffer_load_dwordx4 v10, s[4:7], s77 offen sc1 lds
    s_add_u32 m0, s76, 9216
    s_nop 0
    buffer_load_dwordx4 v11, s[4:7], s77 offen sc1 lds
    s_add_u32 s77, s77, 256
    s_add_u32 m0, s76, 16384
    s_nop 0
    buffer_load_dwordx4 v10, s[4:7], s77 offen sc1 lds
    s_add_u32 m0, s76, 17408
    s_nop 0
    buffer_load_dwordx4 v11, s[4:7], s77 offen sc1 lds
    s_add_u32 s77, s77, 256
    s_add_u32 m0, s76, 24576
    s_nop 0
    buffer_load_dwordx4 v10, s[4:7], s77 offen sc1 lds
    s_add_u32 m0, s76, 25600
    s_nop 0
    buffer_load_dwordx4 v11, s[4:7], s77 offen sc1 lds
    s_mul_i32 s40, s34, 2
    s_add_u32 s40, s40, s32
    s_min_u32 s40, s40, 63
    s_mul_i32 s40, s40, 6144
    s_add_u32 s65, s40, 5376
    s_mul_i32 s40, s35, 2
    s_add_u32 s40, s40, s32
    s_min_u32 s40, s40, 63
    s_add_u32 s40, s40, 64
    s_mul_i32 s40, s40, 6144
    s_add_u32 s66, s40, 5376
    buffer_load_dword v105, v104, s[4:7], s65 offen sc1
    buffer_load_dword v106, v104, s[4:7], s66 offen sc1
    s_mov_b32 s83, 0
s1job_27:
    s_cmp_eq_u32 s83, 2
    s_cbranch_scc1 s1w2_29
    s_cmp_eq_u32 s83, 0
    s_cbranch_scc1 s1w_28
    s_waitcnt vmcnt(0)
    s_branch s1w2_29
s1w_28:
    s_waitcnt vmcnt(0)
s1w2_29:
    s_barrier
    ds_read_b128 v[64:67], v2 offset:0
    ds_read_b128 v[68:71], v3 offset:0
    ds_read_b128 v[72:75], v4 offset:0
    s_waitcnt lgkmcnt(2)
    v_mfma_f32_32x32x16_bf16 v[32:47], a[128:131], v[64:67], 0
    ds_read_b128 v[76:79], v5 offset:0
    v_mfma_f32_32x32x16_bf16 v[48:63], v[64:67], v[128:131], 0
    s_lshl_b32 s82, s30, 10
    s_add_u32 s79, s78, s82
    s_add_u32 s79, s79, 8192
    s_mov_b64 exec, s[86:87]
    buffer_store_dwordx4 v[80:83], v12, s[4:7], s79 offen offset:0 sc1
    s_mov_b64 exec, -1
    v_mfma_f32_32x32x16_bf16 v[16:31], a[0:3], v[64:67], 0
    s_mov_b64 exec, s[86:87]
    buffer_store_dwordx4 v[84:87], v12, s[4:7], s79 offen offset:512 sc1
    s_mov_b64 exec, -1
    s_waitcnt lgkmcnt(2)
    v_mfma_f32_32x32x16_bf16 v[32:47], a[132:135], v[68:71], v[32:47]
    ds_read_b128 v[64:67], v6 offset:0
    s_add_u32 s79, s79, s82
    s_add_u32 s79, s79, 8192
    s_mov_b64 exec, s[86:87]
    buffer_store_dwordx4 v[96:99], v1, s[4:7], s79 offen offset:0 sc1
    s_mov_b64 exec, -1
    v_mfma_f32_32x32x16_bf16 v[48:63], v[68:71], v[132:135], v[48:63]
    s_mov_b64 exec, s[86:87]
    buffer_store_dwordx4 v[100:103], v1, s[4:7], s79 offen offset:512 sc1
    s_mov_b64 exec, -1
    v_mfma_f32_32x32x16_bf16 v[16:31], a[4:7], v[68:71], v[16:31]
    s_add_u32 s79, s78, s82
    s_mov_b64 exec, s[86:87]
    buffer_store_dwordx4 v[88:91], v12, s[4:7], s79 offen offset:0 sc1
    s_mov_b64 exec, -1
    s_waitcnt lgkmcnt(2)
    v_mfma_f32_32x32x16_bf16 v[32:47], a[136:139], v[72:75], v[32:47]
    ds_read_b128 v[68:71], v7 offset:0
    s_mov_b64 exec, s[86:87]
    buffer_store_dwordx4 v[92:95], v12, s[4:7], s79 offen offset:512 sc1
    s_mov_b64 exec, -1
    v_mfma_f32_32x32x16_bf16 v[48:63], v[72:75], v[136:139], v[48:63]
    v_mfma_f32_32x32x16_bf16 v[16:31], a[8:11], v[72:75], v[16:31]
    s_waitcnt lgkmcnt(2)
    v_mfma_f32_32x32x16_bf16 v[32:47], a[140:143], v[76:79], v[32:47]
    ds_read_b128 v[72:75], v8 offset:0
    v_mfma_f32_32x32x16_bf16 v[48:63], v[76:79], v[140:143], v[48:63]
    v_mfma_f32_32x32x16_bf16 v[16:31], a[12:15], v[76:79], v[16:31]
    s_waitcnt lgkmcnt(2)
    v_mfma_f32_32x32x16_bf16 v[32:47], a[144:147], v[64:67], v[32:47]
    ds_read_b128 v[76:79], v9 offset:0
    v_mfma_f32_32x32x16_bf16 v[48:63], v[64:67], v[144:147], v[48:63]
    v_mfma_f32_32x32x16_bf16 v[16:31], a[16:19], v[64:67], v[16:31]
    s_waitcnt lgkmcnt(2)
    v_mfma_f32_32x32x16_bf16 v[32:47], a[148:151], v[68:71], v[32:47]
    ds_read_b128 v[64:67], v2 offset:8192
    v_mfma_f32_32x32x16_bf16 v[48:63], v[68:71], v[148:151], v[48:63]
    v_mfma_f32_32x32x16_bf16 v[16:31], a[20:23], v[68:71], v[16:31]
    s_waitcnt lgkmcnt(2)
    v_mfma_f32_32x32x16_bf16 v[32:47], a[152:155], v[72:75], v[32:47]
    ds_read_b128 v[68:71], v3 offset:8192
    v_mfma_f32_32x32x16_bf16 v[48:63], v[72:75], v[152:155], v[48:63]
    v_mfma_f32_32x32x16_bf16 v[16:31], a[24:27], v[72:75], v[16:31]
    s_waitcnt lgkmcnt(2)
    v_mfma_f32_32x32x16_bf16 v[32:47], a[156:159], v[76:79], v[32:47]
    ds_read_b128 v[72:75], v4 offset:8192
    v_mfma_f32_32x32x16_bf16 v[48:63], v[76:79], v[156:159], v[48:63]
    v_mfma_f32_32x32x16_bf16 v[16:31], a[28:31], v[76:79], v[16:31]
    s_waitcnt lgkmcnt(2)
    v_mfma_f32_32x32x16_bf16 v[32:47], a[160:163], v[64:67], v[32:47]
    ds_read_b128 v[76:79], v5 offset:8192
    v_mfma_f32_32x32x16_bf16 v[48:63], v[64:67], v[160:163], v[48:63]
    v_mfma_f32_32x32x16_bf16 v[16:31], a[32:35], v[64:67], v[16:31]
    s_mul_i32 s40, s34, 2
    s_add_u32 s40, s40, s32
    s_min_u32 s40, s40, 63
    s_mul_i32 s40, s40, 6144
    s_waitcnt lgkmcnt(2)
    v_mfma_f32_32x32x16_bf16 v[32:47], a[164:167], v[68:71], v[32:47]
    ds_read_b128 v[64:67], v6 offset:8192
    s_add_u32 s65, s40, 5376
    s_mul_i32 s40, s35, 2
    s_add_u32 s40, s40, s32
    s_min_u32 s40, s40, 63
    v_mfma_f32_32x32x16_bf16 v[48:63], v[68:71], v[164:167], v[48:63]
    s_add_u32 s40, s40, 64
    s_mul_i32 s40, s40, 6144
    s_add_u32 s66, s40, 5376
    v_mfma_f32_32x32x16_bf16 v[16:31], a[36:39], v[68:71], v[16:31]
    buffer_load_dword v105, v104, s[4:7], s65 offen sc1
    buffer_load_dword v106, v104, s[4:7], s66 offen sc1
    s_waitcnt lgkmcnt(2)
    v_mfma_f32_32x32x16_bf16 v[32:47], a[168:171], v[72:75], v[32:47]
    ds_read_b128 v[68:71], v7 offset:8192
    v_mfma_f32_32x32x16_bf16 v[48:63], v[72:75], v[168:171], v[48:63]
    v_mfma_f32_32x32x16_bf16 v[16:31], a[40:43], v[72:75], v[16:31]
    s_waitcnt lgkmcnt(2)
    v_mfma_f32_32x32x16_bf16 v[32:47], a[172:175], v[76:79], v[32:47]
    ds_read_b128 v[72:75], v8 offset:8192
    v_mfma_f32_32x32x16_bf16 v[48:63], v[76:79], v[172:175], v[48:63]
    v_mfma_f32_32x32x16_bf16 v[16:31], a[44:47], v[76:79], v[16:31]
    s_waitcnt lgkmcnt(2)
    v_mfma_f32_32x32x16_bf16 v[32:47], a[176:179], v[64:67], v[32:47]
    ds_read_b128 v[76:79], v9 offset:8192
    v_mfma_f32_32x32x16_bf16 v[48:63], v[64:67], v[176:179], v[48:63]
    v_mfma_f32_32x32x16_bf16 v[16:31], a[48:51], v[64:67], v[16:31]
    s_waitcnt lgkmcnt(2)
    v_mfma_f32_32x32x16_bf16 v[32:47], a[180:183], v[68:71], v[32:47]
    ds_read_b128 v[64:67], v2 offset:16384
    v_mfma_f32_32x32x16_bf16 v[48:63], v[68:71], v[180:183], v[48:63]
    v_mfma_f32_32x32x16_bf16 v[16:31], a[52:55], v[68:71], v[16:31]
    s_waitcnt lgkmcnt(2)
    v_mfma_f32_32x32x16_bf16 v[32:47], a[184:187], v[72:75], v[32:47]
    ds_read_b128 v[68:71], v3 offset:16384
    v_mfma_f32_32x32x16_bf16 v[48:63], v[72:75], v[184:187], v[48:63]
    v_mfma_f32_32x32x16_bf16 v[16:31], a[56:59], v[72:75], v[16:31]
    s_waitcnt lgkmcnt(2)
    v_mfma_f32_32x32x16_bf16 v[32:47], a[188:191], v[76:79], v[32:47]
    ds_read_b128 v[72:75], v4 offset:16384
    v_mfma_f32_32x32x16_bf16 v[48:63], v[76:79], v[188:191], v[48:63]
    v_mfma_f32_32x32x16_bf16 v[16:31], a[60:63], v[76:79], v[16:31]
    s_waitcnt lgkmcnt(2)
    v_mfma_f32_32x32x16_bf16 v[32:47], a[192:195], v[64:67], v[32:47]
    ds_read_b128 v[76:79], v5 offset:16384
    v_mfma_f32_32x32x16_bf16 v[48:63], v[64:67], v[192:195], v[48:63]
    v_mfma_f32_32x32x16_bf16 v[16:31], a[64:67], v[64:67], v[16:31]
    s_waitcnt lgkmcnt(2)
    v_mfma_f32_32x32x16_bf16 v[32:47], a[196:199], v[68:71], v[32:47]
    ds_read_b128 v[64:67], v6 offset:16384
    v_mfma_f32_32x32x16_bf16 v[48:63], v[68:71], v[196:199], v[48:63]
    s_waitcnt vmcnt(0)
    v_readfirstlane_b32 s40, v105
    v_readfirstlane_b32 s41, v106
    v_mfma_f32_32x32x16_bf16 v[16:31], a[68:71], v[68:71], v[16:31]
    s_nop 1
    s_cmp_ge_u32 s40, 8
    s_cselect_b32 s40, 1, 0
    s_cmp_lt_u32 s34, s38
    s_cselect_b32 s40, s40, 0
    s_waitcnt lgkmcnt(2)
    v_mfma_f32_32x32x16_bf16 v[32:47], a[200:203], v[72:75], v[32:47]
    ds_read_b128 v[68:71], v7 offset:16384
    s_cmp_ge_u32 s41, 8
    s_cselect_b32 s41, 2, 0
    s_cmp_lt_u32 s35, s38
    s_cselect_b32 s41, s41, 0
    v_mfma_f32_32x32x16_bf16 v[48:63], v[72:75], v[200:203], v[48:63]
    s_cmp_lg_u32 s41, 0
    s_cselect_b32 s67, s41, s40
    s_add_u32 s42, s34, s35
    s_lshl_b32 s43, s38, 1
    v_mfma_f32_32x32x16_bf16 v[16:31], a[72:75], v[72:75], v[16:31]
    s_cmp_ge_u32 s42, s43
    s_cselect_b32 s67, 3, s67
    s_waitcnt lgkmcnt(2)
    v_mfma_f32_32x32x16_bf16 v[32:47], a[204:207], v[76:79], v[32:47]
    ds_read_b128 v[72:75], v8 offset:16384
    s_lshl_b32 s40, s30, 2
    s_add_u32 s40, s40, 163792
    v_mov_b32 v13, s40
    v_mov_b32 v14, s67
    v_mfma_f32_32x32x16_bf16 v[48:63], v[76:79], v[204:207], v[48:63]
    ds_write_b32 v13, v14
    v_mfma_f32_32x32x16_bf16 v[16:31], a[76:79], v[76:79], v[16:31]
    s_waitcnt lgkmcnt(3)
    v_mfma_f32_32x32x16_bf16 v[32:47], a[208:211], v[64:67], v[32:47]
    ds_read_b128 v[76:79], v9 offset:16384
    s_waitcnt lgkmcnt(1)
    s_barrier
    v_mov_b32 v13, 163792
    v_mfma_f32_32x32x16_bf16 v[48:63], v[64:67], v[208:211], v[48:63]
    s_cmp_lg_u32 s60, 0
    s_cselect_b32 s72, s74, 0
    v_mov_b32 v14, 1
    v_mfma_f32_32x32x16_bf16 v[16:31], a[80:83], v[64:67], v[16:31]
    s_mov_b64 exec, s[72:73]
    buffer_atomic_add v14, v104, s[4:7], s60 offen
    s_mov_b64 exec, -1
    s_mov_b32 s60, 0
    s_waitcnt lgkmcnt(3)
    v_mfma_f32_32x32x16_bf16 v[32:47], a[212:215], v[68:71], v[32:47]
    ds_read_b128 v[64:67], v2 offset:24576
    ds_read_b32 v105, v13
    v_mfma_f32_32x32x16_bf16 v[48:63], v[68:71], v[212:215], v[48:63]
    v_mfma_f32_32x32x16_bf16 v[16:31], a[84:87], v[68:71], v[16:31]
    s_waitcnt lgkmcnt(0)
    v_readfirstlane_b32 s67, v105
    s_waitcnt lgkmcnt(4)
    v_mfma_f32_32x32x16_bf16 v[32:47], a[216:219], v[72:75], v[32:47]
    ds_read_b128 v[68:71], v3 offset:24576
    s_nop 0
    s_sub_u32 s40, s67, 1
    s_cmp_lt_u32 s40, 2
    s_cselect_b32 s62, 1, 0
    s_cselect_b32 s56, s40, 0
    v_mfma_f32_32x32x16_bf16 v[48:63], v[72:75], v[216:219], v[48:63]
    s_cmp_eq_u32 s56, 0
    s_cselect_b32 s40, s34, s35
    s_mul_i32 s57, s40, 2
    s_add_u32 s57, s57, s32
    v_mfma_f32_32x32x16_bf16 v[16:31], a[88:91], v[72:75], v[16:31]
    s_min_u32 s57, s57, 63
    s_xor_b32 s40, s56, 1
    s_and_b32 s40, s40, s62
    s_add_u32 s34, s34, s40
    s_waitcnt lgkmcnt(3)
    v_mfma_f32_32x32x16_bf16 v[32:47], a[220:223], v[76:79], v[32:47]
    ds_read_b128 v[72:75], v4 offset:24576
    s_and_b32 s40, s56, s62
    s_add_u32 s35, s35, s40
    s_lshl_b32 s40, s56, 6
    s_add_u32 s40, s40, s57
    v_mfma_f32_32x32x16_bf16 v[48:63], v[76:79], v[220:223], v[48:63]
    s_mul_i32 s58, s40, 6144
    s_xor_b32 s68, s61, 32768
    s_mul_i32 s64, s57, 32768
    s_add_u32 s64, s64, 126877696
    v_mfma_f32_32x32x16_bf16 v[16:31], a[92:95], v[76:79], v[16:31]
    s_cmp_eq_u32 s62, 1
    s_cselect_b32 s64, s64, s71
    s_cselect_b64 s[84:85], -1, 0
    s_mov_b32 s75, s64
    s_waitcnt lgkmcnt(3)
    v_mfma_f32_32x32x16_bf16 v[32:47], a[224:227], v[64:67], v[32:47]
    ds_read_b128 v[76:79], v5 offset:24576
    s_lshl_b32 s77, s30, 13
    s_add_u32 s77, s77, s64
    s_lshl_b32 s76, s30, 11
    s_add_u32 s76, s76, s68
    v_mfma_f32_32x32x16_bf16 v[48:63], v[64:67], v[224:227], v[48:63]
    s_add_u32 m0, s76, 0
    s_mov_b64 exec, s[84:85]
    buffer_load_dwordx4 v10, s[4:7], s77 offen sc1 lds
    s_mov_b64 exec, -1
    v_mfma_f32_32x32x16_bf16 v[16:31], a[96:99], v[64:67], v[16:31]
    s_add_u32 m0, s76, 1024
    s_mov_b64 exec, s[84:85]
    buffer_load_dwordx4 v11, s[4:7], s77 offen sc1 lds
    s_mov_b64 exec, -1
    s_add_u32 s77, s77, 256
    s_waitcnt lgkmcnt(2)
    v_mfma_f32_32x32x16_bf16 v[32:47], a[228:231], v[68:71], v[32:47]
    ds_read_b128 v[64:67], v6 offset:24576
    s_add_u32 m0, s76, 8192
    s_mov_b64 exec, s[84:85]
    buffer_load_dwordx4 v10, s[4:7], s77 offen sc1 lds
    s_mov_b64 exec, -1
    v_mfma_f32_32x32x16_bf16 v[48:63], v[68:71], v[228:231], v[48:63]
    s_add_u32 m0, s76, 9216
    s_mov_b64 exec, s[84:85]
    buffer_load_dwordx4 v11, s[4:7], s77 offen sc1 lds
    s_mov_b64 exec, -1
    s_add_u32 s77, s77, 256
    v_mfma_f32_32x32x16_bf16 v[16:31], a[100:103], v[68:71], v[16:31]
    s_add_u32 m0, s76, 16384
    s_mov_b64 exec, s[84:85]
    buffer_load_dwordx4 v10, s[4:7], s77 offen sc1 lds
    s_mov_b64 exec, -1
    s_waitcnt lgkmcnt(2)
    v_mfma_f32_32x32x16_bf16 v[32:47], a[232:235], v[72:75], v[32:47]
    ds_read_b128 v[68:71], v7 offset:24576
    s_add_u32 m0, s76, 17408
    s_mov_b64 exec, s[84:85]
    buffer_load_dwordx4 v11, s[4:7], s77 offen sc1 lds
    s_mov_b64 exec, -1
    s_add_u32 s77, s77, 256
    v_mfma_f32_32x32x16_bf16 v[48:63], v[72:75], v[232:235], v[48:63]
    s_add_u32 m0, s76, 24576
    s_mov_b64 exec, s[84:85]
    buffer_load_dwordx4 v10, s[4:7], s77 offen sc1 lds
    s_mov_b64 exec, -1
    v_mfma_f32_32x32x16_bf16 v[16:31], a[104:107], v[72:75], v[16:31]
    s_add_u32 m0, s76, 25600
    s_mov_b64 exec, s[84:85]
    buffer_load_dwordx4 v11, s[4:7], s77 offen sc1 lds
    s_mov_b64 exec, -1
    s_waitcnt lgkmcnt(2)
    v_mfma_f32_32x32x16_bf16 v[32:47], a[236:239], v[76:79], v[32:47]
    ds_read_b128 v[72:75], v8 offset:24576
    v_mfma_f32_32x32x16_bf16 v[48:63], v[76:79], v[236:239], v[48:63]
    v_mfma_f32_32x32x16_bf16 v[16:31], a[108:111], v[76:79], v[16:31]
    s_waitcnt lgkmcnt(2)
    v_mfma_f32_32x32x16_bf16 v[32:47], a[240:243], v[64:67], v[32:47]
    ds_read_b128 v[76:79], v9 offset:24576
    v_mfma_f32_32x32x16_bf16 v[48:63], v[64:67], v[240:243], v[48:63]
    v_mfma_f32_32x32x16_bf16 v[16:31], a[112:115], v[64:67], v[16:31]
    s_waitcnt lgkmcnt(2)
    v_mfma_f32_32x32x16_bf16 v[32:47], a[244:247], v[68:71], v[32:47]
    v_mfma_f32_32x32x16_bf16 v[48:63], v[68:71], v[244:247], v[48:63]
    v_mfma_f32_32x32x16_bf16 v[16:31], a[116:119], v[68:71], v[16:31]
    s_waitcnt lgkmcnt(1)
    v_mfma_f32_32x32x16_bf16 v[32:47], a[248:251], v[72:75], v[32:47]
    v_mfma_f32_32x32x16_bf16 v[48:63], v[72:75], v[248:251], v[48:63]
    v_mfma_f32_32x32x16_bf16 v[16:31], a[120:123], v[72:75], v[16:31]
    s_waitcnt lgkmcnt(0)
    v_mfma_f32_32x32x16_bf16 v[32:47], a[252:255], v[76:79], v[32:47]
    v_mfma_f32_32x32x16_bf16 v[48:63], v[76:79], v[252:255], v[48:63]
    s_mul_i32 s80, s37, 786432
    s_add_u32 s80, s80, 6291456
    s_mul_i32 s44, s33, 24576
    s_add_u32 s80, s80, s44
    v_mfma_f32_32x32x16_bf16 v[16:31], a[124:127], v[76:79], v[16:31]
    s_nop 5
    v_cvt_pk_bf16_f32 v80, v32, v33
    v_cvt_pk_bf16_f32 v81, v34, v35
    v_cvt_pk_bf16_f32 v82, v36, v37
    v_cvt_pk_bf16_f32 v83, v38, v39
    v_cvt_pk_bf16_f32 v84, v40, v41
    v_cvt_pk_bf16_f32 v85, v42, v43
    v_cvt_pk_bf16_f32 v86, v44, v45
    v_cvt_pk_bf16_f32 v87, v46, v47
    v_cvt_pk_bf16_f32 v88, v16, v17
    v_cvt_pk_bf16_f32 v89, v18, v19
    v_cvt_pk_bf16_f32 v90, v20, v21
    v_cvt_pk_bf16_f32 v91, v22, v23
    v_cvt_pk_bf16_f32 v92, v24, v25
    v_cvt_pk_bf16_f32 v93, v26, v27
    v_cvt_pk_bf16_f32 v94, v28, v29
    v_cvt_pk_bf16_f32 v95, v30, v31
    v_cvt_pk_bf16_f32 v96, v48, v49
    v_cvt_pk_bf16_f32 v97, v50, v51
    v_cvt_pk_bf16_f32 v98, v56, v57
    v_cvt_pk_bf16_f32 v99, v58, v59
    v_cvt_pk_bf16_f32 v100, v52, v53
    v_cvt_pk_bf16_f32 v101, v54, v55
    v_cvt_pk_bf16_f32 v102, v60, v61
    v_cvt_pk_bf16_f32 v103, v62, v63
    s_lshl_b32 s43, s33, 7
    s_add_u32 s43, s43, s47
    s_add_u32 s43, s43, 128
    s_mov_b32 s60, s43
    s_mov_b32 s78, s80
    s_mov_b64 s[86:87], -1
    s_cmp_eq_u32 s36, 0
    s_cselect_b32 s40, s62, 0
    s_mov_b32 s83, 1
    s_cmp_eq_u32 s40, 0
    s_cbranch_scc0 s1nx_30
    s_lshl_b32 s82, s30, 10
    s_add_u32 s79, s78, s82
    s_add_u32 s79, s79, 8192
    buffer_store_dwordx4 v[80:83], v12, s[4:7], s79 offen offset:0 sc1
    buffer_store_dwordx4 v[84:87], v12, s[4:7], s79 offen offset:512 sc1
    s_add_u32 s79, s79, s82
    s_add_u32 s79, s79, 8192
    buffer_store_dwordx4 v[96:99], v1, s[4:7], s79 offen offset:0 sc1
    buffer_store_dwordx4 v[100:103], v1, s[4:7], s79 offen offset:512 sc1
    s_add_u32 s79, s78, s82
    buffer_store_dwordx4 v[88:91], v12, s[4:7], s79 offen offset:0 sc1
    buffer_store_dwordx4 v[92:95], v12, s[4:7], s79 offen offset:512 sc1
    s_mul_i32 s40, s34, 2
    s_add_u32 s40, s40, s32
    s_min_u32 s40, s40, 63
    s_mul_i32 s40, s40, 6144
    s_add_u32 s65, s40, 5376
    s_mul_i32 s40, s35, 2
    s_add_u32 s40, s40, s32
    s_min_u32 s40, s40, 63
    s_add_u32 s40, s40, 64
    s_mul_i32 s40, s40, 6144
    s_add_u32 s66, s40, 5376
    buffer_load_dword v105, v104, s[4:7], s65 offen sc1
    buffer_load_dword v106, v104, s[4:7], s66 offen sc1
    s_waitcnt vmcnt(2)
    s_barrier
    s_cmp_lg_u32 s60, 0
    s_cselect_b32 s72, s74, 0
    v_mov_b32 v14, 1
    s_mov_b64 exec, s[72:73]
    buffer_atomic_add v14, v104, s[4:7], s60 offen
    s_mov_b64 exec, -1
    s_mov_b32 s60, 0
    s_mov_b32 s78, 5505024
    s_mov_b64 s[86:87], 0
    s_mov_b32 s83, 2
    s_cmp_eq_u32 s62, 0
    s_cbranch_scc0 s1nx_30
    s_mov_b32 s83, 0
    s_cmp_eq_u32 s30, 0
    s_cbranch_scc0 s1q_36
    s_waitcnt vmcnt(1)
    v_readfirstlane_b32 s40, v105
    v_readfirstlane_b32 s41, v106
    s_nop 2
    s_cmp_ge_u32 s40, 8
    s_cselect_b32 s40, 1, 0
    s_cmp_lt_u32 s34, s38
    s_cselect_b32 s40, s40, 0
    s_cmp_ge_u32 s41, 8
    s_cselect_b32 s41, 2, 0
    s_cmp_lt_u32 s35, s38
    s_cselect_b32 s41, s41, 0
    s_cmp_lg_u32 s41, 0
    s_cselect_b32 s67, s41, s40
    s_add_u32 s42, s34, s35
    s_lshl_b32 s43, s38, 1
    s_cmp_ge_u32 s42, s43
    s_cselect_b32 s67, 3, s67
    v_mov_b32 v13, 163792
    v_mov_b32 v14, s67
    ds_write_b32 v13, v14
    s_waitcnt lgkmcnt(0)
s1q_36:
    s_barrier
    v_mov_b32 v13, 163792
    ds_read_b32 v14, v13
    s_waitcnt lgkmcnt(0)
    v_readfirstlane_b32 s67, v14
    s_nop 3
    s_cmp_lg_u32 s67, 0
    s_cbranch_scc1 s1q2_37
    s_barrier
    s_cmp_eq_u32 s30, 0
    s_cbranch_scc0 s1bp_38
    s_mul_i32 s40, s34, 2
    s_add_u32 s40, s40, s32
    s_min_u32 s40, s40, 63
    s_mul_i32 s40, s40, 6144
    s_add_u32 s65, s40, 5376
    s_mul_i32 s40, s35, 2
    s_add_u32 s40, s40, s32
    s_min_u32 s40, s40, 63
    s_add_u32 s40, s40, 64
    s_mul_i32 s40, s40, 6144
    s_add_u32 s66, s40, 5376
s1bpl_39:
    buffer_load_dword v105, v104, s[4:7], s65 offen sc1
    buffer_load_dword v106, v104, s[4:7], s66 offen sc1
    s_waitcnt vmcnt(0)
    v_readfirstlane_b32 s40, v105
    v_readfirstlane_b32 s41, v106
    s_nop 2
    s_cmp_ge_u32 s40, 8
    s_cselect_b32 s40, 1, 0
    s_cmp_lt_u32 s34, s38
    s_cselect_b32 s40, s40, 0
    s_cmp_ge_u32 s41, 8
    s_cselect_b32 s41, 2, 0
    s_cmp_lt_u32 s35, s38
    s_cselect_b32 s41, s41, 0
    s_cmp_lg_u32 s41, 0
    s_cselect_b32 s67, s41, s40
    s_add_u32 s42, s34, s35
    s_lshl_b32 s43, s38, 1
    s_cmp_ge_u32 s42, s43
    s_cselect_b32 s67, 3, s67
    s_cmp_lg_u32 s67, 0
    s_cbranch_scc1 s1bpd_40
    s_add_u32 s31, s31, 1
    s_cmp_gt_u32 s31, 300000
    s_cselect_b32 s67, 3, 0
    s_cbranch_scc1 s1bpd_40
    s_sleep 1
    s_branch s1bpl_39
s1bpd_40:
    v_mov_b32 v13, 163792
    v_mov_b32 v14, s67
    ds_write_b32 v13, v14
    s_waitcnt lgkmcnt(0)
s1bp_38:
    s_barrier
    v_mov_b32 v13, 163792
    ds_read_b32 v14, v13
    s_waitcnt lgkmcnt(0)
    v_readfirstlane_b32 s67, v14
    s_nop 4
s1q2_37:
    s_cmp_eq_u32 s67, 3
    s_cbranch_scc1 s1fin_31
    s_sub_u32 s56, s67, 1
    s_cmp_eq_u32 s56, 0
    s_cselect_b32 s40, s34, s35
    s_mul_i32 s57, s40, 2
    s_add_u32 s57, s57, s32
    s_xor_b32 s40, s56, 1
    s_add_u32 s34, s34, s40
    s_add_u32 s35, s35, s56
    s_lshl_b32 s40, s56, 6
    s_add_u32 s40, s40, s57
    s_mul_i32 s58, s40, 6144
    s_xor_b32 s68, s61, 32768
    s_mul_i32 s75, s57, 32768
    s_add_u32 s75, s75, 126877696
    s_mov_b32 s64, s75
    s_lshl_b32 s77, s30, 13
    s_add_u32 s77, s77, s64
    s_lshl_b32 s76, s30, 11
    s_add_u32 s76, s76, s68
    s_add_u32 m0, s76, 0
    s_nop 0
    buffer_load_dwordx4 v10, s[4:7], s77 offen sc1 lds
    s_add_u32 m0, s76, 1024
    s_nop 0
    buffer_load_dwordx4 v11, s[4:7], s77 offen sc1 lds
    s_add_u32 s77, s77, 256
    s_add_u32 m0, s76, 8192
    s_nop 0
    buffer_load_dwordx4 v10, s[4:7], s77 offen sc1 lds
    s_add_u32 m0, s76, 9216
    s_nop 0
    buffer_load_dwordx4 v11, s[4:7], s77 offen sc1 lds
    s_add_u32 s77, s77, 256
    s_add_u32 m0, s76, 16384
    s_nop 0
    buffer_load_dwordx4 v10, s[4:7], s77 offen sc1 lds
    s_add_u32 m0, s76, 17408
    s_nop 0
    buffer_load_dwordx4 v11, s[4:7], s77 offen sc1 lds
    s_add_u32 s77, s77, 256
    s_add_u32 m0, s76, 24576
    s_nop 0
    buffer_load_dwordx4 v10, s[4:7], s77 offen sc1 lds
    s_add_u32 m0, s76, 25600
    s_nop 0
    buffer_load_dwordx4 v11, s[4:7], s77 offen sc1 lds
    s_mul_i32 s40, s34, 2
    s_add_u32 s40, s40, s32
    s_min_u32 s40, s40, 63
    s_mul_i32 s40, s40, 6144
    s_add_u32 s65, s40, 5376
    s_mul_i32 s40, s35, 2
    s_add_u32 s40, s40, s32
    s_min_u32 s40, s40, 63
    s_add_u32 s40, s40, 64
    s_mul_i32 s40, s40, 6144
    s_add_u32 s66, s40, 5376
    buffer_load_dword v105, v104, s[4:7], s65 offen sc1
    buffer_load_dword v106, v104, s[4:7], s66 offen sc1
s1nx_30:
    s_mov_b32 s36, s56
    s_mov_b32 s37, s57
    s_mov_b32 s47, s58
    s_mov_b32 s61, s68
    s_mov_b32 s71, s75
    v_xor_b32 v2, 0x8000, v2
    v_xor_b32 v3, 0x8000, v3
    v_xor_b32 v4, 0x8000, v4
    v_xor_b32 v5, 0x8000, v5
    v_xor_b32 v6, 0x8000, v6
    v_xor_b32 v7, 0x8000, v7
    v_xor_b32 v8, 0x8000, v8
    v_xor_b32 v9, 0x8000, v9
    s_nop 0
    s_branch s1job_27
s1fin_31:
    s_waitcnt vmcnt(0)
    s_branch L_exit
L_s3j:
    s_mov_b32 s32, s52
    s_mov_b32 s34, 0
    s_mov_b32 s35, 0
    s_mov_b32 s38, 32
    s_mov_b32 s39, 0
    s_mov_b32 s33, s53
    s_mov_b32 s45, s54
    s_load_dwordx2 s[12:13], s[0:1], 40
    s_waitcnt vmcnt(0)
    s_barrier
    s_cmp_eq_u32 s30, 0
    s_cbranch_scc0 sinit_41
    s_mov_b64 exec, 1
    v_mov_b32 v13, 1
    v_mov_b32 v14, 64
    buffer_atomic_add v13, v14, s[8:11], 0 offen
    s_mov_b64 exec, -1
sinit_41:
    s_waitcnt lgkmcnt(0)
    s_mov_b32 s14, 0x400000
    s_mov_b32 s15, 0x20000
    s_cmp_eq_u32 s30, 0
    s_cbranch_scc0 gwb_42
    v_mov_b32 v14, 192
    s_nop 1
wd_43:
    buffer_load_dword v13, v14, s[8:11], 0 offen sc1
    s_waitcnt vmcnt(0)
    v_cmp_le_u32 vcc, 8, v13
    s_nop 3
    s_cbranch_vccnz wdd_44
    s_add_u32 s31, s31, 1
    s_cmp_gt_u32 s31, 300000
    s_cbranch_scc1 wdd_44
    s_sleep 16
    s_branch wd_43
wdd_44:
gwb_42:
    s_barrier
    s_lshl_b32 s51, s30, 15
    v_lshrrev_b32 v13, 5, v0
    v_lshlrev_b32 v13, 3, v13
    v_bfe_u32 v14, v0, 2, 2
    v_add_u32 v13, v13, v14
    v_lshlrev_b32 v13, 6, v13
    v_bfe_u32 v14, v0, 4, 1
    v_lshl_add_u32 v13, v14, 5, v13
    v_and_b32 v14, 3, v0
    v_lshl_add_u32 v13, v14, 3, v13
    v_add_u32 v21, s51, v13
    v_bfe_u32 v13, v0, 4, 1
    v_lshlrev_b32 v13, 4, v13
    v_bfe_u32 v14, v0, 5, 1
    v_lshl_add_u32 v13, v14, 2, v13
    v_bfe_u32 v14, v0, 2, 2
    v_add_u32 v13, v13, v14
    v_and_b32 v14, 3, v0
    v_lshlrev_b32 v14, 4, v14
    v_lshl_add_u32 v20, v13, 10, v14
    s_mul_i32 s52, s33, 1048576
    s_lshl_b32 s40, s45, 8
    s_add_u32 s52, s52, s40
    s_lshl_b32 s40, s30, 6
    s_add_u32 s52, s52, s40
    s_waitcnt vmcnt(0)
    s_add_u32 s50, s52, 0
    s_add_u32 m0, s51, 0
    s_nop 0
    buffer_load_dwordx4 v20, s[12:15], s50 offen lds
    s_add_u32 s50, s52, 8192
    s_add_u32 m0, s51, 1024
    s_nop 0
    buffer_load_dwordx4 v20, s[12:15], s50 offen lds
    s_add_u32 s50, s52, 32768
    s_add_u32 m0, s51, 2048
    s_nop 0
    buffer_load_dwordx4 v20, s[12:15], s50 offen lds
    s_add_u32 s50, s52, 40960
    s_add_u32 m0, s51, 3072
    s_nop 0
    buffer_load_dwordx4 v20, s[12:15], s50 offen lds
    s_add_u32 s50, s52, 65536
    s_add_u32 m0, s51, 4096
    s_nop 0
    buffer_load_dwordx4 v20, s[12:15], s50 offen lds
    s_add_u32 s50, s52, 73728
    s_add_u32 m0, s51, 5120
    s_nop 0
    buffer_load_dwordx4 v20, s[12:15], s50 offen lds
    s_add_u32 s50, s52, 98304
    s_add_u32 m0, s51, 6144
    s_nop 0
    buffer_load_dwordx4 v20, s[12:15], s50 offen lds
    s_add_u32 s50, s52, 106496
    s_add_u32 m0, s51, 7168
    s_nop 0
    buffer_load_dwordx4 v20, s[12:15], s50 offen lds
    s_add_u32 s50, s52, 131072
    s_add_u32 m0, s51, 8192
    s_nop 0
    buffer_load_dwordx4 v20, s[12:15], s50 offen lds
    s_add_u32 s50, s52, 139264
    s_add_u32 m0, s51, 9216
    s_nop 0
    buffer_load_dwordx4 v20, s[12:15], s50 offen lds
    s_add_u32 s50, s52, 163840
    s_add_u32 m0, s51, 10240
    s_nop 0
    buffer_load_dwordx4 v20, s[12:15], s50 offen lds
    s_add_u32 s50, s52, 172032
    s_add_u32 m0, s51, 11264
    s_nop 0
    buffer_load_dwordx4 v20, s[12:15], s50 offen lds
    s_add_u32 s50, s52, 196608
    s_add_u32 m0, s51, 12288
    s_nop 0
    buffer_load_dwordx4 v20, s[12:15], s50 offen lds
    s_add_u32 s50, s52, 204800
    s_add_u32 m0, s51, 13312
    s_nop 0
    buffer_load_dwordx4 v20, s[12:15], s50 offen lds
    s_add_u32 s50, s52, 229376
    s_add_u32 m0, s51, 14336
    s_nop 0
    buffer_load_dwordx4 v20, s[12:15], s50 offen lds
    s_add_u32 s50, s52, 237568
    s_add_u32 m0, s51, 15360
    s_nop 0
    buffer_load_dwordx4 v20, s[12:15], s50 offen lds
    s_add_u32 s50, s52, 262144
    s_add_u32 m0, s51, 16384
    s_nop 0
    buffer_load_dwordx4 v20, s[12:15], s50 offen lds
    s_add_u32 s50, s52, 270336
    s_add_u32 m0, s51, 17408
    s_nop 0
    buffer_load_dwordx4 v20, s[12:15], s50 offen lds
    s_add_u32 s50, s52, 294912
    s_add_u32 m0, s51, 18432
    s_nop 0
    buffer_load_dwordx4 v20, s[12:15], s50 offen lds
    s_add_u32 s50, s52, 303104
    s_add_u32 m0, s51, 19456
    s_nop 0
    buffer_load_dwordx4 v20, s[12:15], s50 offen lds
    s_add_u32 s50, s52, 327680
    s_add_u32 m0, s51, 20480
    s_nop 0
    buffer_load_dwordx4 v20, s[12:15], s50 offen lds
    s_add_u32 s50, s52, 335872
    s_add_u32 m0, s51, 21504
    s_nop 0
    buffer_load_dwordx4 v20, s[12:15], s50 offen lds
    s_add_u32 s50, s52, 360448
    s_add_u32 m0, s51, 22528
    s_nop 0
    buffer_load_dwordx4 v20, s[12:15], s50 offen lds
    s_add_u32 s50, s52, 368640
    s_add_u32 m0, s51, 23552
    s_nop 0
    buffer_load_dwordx4 v20, s[12:15], s50 offen lds
    s_add_u32 s50, s52, 393216
    s_add_u32 m0, s51, 24576
    s_nop 0
    buffer_load_dwordx4 v20, s[12:15], s50 offen lds
    s_add_u32 s50, s52, 401408
    s_add_u32 m0, s51, 25600
    s_nop 0
    buffer_load_dwordx4 v20, s[12:15], s50 offen lds
    s_add_u32 s50, s52, 425984
    s_add_u32 m0, s51, 26624
    s_nop 0
    buffer_load_dwordx4 v20, s[12:15], s50 offen lds
    s_add_u32 s50, s52, 434176
    s_add_u32 m0, s51, 27648
    s_nop 0
    buffer_load_dwordx4 v20, s[12:15], s50 offen lds
    s_add_u32 s50, s52, 458752
    s_add_u32 m0, s51, 28672
    s_nop 0
    buffer_load_dwordx4 v20, s[12:15], s50 offen lds
    s_add_u32 s50, s52, 466944
    s_add_u32 m0, s51, 29696
    s_nop 0
    buffer_load_dwordx4 v20, s[12:15], s50 offen lds
    s_add_u32 s50, s52, 491520
    s_add_u32 m0, s51, 30720
    s_nop 0
    buffer_load_dwordx4 v20, s[12:15], s50 offen lds
    s_add_u32 s50, s52, 499712
    s_add_u32 m0, s51, 31744
    s_nop 0
    buffer_load_dwordx4 v20, s[12:15], s50 offen lds
    s_waitcnt vmcnt(28)
    ds_read_b64_tr_b16 a[0:1], v21 offset:0
    ds_read_b64_tr_b16 a[2:3], v21 offset:256
    ds_read_b64_tr_b16 a[4:5], v21 offset:1024
    ds_read_b64_tr_b16 a[6:7], v21 offset:1280
    ds_read_b64_tr_b16 a[8:9], v21 offset:2048
    ds_read_b64_tr_b16 a[10:11], v21 offset:2304
    ds_read_b64_tr_b16 a[12:13], v21 offset:3072
    ds_read_b64_tr_b16 a[14:15], v21 offset:3328
    s_waitcnt lgkmcnt(0)
    s_add_u32 s50, s52, 524288
    s_add_u32 m0, s51, 0
    s_nop 0
    buffer_load_dwordx4 v20, s[12:15], s50 offen lds
    s_add_u32 s50, s52, 532480
    s_add_u32 m0, s51, 1024
    s_nop 0
    buffer_load_dwordx4 v20, s[12:15], s50 offen lds
    s_add_u32 s50, s52, 557056
    s_add_u32 m0, s51, 2048
    s_nop 0
    buffer_load_dwordx4 v20, s[12:15], s50 offen lds
    s_add_u32 s50, s52, 565248
    s_add_u32 m0, s51, 3072
    s_nop 0
    buffer_load_dwordx4 v20, s[12:15], s50 offen lds
    s_waitcnt vmcnt(28)
    ds_read_b64_tr_b16 a[16:17], v21 offset:4096
    ds_read_b64_tr_b16 a[18:19], v21 offset:4352
    ds_read_b64_tr_b16 a[20:21], v21 offset:5120
    ds_read_b64_tr_b16 a[22:23], v21 offset:5376
    ds_read_b64_tr_b16 a[24:25], v21 offset:6144
    ds_read_b64_tr_b16 a[26:27], v21 offset:6400
    ds_read_b64_tr_b16 a[28:29], v21 offset:7168
    ds_read_b64_tr_b16 a[30:31], v21 offset:7424
    s_waitcnt lgkmcnt(0)
    s_add_u32 s50, s52, 589824
    s_add_u32 m0, s51, 4096
    s_nop 0
    buffer_load_dwordx4 v20, s[12:15], s50 offen lds
    s_add_u32 s50, s52, 598016
    s_add_u32 m0, s51, 5120
    s_nop 0
    buffer_load_dwordx4 v20, s[12:15], s50 offen lds
    s_add_u32 s50, s52, 622592
    s_add_u32 m0, s51, 6144
    s_nop 0
    buffer_load_dwordx4 v20, s[12:15], s50 offen lds
    s_add_u32 s50, s52, 630784
    s_add_u32 m0, s51, 7168
    s_nop 0
    buffer_load_dwordx4 v20, s[12:15], s50 offen lds
    s_waitcnt vmcnt(28)
    ds_read_b64_tr_b16 a[32:33], v21 offset:8192
    ds_read_b64_tr_b16 a[34:35], v21 offset:8448
    ds_read_b64_tr_b16 a[36:37], v21 offset:9216
    ds_read_b64_tr_b16 a[38:39], v21 offset:9472
    ds_read_b64_tr_b16 a[40:41], v21 offset:10240
    ds_read_b64_tr_b16 a[42:43], v21 offset:10496
    ds_read_b64_tr_b16 a[44:45], v21 offset:11264
    ds_read_b64_tr_b16 a[46:47], v21 offset:11520
    s_waitcnt lgkmcnt(0)
    s_add_u32 s50, s52, 655360
    s_add_u32 m0, s51, 8192
    s_nop 0
    buffer_load_dwordx4 v20, s[12:15], s50 offen lds
    s_add_u32 s50, s52, 663552
    s_add_u32 m0, s51, 9216
    s_nop 0
    buffer_load_dwordx4 v20, s[12:15], s50 offen lds
    s_add_u32 s50, s52, 688128
    s_add_u32 m0, s51, 10240
    s_nop 0
    buffer_load_dwordx4 v20, s[12:15], s50 offen lds
    s_add_u32 s50, s52, 696320
    s_add_u32 m0, s51, 11264
    s_nop 0
    buffer_load_dwordx4 v20, s[12:15], s50 offen lds
    s_waitcnt vmcnt(28)
    ds_read_b64_tr_b16 a[48:49], v21 offset:12288
    ds_read_b64_tr_b16 a[50:51], v21 offset:12544
    ds_read_b64_tr_b16 a[52:53], v21 offset:13312
    ds_read_b64_tr_b16 a[54:55], v21 offset:13568
    ds_read_b64_tr_b16 a[56:57], v21 offset:14336
    ds_read_b64_tr_b16 a[58:59], v21 offset:14592
    ds_read_b64_tr_b16 a[60:61], v21 offset:15360
    ds_read_b64_tr_b16 a[62:63], v21 offset:15616
    s_waitcnt lgkmcnt(0)
    s_add_u32 s50, s52, 720896
    s_add_u32 m0, s51, 12288
    s_nop 0
    buffer_load_dwordx4 v20, s[12:15], s50 offen lds
    s_add_u32 s50, s52, 729088
    s_add_u32 m0, s51, 13312
    s_nop 0
    buffer_load_dwordx4 v20, s[12:15], s50 offen lds
    s_add_u32 s50, s52, 753664
    s_add_u32 m0, s51, 14336
    s_nop 0
    buffer_load_dwordx4 v20, s[12:15], s50 offen lds
    s_add_u32 s50, s52, 761856
    s_add_u32 m0, s51, 15360
    s_nop 0
    buffer_load_dwordx4 v20, s[12:15], s50 offen lds
    s_waitcnt vmcnt(28)
    ds_read_b64_tr_b16 a[64:65], v21 offset:16384
    ds_read_b64_tr_b16 a[66:67], v21 offset:16640
    ds_read_b64_tr_b16 a[68:69], v21 offset:17408
    ds_read_b64_tr_b16 a[70:71], v21 offset:17664
    ds_read_b64_tr_b16 a[72:73], v21 offset:18432
    ds_read_b64_tr_b16 a[74:75], v21 offset:18688
    ds_read_b64_tr_b16 a[76:77], v21 offset:19456
    ds_read_b64_tr_b16 a[78:79], v21 offset:19712
    s_waitcnt lgkmcnt(0)
    s_add_u32 s50, s52, 786432
    s_add_u32 m0, s51, 16384
    s_nop 0
    buffer_load_dwordx4 v20, s[12:15], s50 offen lds
    s_add_u32 s50, s52, 794624
    s_add_u32 m0, s51, 17408
    s_nop 0
    buffer_load_dwordx4 v20, s[12:15], s50 offen lds
    s_add_u32 s50, s52, 819200
    s_add_u32 m0, s51, 18432
    s_nop 0
    buffer_load_dwordx4 v20, s[12:15], s50 offen lds
    s_add_u32 s50, s52, 827392
    s_add_u32 m0, s51, 19456
    s_nop 0
    buffer_load_dwordx4 v20, s[12:15], s50 offen lds
    s_waitcnt vmcnt(28)
    ds_read_b64_tr_b16 a[80:81], v21 offset:20480
    ds_read_b64_tr_b16 a[82:83], v21 offset:20736
    ds_read_b64_tr_b16 a[84:85], v21 offset:21504
    ds_read_b64_tr_b16 a[86:87], v21 offset:21760
    ds_read_b64_tr_b16 a[88:89], v21 offset:22528
    ds_read_b64_tr_b16 a[90:91], v21 offset:22784
    ds_read_b64_tr_b16 a[92:93], v21 offset:23552
    ds_read_b64_tr_b16 a[94:95], v21 offset:23808
    s_waitcnt lgkmcnt(0)
    s_add_u32 s50, s52, 851968
    s_add_u32 m0, s51, 20480
    s_nop 0
    buffer_load_dwordx4 v20, s[12:15], s50 offen lds
    s_add_u32 s50, s52, 860160
    s_add_u32 m0, s51, 21504
    s_nop 0
    buffer_load_dwordx4 v20, s[12:15], s50 offen lds
    s_add_u32 s50, s52, 884736
    s_add_u32 m0, s51, 22528
    s_nop 0
    buffer_load_dwordx4 v20, s[12:15], s50 offen lds
    s_add_u32 s50, s52, 892928
    s_add_u32 m0, s51, 23552
    s_nop 0
    buffer_load_dwordx4 v20, s[12:15], s50 offen lds
    s_waitcnt vmcnt(28)
    ds_read_b64_tr_b16 a[96:97], v21 offset:24576
    ds_read_b64_tr_b16 a[98:99], v21 offset:24832
    ds_read_b64_tr_b16 a[100:101], v21 offset:25600
    ds_read_b64_tr_b16 a[102:103], v21 offset:25856
    ds_read_b64_tr_b16 a[104:105], v21 offset:26624
    ds_read_b64_tr_b16 a[106:107], v21 offset:26880
    ds_read_b64_tr_b16 a[108:109], v21 offset:27648
    ds_read_b64_tr_b16 a[110:111], v21 offset:27904
    s_waitcnt lgkmcnt(0)
    s_add_u32 s50, s52, 917504
    s_add_u32 m0, s51, 24576
    s_nop 0
    buffer_load_dwordx4 v20, s[12:15], s50 offen lds
    s_add_u32 s50, s52, 925696
    s_add_u32 m0, s51, 25600
    s_nop 0
    buffer_load_dwordx4 v20, s[12:15], s50 offen lds
    s_add_u32 s50, s52, 950272
    s_add_u32 m0, s51, 26624
    s_nop 0
    buffer_load_dwordx4 v20, s[12:15], s50 offen lds
    s_add_u32 s50, s52, 958464
    s_add_u32 m0, s51, 27648
    s_nop 0
    buffer_load_dwordx4 v20, s[12:15], s50 offen lds
    s_waitcnt vmcnt(28)
    ds_read_b64_tr_b16 a[112:113], v21 offset:28672
    ds_read_b64_tr_b16 a[114:115], v21 offset:28928
    ds_read_b64_tr_b16 a[116:117], v21 offset:29696
    ds_read_b64_tr_b16 a[118:119], v21 offset:29952
    ds_read_b64_tr_b16 a[120:121], v21 offset:30720
    ds_read_b64_tr_b16 a[122:123], v21 offset:30976
    ds_read_b64_tr_b16 a[124:125], v21 offset:31744
    ds_read_b64_tr_b16 a[126:127], v21 offset:32000
    s_waitcnt lgkmcnt(0)
    s_add_u32 s50, s52, 983040
    s_add_u32 m0, s51, 28672
    s_nop 0
    buffer_load_dwordx4 v20, s[12:15], s50 offen lds
    s_add_u32 s50, s52, 991232
    s_add_u32 m0, s51, 29696
    s_nop 0
    buffer_load_dwordx4 v20, s[12:15], s50 offen lds
    s_add_u32 s50, s52, 1015808
    s_add_u32 m0, s51, 30720
    s_nop 0
    buffer_load_dwordx4 v20, s[12:15], s50 offen lds
    s_add_u32 s50, s52, 1024000
    s_add_u32 m0, s51, 31744
    s_nop 0
    buffer_load_dwordx4 v20, s[12:15], s50 offen lds
    s_waitcnt vmcnt(28)
    ds_read_b64_tr_b16 a[128:129], v21 offset:0
    ds_read_b64_tr_b16 a[130:131], v21 offset:256
    ds_read_b64_tr_b16 a[132:133], v21 offset:1024
    ds_read_b64_tr_b16 a[134:135], v21 offset:1280
    ds_read_b64_tr_b16 a[136:137], v21 offset:2048
    ds_read_b64_tr_b16 a[138:139], v21 offset:2304
    ds_read_b64_tr_b16 a[140:141], v21 offset:3072
    ds_read_b64_tr_b16 a[142:143], v21 offset:3328
    s_waitcnt lgkmcnt(0)
    s_waitcnt vmcnt(24)
    ds_read_b64_tr_b16 a[144:145], v21 offset:4096
    ds_read_b64_tr_b16 a[146:147], v21 offset:4352
    ds_read_b64_tr_b16 a[148:149], v21 offset:5120
    ds_read_b64_tr_b16 a[150:151], v21 offset:5376
    ds_read_b64_tr_b16 a[152:153], v21 offset:6144
    ds_read_b64_tr_b16 a[154:155], v21 offset:6400
    ds_read_b64_tr_b16 a[156:157], v21 offset:7168
    ds_read_b64_tr_b16 a[158:159], v21 offset:7424
    s_waitcnt lgkmcnt(0)
    s_waitcnt vmcnt(20)
    ds_read_b64_tr_b16 a[160:161], v21 offset:8192
    ds_read_b64_tr_b16 a[162:163], v21 offset:8448
    ds_read_b64_tr_b16 a[164:165], v21 offset:9216
    ds_read_b64_tr_b16 a[166:167], v21 offset:9472
    ds_read_b64_tr_b16 a[168:169], v21 offset:10240
    ds_read_b64_tr_b16 a[170:171], v21 offset:10496
    ds_read_b64_tr_b16 a[172:173], v21 offset:11264
    ds_read_b64_tr_b16 a[174:175], v21 offset:11520
    s_waitcnt lgkmcnt(0)
    s_waitcnt vmcnt(16)
    ds_read_b64_tr_b16 a[176:177], v21 offset:12288
    ds_read_b64_tr_b16 a[178:179], v21 offset:12544
    ds_read_b64_tr_b16 a[180:181], v21 offset:13312
    ds_read_b64_tr_b16 a[182:183], v21 offset:13568
    ds_read_b64_tr_b16 a[184:185], v21 offset:14336
    ds_read_b64_tr_b16 a[186:187], v21 offset:14592
    ds_read_b64_tr_b16 a[188:189], v21 offset:15360
    ds_read_b64_tr_b16 a[190:191], v21 offset:15616
    s_waitcnt lgkmcnt(0)
    s_waitcnt vmcnt(12)
    ds_read_b64_tr_b16 a[192:193], v21 offset:16384
    ds_read_b64_tr_b16 a[194:195], v21 offset:16640
    ds_read_b64_tr_b16 a[196:197], v21 offset:17408
    ds_read_b64_tr_b16 a[198:199], v21 offset:17664
    ds_read_b64_tr_b16 a[200:201], v21 offset:18432
    ds_read_b64_tr_b16 a[202:203], v21 offset:18688
    ds_read_b64_tr_b16 a[204:205], v21 offset:19456
    ds_read_b64_tr_b16 a[206:207], v21 offset:19712
    s_waitcnt lgkmcnt(0)
    s_waitcnt vmcnt(8)
    ds_read_b64_tr_b16 a[208:209], v21 offset:20480
    ds_read_b64_tr_b16 a[210:211], v21 offset:20736
    ds_read_b64_tr_b16 a[212:213], v21 offset:21504
    ds_read_b64_tr_b16 a[214:215], v21 offset:21760
    ds_read_b64_tr_b16 a[216:217], v21 offset:22528
    ds_read_b64_tr_b16 a[218:219], v21 offset:22784
    ds_read_b64_tr_b16 a[220:221], v21 offset:23552
    ds_read_b64_tr_b16 a[222:223], v21 offset:23808
    s_waitcnt lgkmcnt(0)
    s_waitcnt vmcnt(4)
    ds_read_b64_tr_b16 a[224:225], v21 offset:24576
    ds_read_b64_tr_b16 a[226:227], v21 offset:24832
    ds_read_b64_tr_b16 a[228:229], v21 offset:25600
    ds_read_b64_tr_b16 a[230:231], v21 offset:25856
    ds_read_b64_tr_b16 a[232:233], v21 offset:26624
    ds_read_b64_tr_b16 a[234:235], v21 offset:26880
    ds_read_b64_tr_b16 a[236:237], v21 offset:27648
    ds_read_b64_tr_b16 a[238:239], v21 offset:27904
    s_waitcnt lgkmcnt(0)
    s_waitcnt vmcnt(0)
    ds_read_b64_tr_b16 a[240:241], v21 offset:28672
    ds_read_b64_tr_b16 a[242:243], v21 offset:28928
    ds_read_b64_tr_b16 a[244:245], v21 offset:29696
    ds_read_b64_tr_b16 a[246:247], v21 offset:29952
    ds_read_b64_tr_b16 a[248:249], v21 offset:30720
    ds_read_b64_tr_b16 a[250:251], v21 offset:30976
    ds_read_b64_tr_b16 a[252:253], v21 offset:31744
    ds_read_b64_tr_b16 a[254:255], v21 offset:32000
    s_waitcnt lgkmcnt(0)
    v_lshlrev_b32 v1, 4, v0
    v_mov_b32 v7, v1
    v_and_b32 v13, 31, v0
    v_lshrrev_b32 v14, 5, v0
    v_and_b32 v15, 7, v0
    v_xor_b32 v14, v14, v15
    v_lshlrev_b32 v14, 4, v14
    v_lshl_add_u32 v2, v13, 7, v14
    s_lshl_b32 s40, s30, 12
    s_add_u32 s40, s40, 131072
    v_add_u32 v2, s40, v2
    v_lshrrev_b32 v13, 3, v0
    v_and_b32 v14, 7, v0
    v_xor_b32 v15, v14, v13
    v_lshlrev_b32 v15, 4, v15
    v_lshl_add_u32 v3, v13, 7, v15
    v_add_u32 v3, s40, v3
    v_lshlrev_b32 v14, 4, v14
    v_lshl_add_u32 v4, v13, 11, v14
    v_mov_b32 v5, 0
    s_lshl_b32 s53, s33, 7
    s_add_u32 s53, s53, 4224
    s_lshl_b32 s54, s33, 16
    s_cmp_eq_u32 s30, 0
    s_cbranch_scc0 winitb_45
    v_mov_b32 v14, 64
    s_nop 1
wd_46:
    buffer_load_dword v13, v14, s[8:11], 0 offen sc1
    s_waitcnt vmcnt(0)
    v_cmp_le_u32 vcc, 0x80, v13
    s_nop 3
    s_cbranch_vccnz wdd_47
    s_add_u32 s31, s31, 1
    s_cmp_gt_u32 s31, 300000
    s_cbranch_scc1 wdd_47
    s_sleep 6
    s_branch wd_46
wdd_47:
winitb_45:
    s_barrier
    s_barrier
    s_mov_b32 s60, 0
    s_mov_b32 s81, 0
    s_mov_b32 s78, 5505024
    s_mov_b64 s[86:87], 0
    s_mov_b32 s61, 0
    s_cmp_eq_u32 s30, 0
    s_cselect_b32 s74, 1, 0
    s_mov_b32 s73, 0
    s_cmp_eq_u32 s30, 0
    s_cbranch_scc0 s3bp_53
    s_mul_i32 s40, s34, 2
    s_add_u32 s40, s40, s32
    s_min_u32 s40, s40, 63
    s_mul_i32 s40, s40, 6144
    s_add_u32 s65, s40, s53
    s_mul_i32 s40, s35, 2
    s_add_u32 s40, s40, s32
    s_min_u32 s40, s40, 63
    s_add_u32 s40, s40, 64
    s_mul_i32 s40, s40, 6144
    s_add_u32 s66, s40, s53
s3bpl_54:
    buffer_load_dword v8, v5, s[4:7], s65 offen sc1
    buffer_load_dword v9, v5, s[4:7], s66 offen sc1
    s_waitcnt vmcnt(0)
    v_readfirstlane_b32 s40, v8
    v_readfirstlane_b32 s41, v9
    s_nop 2
    s_cmp_ge_u32 s40, 2
    s_cselect_b32 s40, 1, 0
    s_cmp_lt_u32 s34, s38
    s_cselect_b32 s40, s40, 0
    s_cmp_ge_u32 s41, 2
    s_cselect_b32 s41, 2, 0
    s_cmp_lt_u32 s35, s38
    s_cselect_b32 s41, s41, 0
    s_cmp_lg_u32 s40, 0
    s_cselect_b32 s67, s40, s41
    s_add_u32 s42, s34, s35
    s_lshl_b32 s43, s38, 1
    s_cmp_ge_u32 s42, s43
    s_cselect_b32 s67, 3, s67
    s_cmp_lg_u32 s67, 0
    s_cbranch_scc1 s3bpd_55
    s_add_u32 s31, s31, 1
    s_cmp_gt_u32 s31, 300000
    s_cselect_b32 s67, 3, 0
    s_cbranch_scc1 s3bpd_55
    s_sleep 1
    s_branch s3bpl_54
s3bpd_55:
    v_mov_b32 v13, 163792
    v_mov_b32 v14, s67
    ds_write_b32 v13, v14
    s_waitcnt lgkmcnt(0)
s3bp_53:
    s_barrier
    v_mov_b32 v13, 163792
    ds_read_b32 v14, v13
    s_waitcnt lgkmcnt(0)
    v_readfirstlane_b32 s67, v14
    s_nop 3
    s_cmp_eq_u32 s67, 3
    s_cbranch_scc1 s3fin_52
    s_sub_u32 s36, s67, 1
    s_cmp_eq_u32 s36, 0
    s_cselect_b32 s40, s34, s35
    s_mul_i32 s37, s40, 2
    s_add_u32 s37, s37, s32
    s_xor_b32 s40, s36, 1
    s_add_u32 s34, s34, s40
    s_add_u32 s35, s35, s36
    s_lshl_b32 s40, s36, 6
    s_add_u32 s40, s40, s37
    s_mul_i32 s47, s40, 6144
    s_mul_i32 s71, s37, 262144
    s_add_u32 s71, s71, 73400320
    s_add_u32 s71, s71, s54
    s_mul_i32 s76, s30, 16384
    s_add_u32 s77, s71, s76
    s_add_u32 s76, s76, s61
    s_add_u32 m0, s76, 0
    s_nop 0
    buffer_load_dwordx4 v1, s[4:7], s77 offen offset:0 sc1 lds
    buffer_load_dwordx4 v1, s[4:7], s77 offen offset:1024 sc1 lds
    buffer_load_dwordx4 v1, s[4:7], s77 offen offset:2048 sc1 lds
    buffer_load_dwordx4 v1, s[4:7], s77 offen offset:3072 sc1 lds
    s_add_u32 m0, s76, 4096
    s_add_u32 s77, s77, 4096
    buffer_load_dwordx4 v1, s[4:7], s77 offen offset:0 sc1 lds
    buffer_load_dwordx4 v1, s[4:7], s77 offen offset:1024 sc1 lds
    buffer_load_dwordx4 v1, s[4:7], s77 offen offset:2048 sc1 lds
    buffer_load_dwordx4 v1, s[4:7], s77 offen offset:3072 sc1 lds
    s_add_u32 m0, s76, 8192
    s_add_u32 s77, s77, 4096
    buffer_load_dwordx4 v1, s[4:7], s77 offen offset:0 sc1 lds
    buffer_load_dwordx4 v1, s[4:7], s77 offen offset:1024 sc1 lds
    buffer_load_dwordx4 v1, s[4:7], s77 offen offset:2048 sc1 lds
    buffer_load_dwordx4 v1, s[4:7], s77 offen offset:3072 sc1 lds
    s_add_u32 m0, s76, 12288
    s_add_u32 s77, s77, 4096
    buffer_load_dwordx4 v1, s[4:7], s77 offen offset:0 sc1 lds
    buffer_load_dwordx4 v1, s[4:7], s77 offen offset:1024 sc1 lds
    buffer_load_dwordx4 v1, s[4:7], s77 offen offset:2048 sc1 lds
    buffer_load_dwordx4 v1, s[4:7], s77 offen offset:3072 sc1 lds
    s_mul_i32 s40, s34, 2
    s_add_u32 s40, s40, s32
    s_min_u32 s40, s40, 63
    s_mul_i32 s40, s40, 6144
    s_add_u32 s65, s40, s53
    s_mul_i32 s40, s35, 2
    s_add_u32 s40, s40, s32
    s_min_u32 s40, s40, 63
    s_add_u32 s40, s40, 64
    s_mul_i32 s40, s40, 6144
    s_add_u32 s66, s40, s53
    buffer_load_dword v8, v5, s[4:7], s65 offen sc1
    buffer_load_dword v9, v5, s[4:7], s66 offen sc1
    s_mov_b32 s83, 0
s3job_48:
    s_cmp_eq_u32 s83, 2
    s_cbranch_scc1 s3w2_50
    s_cmp_eq_u32 s83, 0
    s_cbranch_scc1 s3w_49
    s_waitcnt vmcnt(7)
    s_branch s3w2_50
s3w_49:
    s_waitcnt vmcnt(0)
s3w2_50:
    s_barrier
    ds_read_b128 v[32:35], v7 offset:0
    ds_read_b128 v[36:39], v7 offset:1024
    ds_read_b128 v[40:43], v7 offset:2048
    ds_read_b128 v[44:47], v7 offset:3072
    ds_read_b128 v[48:51], v7 offset:4096
    ds_read_b128 v[52:55], v7 offset:5120
    s_waitcnt lgkmcnt(5)
    v_mfma_f32_32x32x16_bf16 v[16:31], a[0:3], v[32:35], 0
    ds_read_b128 v[56:59], v7 offset:6144
    s_waitcnt lgkmcnt(5)
    v_mfma_f32_32x32x16_bf16 v[16:31], a[4:7], v[36:39], v[16:31]
    ds_read_b128 v[60:63], v7 offset:7168
    s_cmp_eq_u32 s83, 2
    s_nop 8
    s_cbranch_scc1 s3hs_56
    s_waitcnt vmcnt(4)
s3hs_56:
    v_readfirstlane_b32 s40, v8
    v_readfirstlane_b32 s41, v9
    s_waitcnt lgkmcnt(5)
    v_mfma_f32_32x32x16_bf16 v[16:31], a[8:11], v[40:43], v[16:31]
    ds_read_b128 v[32:35], v7 offset:8192
    s_cmp_ge_u32 s40, 2
    s_cselect_b32 s40, 1, 0
    s_cmp_lt_u32 s34, s38
    s_cselect_b32 s40, s40, 0
    s_waitcnt lgkmcnt(5)
    v_mfma_f32_32x32x16_bf16 v[16:31], a[12:15], v[44:47], v[16:31]
    ds_read_b128 v[36:39], v7 offset:9216
    s_cmp_ge_u32 s41, 2
    s_cselect_b32 s41, 2, 0
    s_cmp_lt_u32 s35, s38
    s_cselect_b32 s41, s41, 0
    s_waitcnt lgkmcnt(5)
    v_mfma_f32_32x32x16_bf16 v[16:31], a[16:19], v[48:51], v[16:31]
    ds_read_b128 v[40:43], v7 offset:10240
    s_cmp_lg_u32 s40, 0
    s_cselect_b32 s67, s40, s41
    s_add_u32 s42, s34, s35
    s_lshl_b32 s43, s38, 1
    s_waitcnt lgkmcnt(5)
    v_mfma_f32_32x32x16_bf16 v[16:31], a[20:23], v[52:55], v[16:31]
    ds_read_b128 v[44:47], v7 offset:11264
    s_cmp_ge_u32 s42, s43
    s_cselect_b32 s67, 3, s67
    s_waitcnt lgkmcnt(5)
    v_mfma_f32_32x32x16_bf16 v[16:31], a[24:27], v[56:59], v[16:31]
    ds_read_b128 v[48:51], v7 offset:12288
    s_lshl_b32 s40, s30, 2
    s_add_u32 s40, s40, 163792
    v_mov_b32 v13, s40
    v_mov_b32 v14, s67
    s_waitcnt lgkmcnt(5)
    v_mfma_f32_32x32x16_bf16 v[16:31], a[28:31], v[60:63], v[16:31]
    ds_read_b128 v[52:55], v7 offset:13312
    ds_write_b32 v13, v14
    s_waitcnt lgkmcnt(6)
    v_mfma_f32_32x32x16_bf16 v[16:31], a[32:35], v[32:35], v[16:31]
    ds_read_b128 v[56:59], v7 offset:14336
    s_waitcnt lgkmcnt(6)
    v_mfma_f32_32x32x16_bf16 v[16:31], a[36:39], v[36:39], v[16:31]
    ds_read_b128 v[60:63], v7 offset:15360
    s_waitcnt lgkmcnt(2)
    s_barrier
    v_mov_b32 v13, 163792
    ds_read_b32 v8, v13
    s_waitcnt lgkmcnt(7)
    v_mfma_f32_32x32x16_bf16 v[16:31], a[40:43], v[40:43], v[16:31]
    ds_read_b128 v[32:35], v7 offset:16384
    s_waitcnt lgkmcnt(7)
    v_mfma_f32_32x32x16_bf16 v[16:31], a[44:47], v[44:47], v[16:31]
    ds_read_b128 v[36:39], v7 offset:17408
    s_waitcnt lgkmcnt(2)
    v_readfirstlane_b32 s67, v8
    s_waitcnt lgkmcnt(7)
    v_mfma_f32_32x32x16_bf16 v[16:31], a[48:51], v[48:51], v[16:31]
    ds_read_b128 v[40:43], v7 offset:18432
    s_nop 0
    s_sub_u32 s40, s67, 1
    s_cmp_lt_u32 s40, 2
    s_cselect_b32 s62, 1, 0
    s_cselect_b32 s56, s40, 0
    s_waitcnt lgkmcnt(7)
    v_mfma_f32_32x32x16_bf16 v[16:31], a[52:55], v[52:55], v[16:31]
    ds_read_b128 v[44:47], v7 offset:19456
    s_cmp_eq_u32 s56, 0
    s_cselect_b32 s40, s34, s35
    s_mul_i32 s57, s40, 2
    s_add_u32 s57, s57, s32
    s_waitcnt lgkmcnt(6)
    v_mfma_f32_32x32x16_bf16 v[16:31], a[56:59], v[56:59], v[16:31]
    ds_read_b128 v[48:51], v7 offset:20480
    s_min_u32 s57, s57, 63
    s_xor_b32 s40, s56, 1
    s_and_b32 s40, s40, s62
    s_add_u32 s34, s34, s40
    s_waitcnt lgkmcnt(6)
    v_mfma_f32_32x32x16_bf16 v[16:31], a[60:63], v[60:63], v[16:31]
    ds_read_b128 v[52:55], v7 offset:21504
    s_and_b32 s40, s56, s62
    s_add_u32 s35, s35, s40
    s_lshl_b32 s40, s56, 6
    s_add_u32 s40, s40, s57
    s_waitcnt lgkmcnt(5)
    v_mfma_f32_32x32x16_bf16 v[16:31], a[64:67], v[32:35], v[16:31]
    ds_read_b128 v[56:59], v7 offset:22528
    s_mul_i32 s58, s40, 6144
    s_xor_b32 s68, s61, 65536
    s_waitcnt lgkmcnt(5)
    v_mfma_f32_32x32x16_bf16 v[16:31], a[68:71], v[36:39], v[16:31]
    ds_read_b128 v[60:63], v7 offset:23552
    s_mul_i32 s64, s57, 262144
    s_add_u32 s64, s64, 73400320
    s_add_u32 s64, s64, s54
    s_waitcnt lgkmcnt(5)
    v_mfma_f32_32x32x16_bf16 v[16:31], a[72:75], v[40:43], v[16:31]
    ds_read_b128 v[32:35], v7 offset:24576
    s_cmp_eq_u32 s62, 1
    s_cselect_b32 s64, s64, s71
    s_cselect_b64 s[84:85], -1, 0
    s_mov_b32 s75, s64
    s_waitcnt lgkmcnt(5)
    v_mfma_f32_32x32x16_bf16 v[16:31], a[76:79], v[44:47], v[16:31]
    ds_read_b128 v[36:39], v7 offset:25600
    s_mul_i32 s76, s30, 16384
    s_add_u32 s77, s64, s76
    s_add_u32 s76, s76, s68
    s_waitcnt lgkmcnt(5)
    v_mfma_f32_32x32x16_bf16 v[16:31], a[80:83], v[48:51], v[16:31]
    ds_read_b128 v[40:43], v7 offset:26624
    s_add_u32 m0, s76, 0
    s_mov_b64 exec, s[84:85]
    buffer_load_dwordx4 v1, s[4:7], s77 offen offset:0 sc1 lds
    s_mov_b64 exec, -1
    s_waitcnt lgkmcnt(5)
    v_mfma_f32_32x32x16_bf16 v[16:31], a[84:87], v[52:55], v[16:31]
    ds_read_b128 v[44:47], v7 offset:27648
    s_mov_b64 exec, s[84:85]
    buffer_load_dwordx4 v1, s[4:7], s77 offen offset:1024 sc1 lds
    s_mov_b64 exec, -1
    s_waitcnt lgkmcnt(5)
    v_mfma_f32_32x32x16_bf16 v[16:31], a[88:91], v[56:59], v[16:31]
    ds_read_b128 v[48:51], v7 offset:28672
    s_mov_b64 exec, s[84:85]
    buffer_load_dwordx4 v1, s[4:7], s77 offen offset:2048 sc1 lds
    s_mov_b64 exec, -1
    s_waitcnt lgkmcnt(5)
    v_mfma_f32_32x32x16_bf16 v[16:31], a[92:95], v[60:63], v[16:31]
    ds_read_b128 v[52:55], v7 offset:29696
    s_mov_b64 exec, s[84:85]
    buffer_load_dwordx4 v1, s[4:7], s77 offen offset:3072 sc1 lds
    s_mov_b64 exec, -1
    s_waitcnt lgkmcnt(5)
    v_mfma_f32_32x32x16_bf16 v[16:31], a[96:99], v[32:35], v[16:31]
    ds_read_b128 v[56:59], v7 offset:30720
    s_add_u32 m0, s76, 4096
    s_add_u32 s77, s77, 4096
    s_mov_b64 exec, s[84:85]
    buffer_load_dwordx4 v1, s[4:7], s77 offen offset:0 sc1 lds
    s_mov_b64 exec, -1
    s_waitcnt lgkmcnt(5)
    v_mfma_f32_32x32x16_bf16 v[16:31], a[100:103], v[36:39], v[16:31]
    ds_read_b128 v[60:63], v7 offset:31744
    s_mov_b64 exec, s[84:85]
    buffer_load_dwordx4 v1, s[4:7], s77 offen offset:1024 sc1 lds
    s_mov_b64 exec, -1
    s_waitcnt lgkmcnt(5)
    v_mfma_f32_32x32x16_bf16 v[16:31], a[104:107], v[40:43], v[16:31]
    ds_read_b128 v[32:35], v7 offset:32768
    s_mov_b64 exec, s[84:85]
    buffer_load_dwordx4 v1, s[4:7], s77 offen offset:2048 sc1 lds
    s_mov_b64 exec, -1
    s_waitcnt lgkmcnt(5)
    v_mfma_f32_32x32x16_bf16 v[16:31], a[108:111], v[44:47], v[16:31]
    ds_read_b128 v[36:39], v7 offset:33792
    s_mov_b64 exec, s[84:85]
    buffer_load_dwordx4 v1, s[4:7], s77 offen offset:3072 sc1 lds
    s_mov_b64 exec, -1
    s_waitcnt lgkmcnt(5)
    v_mfma_f32_32x32x16_bf16 v[16:31], a[112:115], v[48:51], v[16:31]
    ds_read_b128 v[40:43], v7 offset:34816
    s_add_u32 m0, s76, 8192
    s_add_u32 s77, s77, 4096
    s_mov_b64 exec, s[84:85]
    buffer_load_dwordx4 v1, s[4:7], s77 offen offset:0 sc1 lds
    s_mov_b64 exec, -1
    s_waitcnt lgkmcnt(5)
    v_mfma_f32_32x32x16_bf16 v[16:31], a[116:119], v[52:55], v[16:31]
    ds_read_b128 v[44:47], v7 offset:35840
    s_mov_b64 exec, s[84:85]
    buffer_load_dwordx4 v1, s[4:7], s77 offen offset:1024 sc1 lds
    s_mov_b64 exec, -1
    s_waitcnt lgkmcnt(5)
    v_mfma_f32_32x32x16_bf16 v[16:31], a[120:123], v[56:59], v[16:31]
    ds_read_b128 v[48:51], v7 offset:36864
    s_mov_b64 exec, s[84:85]
    buffer_load_dwordx4 v1, s[4:7], s77 offen offset:2048 sc1 lds
    s_mov_b64 exec, -1
    s_waitcnt lgkmcnt(5)
    v_mfma_f32_32x32x16_bf16 v[16:31], a[124:127], v[60:63], v[16:31]
    ds_read_b128 v[52:55], v7 offset:37888
    s_mov_b64 exec, s[84:85]
    buffer_load_dwordx4 v1, s[4:7], s77 offen offset:3072 sc1 lds
    s_mov_b64 exec, -1
    s_waitcnt lgkmcnt(5)
    v_mfma_f32_32x32x16_bf16 v[16:31], a[128:131], v[32:35], v[16:31]
    ds_read_b128 v[56:59], v7 offset:38912
    s_add_u32 m0, s76, 12288
    s_add_u32 s77, s77, 4096
    s_mov_b64 exec, s[84:85]
    buffer_load_dwordx4 v1, s[4:7], s77 offen offset:0 sc1 lds
    s_mov_b64 exec, -1
    s_waitcnt lgkmcnt(5)
    v_mfma_f32_32x32x16_bf16 v[16:31], a[132:135], v[36:39], v[16:31]
    ds_read_b128 v[60:63], v7 offset:39936
    s_mov_b64 exec, s[84:85]
    buffer_load_dwordx4 v1, s[4:7], s77 offen offset:1024 sc1 lds
    s_mov_b64 exec, -1
    s_waitcnt lgkmcnt(5)
    v_mfma_f32_32x32x16_bf16 v[16:31], a[136:139], v[40:43], v[16:31]
    ds_read_b128 v[32:35], v7 offset:40960
    s_mov_b64 exec, s[84:85]
    buffer_load_dwordx4 v1, s[4:7], s77 offen offset:2048 sc1 lds
    s_mov_b64 exec, -1
    s_waitcnt lgkmcnt(5)
    v_mfma_f32_32x32x16_bf16 v[16:31], a[140:143], v[44:47], v[16:31]
    ds_read_b128 v[36:39], v7 offset:41984
    s_mov_b64 exec, s[84:85]
    buffer_load_dwordx4 v1, s[4:7], s77 offen offset:3072 sc1 lds
    s_mov_b64 exec, -1
    s_waitcnt lgkmcnt(5)
    v_mfma_f32_32x32x16_bf16 v[16:31], a[144:147], v[48:51], v[16:31]
    ds_read_b128 v[40:43], v7 offset:43008
    s_waitcnt vmcnt(16)
    s_barrier
    s_cmp_lg_u32 s60, 0
    s_cselect_b32 s72, s74, 0
    v_mov_b32 v14, 1
    s_waitcnt lgkmcnt(5)
    v_mfma_f32_32x32x16_bf16 v[16:31], a[148:151], v[52:55], v[16:31]
    ds_read_b128 v[44:47], v7 offset:44032
    s_mov_b64 exec, s[72:73]
    buffer_atomic_add v14, v5, s[4:7], s60 offen
    s_mov_b64 exec, -1
    s_mov_b32 s60, 0
    s_waitcnt lgkmcnt(5)
    v_mfma_f32_32x32x16_bf16 v[16:31], a[152:155], v[56:59], v[16:31]
    ds_read_b128 v[48:51], v7 offset:45056
    s_mul_i32 s40, s34, 2
    s_add_u32 s40, s40, s32
    s_min_u32 s40, s40, 63
    s_mul_i32 s40, s40, 6144
    s_waitcnt lgkmcnt(5)
    v_mfma_f32_32x32x16_bf16 v[16:31], a[156:159], v[60:63], v[16:31]
    ds_read_b128 v[52:55], v7 offset:46080
    s_add_u32 s65, s40, s53
    s_mul_i32 s40, s35, 2
    s_add_u32 s40, s40, s32
    s_min_u32 s40, s40, 63
    s_waitcnt lgkmcnt(5)
    v_mfma_f32_32x32x16_bf16 v[16:31], a[160:163], v[32:35], v[16:31]
    ds_read_b128 v[56:59], v7 offset:47104
    s_add_u32 s40, s40, 64
    s_mul_i32 s40, s40, 6144
    s_add_u32 s66, s40, s53
    s_waitcnt lgkmcnt(5)
    v_mfma_f32_32x32x16_bf16 v[16:31], a[164:167], v[36:39], v[16:31]
    ds_read_b128 v[60:63], v7 offset:48128
    buffer_load_dword v8, v5, s[4:7], s65 offen sc1
    buffer_load_dword v9, v5, s[4:7], s66 offen sc1
    s_waitcnt lgkmcnt(5)
    v_mfma_f32_32x32x16_bf16 v[16:31], a[168:171], v[40:43], v[16:31]
    ds_read_b128 v[32:35], v7 offset:49152
    s_waitcnt lgkmcnt(5)
    v_mfma_f32_32x32x16_bf16 v[16:31], a[172:175], v[44:47], v[16:31]
    ds_read_b128 v[36:39], v7 offset:50176
    s_waitcnt lgkmcnt(5)
    v_mfma_f32_32x32x16_bf16 v[16:31], a[176:179], v[48:51], v[16:31]
    ds_read_b128 v[40:43], v7 offset:51200
    s_waitcnt lgkmcnt(5)
    v_mfma_f32_32x32x16_bf16 v[16:31], a[180:183], v[52:55], v[16:31]
    ds_read_b128 v[44:47], v7 offset:52224
    s_waitcnt lgkmcnt(5)
    v_mfma_f32_32x32x16_bf16 v[16:31], a[184:187], v[56:59], v[16:31]
    ds_read_b128 v[48:51], v7 offset:53248
    s_waitcnt lgkmcnt(5)
    v_mfma_f32_32x32x16_bf16 v[16:31], a[188:191], v[60:63], v[16:31]
    ds_read_b128 v[52:55], v7 offset:54272
    s_waitcnt lgkmcnt(5)
    v_mfma_f32_32x32x16_bf16 v[16:31], a[192:195], v[32:35], v[16:31]
    ds_read_b128 v[56:59], v7 offset:55296
    s_waitcnt lgkmcnt(5)
    v_mfma_f32_32x32x16_bf16 v[16:31], a[196:199], v[36:39], v[16:31]
    ds_read_b128 v[60:63], v7 offset:56320
    s_waitcnt lgkmcnt(5)
    v_mfma_f32_32x32x16_bf16 v[16:31], a[200:203], v[40:43], v[16:31]
    ds_read_b128 v[32:35], v7 offset:57344
    s_waitcnt lgkmcnt(5)
    v_mfma_f32_32x32x16_bf16 v[16:31], a[204:207], v[44:47], v[16:31]
    ds_read_b128 v[36:39], v7 offset:58368
    s_waitcnt lgkmcnt(5)
    v_mfma_f32_32x32x16_bf16 v[16:31], a[208:211], v[48:51], v[16:31]
    ds_read_b128 v[40:43], v7 offset:59392
    s_waitcnt lgkmcnt(5)
    v_mfma_f32_32x32x16_bf16 v[16:31], a[212:215], v[52:55], v[16:31]
    ds_read_b128 v[44:47], v7 offset:60416
    s_waitcnt lgkmcnt(5)
    v_mfma_f32_32x32x16_bf16 v[16:31], a[216:219], v[56:59], v[16:31]
    ds_read_b128 v[48:51], v7 offset:61440
    s_waitcnt lgkmcnt(5)
    v_mfma_f32_32x32x16_bf16 v[16:31], a[220:223], v[60:63], v[16:31]
    ds_read_b128 v[52:55], v7 offset:62464
    s_waitcnt lgkmcnt(5)
    v_mfma_f32_32x32x16_bf16 v[16:31], a[224:227], v[32:35], v[16:31]
    ds_read_b128 v[56:59], v7 offset:63488
    s_waitcnt lgkmcnt(5)
    v_mfma_f32_32x32x16_bf16 v[16:31], a[228:231], v[36:39], v[16:31]
    ds_read_b128 v[60:63], v7 offset:64512
    s_waitcnt lgkmcnt(5)
    v_mfma_f32_32x32x16_bf16 v[16:31], a[232:235], v[40:43], v[16:31]
    s_waitcnt lgkmcnt(4)
    v_mfma_f32_32x32x16_bf16 v[16:31], a[236:239], v[44:47], v[16:31]
    s_waitcnt lgkmcnt(3)
    v_mfma_f32_32x32x16_bf16 v[16:31], a[240:243], v[48:51], v[16:31]
    s_waitcnt lgkmcnt(2)
    v_mfma_f32_32x32x16_bf16 v[16:31], a[244:247], v[52:55], v[16:31]
    s_mul_i32 s80, s37, 262144
    s_add_u32 s80, s80, 90177536
    s_lshl_b32 s44, s33, 16
    s_add_u32 s80, s80, s44
    s_waitcnt lgkmcnt(1)
    v_mfma_f32_32x32x16_bf16 v[16:31], a[248:251], v[56:59], v[16:31]
    s_lshl_b32 s44, s45, 9
    s_add_u32 s80, s80, s44
    s_lshl_b32 s44, s30, 7
    s_add_u32 s80, s80, s44
    s_waitcnt lgkmcnt(0)
    v_mfma_f32_32x32x16_bf16 v[16:31], a[252:255], v[60:63], v[16:31]
    s_nop 11
    v_mov_b64 v[80:81], v[16:17]
    v_mov_b64 v[82:83], v[18:19]
    v_mov_b64 v[84:85], v[20:21]
    v_mov_b64 v[86:87], v[22:23]
    v_mov_b64 v[88:89], v[24:25]
    v_mov_b64 v[90:91], v[26:27]
    v_mov_b64 v[92:93], v[28:29]
    v_mov_b64 v[94:95], v[30:31]
    s_add_u32 s43, s47, 4736
    s_mov_b32 s60, s43
    s_mov_b32 s78, s80
    s_mov_b64 s[86:87], -1
    ds_write_b128 v2, v[80:83]
    v_xor_b32 v10, 32, v2
    ds_write_b128 v10, v[84:87]
    s_nop 1
    v_xor_b32 v10, 64, v2
    ds_write_b128 v10, v[88:91]
    s_nop 1
    v_xor_b32 v10, 96, v2
    ds_write_b128 v10, v[92:95]
    s_waitcnt lgkmcnt(0)
    ds_read_b128 v[64:67], v3 offset:0
    ds_read_b128 v[68:71], v3 offset:1024
    ds_read_b128 v[72:75], v3 offset:2048
    ds_read_b128 v[76:79], v3 offset:3072
    s_mov_b32 s79, s78
    s_waitcnt lgkmcnt(3)
    buffer_store_dwordx4 v[64:67], v4, s[4:7], s79 offen sc1
    s_add_u32 s79, s79, 16384
    s_waitcnt lgkmcnt(2)
    buffer_store_dwordx4 v[68:71], v4, s[4:7], s79 offen sc1
    s_add_u32 s79, s79, 16384
    s_waitcnt lgkmcnt(1)
    buffer_store_dwordx4 v[72:75], v4, s[4:7], s79 offen sc1
    s_add_u32 s79, s79, 16384
    s_waitcnt lgkmcnt(0)
    buffer_store_dwordx4 v[76:79], v4, s[4:7], s79 offen sc1
    s_add_u32 s79, s79, 16384
    s_mov_b32 s83, 1
    s_cmp_eq_u32 s62, 0
    s_cbranch_scc0 s3nx_51
    s_mul_i32 s40, s34, 2
    s_add_u32 s40, s40, s32
    s_min_u32 s40, s40, 63
    s_mul_i32 s40, s40, 6144
    s_add_u32 s65, s40, s53
    s_mul_i32 s40, s35, 2
    s_add_u32 s40, s40, s32
    s_min_u32 s40, s40, 63
    s_add_u32 s40, s40, 64
    s_mul_i32 s40, s40, 6144
    s_add_u32 s66, s40, s53
    buffer_load_dword v8, v5, s[4:7], s65 offen sc1
    buffer_load_dword v9, v5, s[4:7], s66 offen sc1
    s_waitcnt vmcnt(2)
    s_barrier
    s_cmp_lg_u32 s60, 0
    s_cselect_b32 s72, s74, 0
    v_mov_b32 v14, 1
    s_mov_b64 exec, s[72:73]
    buffer_atomic_add v14, v5, s[4:7], s60 offen
    s_mov_b64 exec, -1
    s_mov_b32 s60, 0
    s_mov_b32 s78, 5505024
    s_mov_b64 s[86:87], 0
    s_mov_b32 s83, 2
    s_cmp_eq_u32 s62, 0
    s_cbranch_scc0 s3nx_51
    s_mov_b32 s83, 0
    s_cmp_eq_u32 s30, 0
    s_cbranch_scc0 s3q_57
    s_waitcnt vmcnt(1)
    v_readfirstlane_b32 s40, v8
    v_readfirstlane_b32 s41, v9
    s_nop 2
    s_cmp_ge_u32 s40, 2
    s_cselect_b32 s40, 1, 0
    s_cmp_lt_u32 s34, s38
    s_cselect_b32 s40, s40, 0
    s_cmp_ge_u32 s41, 2
    s_cselect_b32 s41, 2, 0
    s_cmp_lt_u32 s35, s38
    s_cselect_b32 s41, s41, 0
    s_cmp_lg_u32 s40, 0
    s_cselect_b32 s67, s40, s41
    s_add_u32 s42, s34, s35
    s_lshl_b32 s43, s38, 1
    s_cmp_ge_u32 s42, s43
    s_cselect_b32 s67, 3, s67
    v_mov_b32 v13, 163792
    v_mov_b32 v14, s67
    ds_write_b32 v13, v14
    s_waitcnt lgkmcnt(0)
s3q_57:
    s_barrier
    v_mov_b32 v13, 163792
    ds_read_b32 v14, v13
    s_waitcnt lgkmcnt(0)
    v_readfirstlane_b32 s67, v14
    s_nop 3
    s_cmp_lg_u32 s67, 0
    s_cbranch_scc1 s3q2_58
    s_barrier
    s_cmp_eq_u32 s30, 0
    s_cbranch_scc0 s3bp_59
    s_mul_i32 s40, s34, 2
    s_add_u32 s40, s40, s32
    s_min_u32 s40, s40, 63
    s_mul_i32 s40, s40, 6144
    s_add_u32 s65, s40, s53
    s_mul_i32 s40, s35, 2
    s_add_u32 s40, s40, s32
    s_min_u32 s40, s40, 63
    s_add_u32 s40, s40, 64
    s_mul_i32 s40, s40, 6144
    s_add_u32 s66, s40, s53
s3bpl_60:
    buffer_load_dword v8, v5, s[4:7], s65 offen sc1
    buffer_load_dword v9, v5, s[4:7], s66 offen sc1
    s_waitcnt vmcnt(0)
    v_readfirstlane_b32 s40, v8
    v_readfirstlane_b32 s41, v9
    s_nop 2
    s_cmp_ge_u32 s40, 2
    s_cselect_b32 s40, 1, 0
    s_cmp_lt_u32 s34, s38
    s_cselect_b32 s40, s40, 0
    s_cmp_ge_u32 s41, 2
    s_cselect_b32 s41, 2, 0
    s_cmp_lt_u32 s35, s38
    s_cselect_b32 s41, s41, 0
    s_cmp_lg_u32 s40, 0
    s_cselect_b32 s67, s40, s41
    s_add_u32 s42, s34, s35
    s_lshl_b32 s43, s38, 1
    s_cmp_ge_u32 s42, s43
    s_cselect_b32 s67, 3, s67
    s_cmp_lg_u32 s67, 0
    s_cbranch_scc1 s3bpd_61
    s_add_u32 s31, s31, 1
    s_cmp_gt_u32 s31, 300000
    s_cselect_b32 s67, 3, 0
    s_cbranch_scc1 s3bpd_61
    s_sleep 1
    s_branch s3bpl_60
s3bpd_61:
    v_mov_b32 v13, 163792
    v_mov_b32 v14, s67
    ds_write_b32 v13, v14
    s_waitcnt lgkmcnt(0)
s3bp_59:
    s_barrier
    v_mov_b32 v13, 163792
    ds_read_b32 v14, v13
    s_waitcnt lgkmcnt(0)
    v_readfirstlane_b32 s67, v14
    s_nop 4
s3q2_58:
    s_cmp_eq_u32 s67, 3
    s_cbranch_scc1 s3fin_52
    s_sub_u32 s56, s67, 1
    s_cmp_eq_u32 s56, 0
    s_cselect_b32 s40, s34, s35
    s_mul_i32 s57, s40, 2
    s_add_u32 s57, s57, s32
    s_xor_b32 s40, s56, 1
    s_add_u32 s34, s34, s40
    s_add_u32 s35, s35, s56
    s_lshl_b32 s40, s56, 6
    s_add_u32 s40, s40, s57
    s_mul_i32 s58, s40, 6144
    s_xor_b32 s68, s61, 65536
    s_mul_i32 s75, s57, 262144
    s_add_u32 s75, s75, 73400320
    s_add_u32 s75, s75, s54
    s_mov_b32 s64, s75
    s_mul_i32 s76, s30, 16384
    s_add_u32 s77, s64, s76
    s_add_u32 s76, s76, s68
    s_add_u32 m0, s76, 0
    s_nop 0
    buffer_load_dwordx4 v1, s[4:7], s77 offen offset:0 sc1 lds
    buffer_load_dwordx4 v1, s[4:7], s77 offen offset:1024 sc1 lds
    buffer_load_dwordx4 v1, s[4:7], s77 offen offset:2048 sc1 lds
    buffer_load_dwordx4 v1, s[4:7], s77 offen offset:3072 sc1 lds
    s_add_u32 m0, s76, 4096
    s_add_u32 s77, s77, 4096
    buffer_load_dwordx4 v1, s[4:7], s77 offen offset:0 sc1 lds
    buffer_load_dwordx4 v1, s[4:7], s77 offen offset:1024 sc1 lds
    buffer_load_dwordx4 v1, s[4:7], s77 offen offset:2048 sc1 lds
    buffer_load_dwordx4 v1, s[4:7], s77 offen offset:3072 sc1 lds
    s_add_u32 m0, s76, 8192
    s_add_u32 s77, s77, 4096
    buffer_load_dwordx4 v1, s[4:7], s77 offen offset:0 sc1 lds
    buffer_load_dwordx4 v1, s[4:7], s77 offen offset:1024 sc1 lds
    buffer_load_dwordx4 v1, s[4:7], s77 offen offset:2048 sc1 lds
    buffer_load_dwordx4 v1, s[4:7], s77 offen offset:3072 sc1 lds
    s_add_u32 m0, s76, 12288
    s_add_u32 s77, s77, 4096
    buffer_load_dwordx4 v1, s[4:7], s77 offen offset:0 sc1 lds
    buffer_load_dwordx4 v1, s[4:7], s77 offen offset:1024 sc1 lds
    buffer_load_dwordx4 v1, s[4:7], s77 offen offset:2048 sc1 lds
    buffer_load_dwordx4 v1, s[4:7], s77 offen offset:3072 sc1 lds
    s_mul_i32 s40, s34, 2
    s_add_u32 s40, s40, s32
    s_min_u32 s40, s40, 63
    s_mul_i32 s40, s40, 6144
    s_add_u32 s65, s40, s53
    s_mul_i32 s40, s35, 2
    s_add_u32 s40, s40, s32
    s_min_u32 s40, s40, 63
    s_add_u32 s40, s40, 64
    s_mul_i32 s40, s40, 6144
    s_add_u32 s66, s40, s53
    buffer_load_dword v8, v5, s[4:7], s65 offen sc1
    buffer_load_dword v9, v5, s[4:7], s66 offen sc1
s3nx_51:
    s_mov_b32 s36, s56
    s_mov_b32 s37, s57
    s_mov_b32 s47, s58
    s_mov_b32 s61, s68
    s_mov_b32 s71, s75
    v_xor_b32 v7, 0x10000, v7
    s_nop 0
    s_branch s3job_48
s3fin_52:
    s_waitcnt vmcnt(0)
    s_branch L_exit
L_s5j:
    s_mov_b32 s32, s52
    s_mov_b32 s34, 0
    s_mov_b32 s35, 0
    s_mov_b32 s38, 32
    s_mov_b32 s39, 0
    s_mov_b32 s33, s53
    s_mov_b32 s45, s54
    s_load_dwordx2 s[12:13], s[0:1], 80
    s_waitcnt vmcnt(0)
    s_barrier
    s_cmp_eq_u32 s30, 0
    s_cbranch_scc0 sinit_62
    s_mov_b64 exec, 1
    v_mov_b32 v13, 1
    v_mov_b32 v14, 64
    buffer_atomic_add v13, v14, s[8:11], 0 offen
    s_mov_b64 exec, -1
sinit_62:
    s_waitcnt lgkmcnt(0)
    s_mov_b32 s14, 0x1c0000
    s_mov_b32 s15, 0x20000
    s_cmp_eq_u32 s30, 0
    s_cbranch_scc0 gwb_63
    v_mov_b32 v14, 192
    s_nop 1
wd_64:
    buffer_load_dword v13, v14, s[8:11], 0 offen sc1
    s_waitcnt vmcnt(0)
    v_cmp_le_u32 vcc, 8, v13
    s_nop 3
    s_cbranch_vccnz wdd_65
    s_add_u32 s31, s31, 1
    s_cmp_gt_u32 s31, 300000
    s_cbranch_scc1 wdd_65
    s_sleep 16
    s_branch wd_64
wdd_65:
gwb_63:
    s_barrier
    s_lshl_b32 s51, s30, 15
    v_lshrrev_b32 v13, 5, v0
    v_lshlrev_b32 v13, 3, v13
    v_bfe_u32 v14, v0, 2, 2
    v_add_u32 v13, v13, v14
    v_lshlrev_b32 v13, 6, v13
    v_bfe_u32 v14, v0, 4, 1
    v_lshl_add_u32 v13, v14, 5, v13
    v_and_b32 v14, 3, v0
    v_lshl_add_u32 v13, v14, 3, v13
    v_add_u32 v21, s51, v13
    v_bfe_u32 v13, v0, 4, 1
    v_lshlrev_b32 v13, 3, v13
    v_bfe_u32 v14, v0, 5, 1
    v_lshl_add_u32 v13, v14, 2, v13
    v_bfe_u32 v14, v0, 2, 2
    v_add_u32 v13, v13, v14
    v_and_b32 v14, 3, v0
    v_lshlrev_b32 v14, 4, v14
    v_lshl_add_u32 v20, v13, 10, v14
    s_mul_i32 s52, s33, 917504
    s_lshl_b32 s40, s45, 8
    s_add_u32 s52, s52, s40
    s_lshl_b32 s40, s30, 6
    s_add_u32 s52, s52, s40
    s_waitcnt vmcnt(0)
    s_add_u32 s50, s52, 0
    s_add_u32 m0, s51, 0
    s_nop 0
    buffer_load_dwordx4 v20, s[12:15], s50 offen lds
    s_add_u32 s50, s52, 16384
    s_add_u32 m0, s51, 1024
    s_nop 0
    buffer_load_dwordx4 v20, s[12:15], s50 offen lds
    s_add_u32 s50, s52, 32768
    s_add_u32 m0, s51, 2048
    s_nop 0
    buffer_load_dwordx4 v20, s[12:15], s50 offen lds
    s_add_u32 s50, s52, 49152
    s_add_u32 m0, s51, 3072
    s_nop 0
    buffer_load_dwordx4 v20, s[12:15], s50 offen lds
    s_add_u32 s50, s52, 65536
    s_add_u32 m0, s51, 4096
    s_nop 0
    buffer_load_dwordx4 v20, s[12:15], s50 offen lds
    s_add_u32 s50, s52, 81920
    s_add_u32 m0, s51, 5120
    s_nop 0
    buffer_load_dwordx4 v20, s[12:15], s50 offen lds
    s_add_u32 s50, s52, 98304
    s_add_u32 m0, s51, 6144
    s_nop 0
    buffer_load_dwordx4 v20, s[12:15], s50 offen lds
    s_add_u32 s50, s52, 114688
    s_add_u32 m0, s51, 7168
    s_nop 0
    buffer_load_dwordx4 v20, s[12:15], s50 offen lds
    s_add_u32 s50, s52, 131072
    s_add_u32 m0, s51, 8192
    s_nop 0
    buffer_load_dwordx4 v20, s[12:15], s50 offen lds
    s_add_u32 s50, s52, 147456
    s_add_u32 m0, s51, 9216
    s_nop 0
    buffer_load_dwordx4 v20, s[12:15], s50 offen lds
    s_add_u32 s50, s52, 163840
    s_add_u32 m0, s51, 10240
    s_nop 0
    buffer_load_dwordx4 v20, s[12:15], s50 offen lds
    s_add_u32 s50, s52, 180224
    s_add_u32 m0, s51, 11264
    s_nop 0
    buffer_load_dwordx4 v20, s[12:15], s50 offen lds
    s_add_u32 s50, s52, 196608
    s_add_u32 m0, s51, 12288
    s_nop 0
    buffer_load_dwordx4 v20, s[12:15], s50 offen lds
    s_add_u32 s50, s52, 212992
    s_add_u32 m0, s51, 13312
    s_nop 0
    buffer_load_dwordx4 v20, s[12:15], s50 offen lds
    s_add_u32 s50, s52, 229376
    s_add_u32 m0, s51, 14336
    s_nop 0
    buffer_load_dwordx4 v20, s[12:15], s50 offen lds
    s_add_u32 s50, s52, 245760
    s_add_u32 m0, s51, 15360
    s_nop 0
    buffer_load_dwordx4 v20, s[12:15], s50 offen lds
    s_add_u32 s50, s52, 262144
    s_add_u32 m0, s51, 16384
    s_nop 0
    buffer_load_dwordx4 v20, s[12:15], s50 offen lds
    s_add_u32 s50, s52, 278528
    s_add_u32 m0, s51, 17408
    s_nop 0
    buffer_load_dwordx4 v20, s[12:15], s50 offen lds
    s_add_u32 s50, s52, 294912
    s_add_u32 m0, s51, 18432
    s_nop 0
    buffer_load_dwordx4 v20, s[12:15], s50 offen lds
    s_add_u32 s50, s52, 311296
    s_add_u32 m0, s51, 19456
    s_nop 0
    buffer_load_dwordx4 v20, s[12:15], s50 offen lds
    s_add_u32 s50, s52, 327680
    s_add_u32 m0, s51, 20480
    s_nop 0
    buffer_load_dwordx4 v20, s[12:15], s50 offen lds
    s_add_u32 s50, s52, 344064
    s_add_u32 m0, s51, 21504
    s_nop 0
    buffer_load_dwordx4 v20, s[12:15], s50 offen lds
    s_add_u32 s50, s52, 360448
    s_add_u32 m0, s51, 22528
    s_nop 0
    buffer_load_dwordx4 v20, s[12:15], s50 offen lds
    s_add_u32 s50, s52, 376832
    s_add_u32 m0, s51, 23552
    s_nop 0
    buffer_load_dwordx4 v20, s[12:15], s50 offen lds
    s_add_u32 s50, s52, 393216
    s_add_u32 m0, s51, 24576
    s_nop 0
    buffer_load_dwordx4 v20, s[12:15], s50 offen lds
    s_add_u32 s50, s52, 409600
    s_add_u32 m0, s51, 25600
    s_nop 0
    buffer_load_dwordx4 v20, s[12:15], s50 offen lds
    s_add_u32 s50, s52, 425984
    s_add_u32 m0, s51, 26624
    s_nop 0
    buffer_load_dwordx4 v20, s[12:15], s50 offen lds
    s_add_u32 s50, s52, 442368
    s_add_u32 m0, s51, 27648
    s_nop 0
    buffer_load_dwordx4 v20, s[12:15], s50 offen lds
    s_add_u32 s50, s52, 458752
    s_add_u32 m0, s51, 28672
    s_nop 0
    buffer_load_dwordx4 v20, s[12:15], s50 offen lds
    s_add_u32 s50, s52, 475136
    s_add_u32 m0, s51, 29696
    s_nop 0
    buffer_load_dwordx4 v20, s[12:15], s50 offen lds
    s_add_u32 s50, s52, 491520
    s_add_u32 m0, s51, 30720
    s_nop 0
    buffer_load_dwordx4 v20, s[12:15], s50 offen lds
    s_add_u32 s50, s52, 507904
    s_add_u32 m0, s51, 31744
    s_nop 0
    buffer_load_dwordx4 v20, s[12:15], s50 offen lds
    s_waitcnt vmcnt(28)
    ds_read_b64_tr_b16 a[0:1], v21 offset:0
    ds_read_b64_tr_b16 a[2:3], v21 offset:256
    ds_read_b64_tr_b16 a[4:5], v21 offset:1024
    ds_read_b64_tr_b16 a[6:7], v21 offset:1280
    ds_read_b64_tr_b16 a[8:9], v21 offset:2048
    ds_read_b64_tr_b16 a[10:11], v21 offset:2304
    ds_read_b64_tr_b16 a[12:13], v21 offset:3072
    ds_read_b64_tr_b16 a[14:15], v21 offset:3328
    s_waitcnt lgkmcnt(0)
    s_add_u32 s50, s52, 524288
    s_add_u32 m0, s51, 0
    s_nop 0
    buffer_load_dwordx4 v20, s[12:15], s50 offen lds
    s_add_u32 s50, s52, 540672
    s_add_u32 m0, s51, 1024
    s_nop 0
    buffer_load_dwordx4 v20, s[12:15], s50 offen lds
    s_add_u32 s50, s52, 557056
    s_add_u32 m0, s51, 2048
    s_nop 0
    buffer_load_dwordx4 v20, s[12:15], s50 offen lds
    s_add_u32 s50, s52, 573440
    s_add_u32 m0, s51, 3072
    s_nop 0
    buffer_load_dwordx4 v20, s[12:15], s50 offen lds
    s_waitcnt vmcnt(28)
    ds_read_b64_tr_b16 a[16:17], v21 offset:4096
    ds_read_b64_tr_b16 a[18:19], v21 offset:4352
    ds_read_b64_tr_b16 a[20:21], v21 offset:5120
    ds_read_b64_tr_b16 a[22:23], v21 offset:5376
    ds_read_b64_tr_b16 a[24:25], v21 offset:6144
    ds_read_b64_tr_b16 a[26:27], v21 offset:6400
    ds_read_b64_tr_b16 a[28:29], v21 offset:7168
    ds_read_b64_tr_b16 a[30:31], v21 offset:7424
    s_waitcnt lgkmcnt(0)
    s_add_u32 s50, s52, 589824
    s_add_u32 m0, s51, 4096
    s_nop 0
    buffer_load_dwordx4 v20, s[12:15], s50 offen lds
    s_add_u32 s50, s52, 606208
    s_add_u32 m0, s51, 5120
    s_nop 0
    buffer_load_dwordx4 v20, s[12:15], s50 offen lds
    s_add_u32 s50, s52, 622592
    s_add_u32 m0, s51, 6144
    s_nop 0
    buffer_load_dwordx4 v20, s[12:15], s50 offen lds
    s_add_u32 s50, s52, 638976
    s_add_u32 m0, s51, 7168
    s_nop 0
    buffer_load_dwordx4 v20, s[12:15], s50 offen lds
    s_waitcnt vmcnt(28)
    ds_read_b64_tr_b16 a[32:33], v21 offset:8192
    ds_read_b64_tr_b16 a[34:35], v21 offset:8448
    ds_read_b64_tr_b16 a[36:37], v21 offset:9216
    ds_read_b64_tr_b16 a[38:39], v21 offset:9472
    ds_read_b64_tr_b16 a[40:41], v21 offset:10240
    ds_read_b64_tr_b16 a[42:43], v21 offset:10496
    ds_read_b64_tr_b16 a[44:45], v21 offset:11264
    ds_read_b64_tr_b16 a[46:47], v21 offset:11520
    s_waitcnt lgkmcnt(0)
    s_add_u32 s50, s52, 655360
    s_add_u32 m0, s51, 8192
    s_nop 0
    buffer_load_dwordx4 v20, s[12:15], s50 offen lds
    s_add_u32 s50, s52, 671744
    s_add_u32 m0, s51, 9216
    s_nop 0
    buffer_load_dwordx4 v20, s[12:15], s50 offen lds
    s_add_u32 s50, s52, 688128
    s_add_u32 m0, s51, 10240
    s_nop 0
    buffer_load_dwordx4 v20, s[12:15], s50 offen lds
    s_add_u32 s50, s52, 704512
    s_add_u32 m0, s51, 11264
    s_nop 0
    buffer_load_dwordx4 v20, s[12:15], s50 offen lds
    s_waitcnt vmcnt(28)
    ds_read_b64_tr_b16 a[48:49], v21 offset:12288
    ds_read_b64_tr_b16 a[50:51], v21 offset:12544
    ds_read_b64_tr_b16 a[52:53], v21 offset:13312
    ds_read_b64_tr_b16 a[54:55], v21 offset:13568
    ds_read_b64_tr_b16 a[56:57], v21 offset:14336
    ds_read_b64_tr_b16 a[58:59], v21 offset:14592
    ds_read_b64_tr_b16 a[60:61], v21 offset:15360
    ds_read_b64_tr_b16 a[62:63], v21 offset:15616
    s_waitcnt lgkmcnt(0)
    s_add_u32 s50, s52, 720896
    s_add_u32 m0, s51, 12288
    s_nop 0
    buffer_load_dwordx4 v20, s[12:15], s50 offen lds
    s_add_u32 s50, s52, 737280
    s_add_u32 m0, s51, 13312
    s_nop 0
    buffer_load_dwordx4 v20, s[12:15], s50 offen lds
    s_add_u32 s50, s52, 753664
    s_add_u32 m0, s51, 14336
    s_nop 0
    buffer_load_dwordx4 v20, s[12:15], s50 offen lds
    s_add_u32 s50, s52, 770048
    s_add_u32 m0, s51, 15360
    s_nop 0
    buffer_load_dwordx4 v20, s[12:15], s50 offen lds
    s_waitcnt vmcnt(28)
    ds_read_b64_tr_b16 a[64:65], v21 offset:16384
    ds_read_b64_tr_b16 a[66:67], v21 offset:16640
    ds_read_b64_tr_b16 a[68:69], v21 offset:17408
    ds_read_b64_tr_b16 a[70:71], v21 offset:17664
    ds_read_b64_tr_b16 a[72:73], v21 offset:18432
    ds_read_b64_tr_b16 a[74:75], v21 offset:18688
    ds_read_b64_tr_b16 a[76:77], v21 offset:19456
    ds_read_b64_tr_b16 a[78:79], v21 offset:19712
    s_waitcnt lgkmcnt(0)
    s_add_u32 s50, s52, 786432
    s_add_u32 m0, s51, 16384
    s_nop 0
    buffer_load_dwordx4 v20, s[12:15], s50 offen lds
    s_add_u32 s50, s52, 802816
    s_add_u32 m0, s51, 17408
    s_nop 0
    buffer_load_dwordx4 v20, s[12:15], s50 offen lds
    s_add_u32 s50, s52, 819200
    s_add_u32 m0, s51, 18432
    s_nop 0
    buffer_load_dwordx4 v20, s[12:15], s50 offen lds
    s_add_u32 s50, s52, 835584
    s_add_u32 m0, s51, 19456
    s_nop 0
    buffer_load_dwordx4 v20, s[12:15], s50 offen lds
    s_waitcnt vmcnt(28)
    ds_read_b64_tr_b16 a[80:81], v21 offset:20480
    ds_read_b64_tr_b16 a[82:83], v21 offset:20736
    ds_read_b64_tr_b16 a[84:85], v21 offset:21504
    ds_read_b64_tr_b16 a[86:87], v21 offset:21760
    ds_read_b64_tr_b16 a[88:89], v21 offset:22528
    ds_read_b64_tr_b16 a[90:91], v21 offset:22784
    ds_read_b64_tr_b16 a[92:93], v21 offset:23552
    ds_read_b64_tr_b16 a[94:95], v21 offset:23808
    s_waitcnt lgkmcnt(0)
    s_add_u32 s50, s52, 851968
    s_add_u32 m0, s51, 20480
    s_nop 0
    buffer_load_dwordx4 v20, s[12:15], s50 offen lds
    s_add_u32 s50, s52, 868352
    s_add_u32 m0, s51, 21504
    s_nop 0
    buffer_load_dwordx4 v20, s[12:15], s50 offen lds
    s_add_u32 s50, s52, 884736
    s_add_u32 m0, s51, 22528
    s_nop 0
    buffer_load_dwordx4 v20, s[12:15], s50 offen lds
    s_add_u32 s50, s52, 901120
    s_add_u32 m0, s51, 23552
    s_nop 0
    buffer_load_dwordx4 v20, s[12:15], s50 offen lds
    s_waitcnt vmcnt(28)
    ds_read_b64_tr_b16 a[96:97], v21 offset:24576
    ds_read_b64_tr_b16 a[98:99], v21 offset:24832
    ds_read_b64_tr_b16 a[100:101], v21 offset:25600
    ds_read_b64_tr_b16 a[102:103], v21 offset:25856
    ds_read_b64_tr_b16 a[104:105], v21 offset:26624
    ds_read_b64_tr_b16 a[106:107], v21 offset:26880
    ds_read_b64_tr_b16 a[108:109], v21 offset:27648
    ds_read_b64_tr_b16 a[110:111], v21 offset:27904
    s_waitcnt lgkmcnt(0)
    s_waitcnt vmcnt(24)
    ds_read_b64_tr_b16 a[112:113], v21 offset:28672
    ds_read_b64_tr_b16 a[114:115], v21 offset:28928
    ds_read_b64_tr_b16 a[116:117], v21 offset:29696
    ds_read_b64_tr_b16 a[118:119], v21 offset:29952
    ds_read_b64_tr_b16 a[120:121], v21 offset:30720
    ds_read_b64_tr_b16 a[122:123], v21 offset:30976
    ds_read_b64_tr_b16 a[124:125], v21 offset:31744
    ds_read_b64_tr_b16 a[126:127], v21 offset:32000
    s_waitcnt lgkmcnt(0)
    s_waitcnt vmcnt(20)
    ds_read_b64_tr_b16 a[128:129], v21 offset:0
    ds_read_b64_tr_b16 a[130:131], v21 offset:256
    ds_read_b64_tr_b16 a[132:133], v21 offset:1024
    ds_read_b64_tr_b16 a[134:135], v21 offset:1280
    ds_read_b64_tr_b16 a[136:137], v21 offset:2048
    ds_read_b64_tr_b16 a[138:139], v21 offset:2304
    ds_read_b64_tr_b16 a[140:141], v21 offset:3072
    ds_read_b64_tr_b16 a[142:143], v21 offset:3328
    s_waitcnt lgkmcnt(0)
    s_waitcnt vmcnt(16)
    ds_read_b64_tr_b16 a[144:145], v21 offset:4096
    ds_read_b64_tr_b16 a[146:147], v21 offset:4352
    ds_read_b64_tr_b16 a[148:149], v21 offset:5120
    ds_read_b64_tr_b16 a[150:151], v21 offset:5376
    ds_read_b64_tr_b16 a[152:153], v21 offset:6144
    ds_read_b64_tr_b16 a[154:155], v21 offset:6400
    ds_read_b64_tr_b16 a[156:157], v21 offset:7168
    ds_read_b64_tr_b16 a[158:159], v21 offset:7424
    s_waitcnt lgkmcnt(0)
    s_waitcnt vmcnt(12)
    ds_read_b64_tr_b16 a[160:161], v21 offset:8192
    ds_read_b64_tr_b16 a[162:163], v21 offset:8448
    ds_read_b64_tr_b16 a[164:165], v21 offset:9216
    ds_read_b64_tr_b16 a[166:167], v21 offset:9472
    ds_read_b64_tr_b16 a[168:169], v21 offset:10240
    ds_read_b64_tr_b16 a[170:171], v21 offset:10496
    ds_read_b64_tr_b16 a[172:173], v21 offset:11264
    ds_read_b64_tr_b16 a[174:175], v21 offset:11520
    s_waitcnt lgkmcnt(0)
    s_waitcnt vmcnt(8)
    ds_read_b64_tr_b16 a[176:177], v21 offset:12288
    ds_read_b64_tr_b16 a[178:179], v21 offset:12544
    ds_read_b64_tr_b16 a[180:181], v21 offset:13312
    ds_read_b64_tr_b16 a[182:183], v21 offset:13568
    ds_read_b64_tr_b16 a[184:185], v21 offset:14336
    ds_read_b64_tr_b16 a[186:187], v21 offset:14592
    ds_read_b64_tr_b16 a[188:189], v21 offset:15360
    ds_read_b64_tr_b16 a[190:191], v21 offset:15616
    s_waitcnt lgkmcnt(0)
    s_waitcnt vmcnt(4)
    ds_read_b64_tr_b16 a[192:193], v21 offset:16384
    ds_read_b64_tr_b16 a[194:195], v21 offset:16640
    ds_read_b64_tr_b16 a[196:197], v21 offset:17408
    ds_read_b64_tr_b16 a[198:199], v21 offset:17664
    ds_read_b64_tr_b16 a[200:201], v21 offset:18432
    ds_read_b64_tr_b16 a[202:203], v21 offset:18688
    ds_read_b64_tr_b16 a[204:205], v21 offset:19456
    ds_read_b64_tr_b16 a[206:207], v21 offset:19712
    s_waitcnt lgkmcnt(0)
    s_waitcnt vmcnt(0)
    ds_read_b64_tr_b16 a[208:209], v21 offset:20480
    ds_read_b64_tr_b16 a[210:211], v21 offset:20736
    ds_read_b64_tr_b16 a[212:213], v21 offset:21504
    ds_read_b64_tr_b16 a[214:215], v21 offset:21760
    ds_read_b64_tr_b16 a[216:217], v21 offset:22528
    ds_read_b64_tr_b16 a[218:219], v21 offset:22784
    ds_read_b64_tr_b16 a[220:221], v21 offset:23552
    ds_read_b64_tr_b16 a[222:223], v21 offset:23808
    s_waitcnt lgkmcnt(0)
    v_lshlrev_b32 v1, 4, v0
    v_mov_b32 v7, v1
    v_and_b32 v13, 31, v0
    v_lshrrev_b32 v14, 5, v0
    v_and_b32 v15, 7, v0
    v_xor_b32 v14, v14, v15
    v_lshlrev_b32 v14, 4, v14
    v_lshl_add_u32 v2, v13, 7, v14
    s_lshl_b32 s40, s30, 12
    s_add_u32 s40, s40, 131072
    v_add_u32 v2, s40, v2
    v_lshrrev_b32 v13, 3, v0
    v_and_b32 v14, 7, v0
    v_xor_b32 v15, v14, v13
    v_lshlrev_b32 v15, 4, v15
    v_lshl_add_u32 v3, v13, 7, v15
    v_add_u32 v3, s40, v3
    v_lshlrev_b32 v14, 4, v14
    v_lshl_add_u32 v4, v13, 11, v14
    v_mov_b32 v5, 0
    s_lshl_b32 s53, s33, 7
    s_add_u32 s53, s53, 4992
    s_mul_i32 s54, s33, 57344
    s_cmp_eq_u32 s30, 0
    s_cbranch_scc0 winitb_66
    v_mov_b32 v14, 64
    s_nop 1
wd_67:
    buffer_load_dword v13, v14, s[8:11], 0 offen sc1
    s_waitcnt vmcnt(0)
    v_cmp_le_u32 vcc, 0x80, v13
    s_nop 3
    s_cbranch_vccnz wdd_68
    s_add_u32 s31, s31, 1
    s_cmp_gt_u32 s31, 300000
    s_cbranch_scc1 wdd_68
    s_sleep 6
    s_branch wd_67
wdd_68:
winitb_66:
    s_barrier
    s_barrier
    s_mov_b32 s60, 0
    s_mov_b32 s81, 0
    s_mov_b32 s78, 5505024
    s_mov_b64 s[86:87], 0
    s_mov_b32 s61, 0
    s_cmp_eq_u32 s30, 0
    s_cselect_b32 s74, 1, 0
    s_mov_b32 s73, 0
    s_cmp_eq_u32 s30, 0
    s_cbranch_scc0 s5bp_74
    s_mul_i32 s40, s34, 2
    s_add_u32 s40, s40, s32
    s_min_u32 s40, s40, 63
    s_mul_i32 s40, s40, 6144
    s_add_u32 s65, s40, s53
    s_mul_i32 s40, s35, 2
    s_add_u32 s40, s40, s32
    s_min_u32 s40, s40, 63
    s_add_u32 s40, s40, 64
    s_mul_i32 s40, s40, 6144
    s_add_u32 s66, s40, s53
s5bpl_75:
    buffer_load_dword v8, v5, s[4:7], s65 offen sc1
    buffer_load_dword v9, v5, s[4:7], s66 offen sc1
    s_waitcnt vmcnt(0)
    v_readfirstlane_b32 s40, v8
    v_readfirstlane_b32 s41, v9
    s_nop 2
    s_cmp_ge_u32 s40, 7
    s_cselect_b32 s40, 1, 0
    s_cmp_lt_u32 s34, s38
    s_cselect_b32 s40, s40, 0
    s_cmp_ge_u32 s41, 7
    s_cselect_b32 s41, 2, 0
    s_cmp_lt_u32 s35, s38
    s_cselect_b32 s41, s41, 0
    s_cmp_lg_u32 s40, 0
    s_cselect_b32 s67, s40, s41
    s_add_u32 s42, s34, s35
    s_lshl_b32 s43, s38, 1
    s_cmp_ge_u32 s42, s43
    s_cselect_b32 s67, 3, s67
    s_cmp_lg_u32 s67, 0
    s_cbranch_scc1 s5bpd_76
    s_add_u32 s31, s31, 1
    s_cmp_gt_u32 s31, 300000
    s_cselect_b32 s67, 3, 0
    s_cbranch_scc1 s5bpd_76
    s_sleep 1
    s_branch s5bpl_75
s5bpd_76:
    v_mov_b32 v13, 163792
    v_mov_b32 v14, s67
    ds_write_b32 v13, v14
    s_waitcnt lgkmcnt(0)
s5bp_74:
    s_barrier
    v_mov_b32 v13, 163792
    ds_read_b32 v14, v13
    s_waitcnt lgkmcnt(0)
    v_readfirstlane_b32 s67, v14
    s_nop 3
    s_cmp_eq_u32 s67, 3
    s_cbranch_scc1 s5fin_73
    s_sub_u32 s36, s67, 1
    s_cmp_eq_u32 s36, 0
    s_cselect_b32 s40, s34, s35
    s_mul_i32 s37, s40, 2
    s_add_u32 s37, s37, s32
    s_xor_b32 s40, s36, 1
    s_add_u32 s34, s34, s40
    s_add_u32 s35, s35, s36
    s_lshl_b32 s40, s36, 6
    s_add_u32 s40, s40, s37
    s_mul_i32 s47, s40, 6144
    s_mul_i32 s71, s37, 114688
    s_add_u32 s71, s71, 111149056
    s_add_u32 s71, s71, s54
    s_mul_i32 s76, s30, 14336
    s_add_u32 s77, s71, s76
    s_add_u32 s76, s76, s61
    s_add_u32 m0, s76, 0
    s_nop 0
    buffer_load_dwordx4 v1, s[4:7], s77 offen offset:0 sc1 lds
    buffer_load_dwordx4 v1, s[4:7], s77 offen offset:1024 sc1 lds
    buffer_load_dwordx4 v1, s[4:7], s77 offen offset:2048 sc1 lds
    buffer_load_dwordx4 v1, s[4:7], s77 offen offset:3072 sc1 lds
    s_add_u32 m0, s76, 4096
    s_add_u32 s77, s77, 4096
    buffer_load_dwordx4 v1, s[4:7], s77 offen offset:0 sc1 lds
    buffer_load_dwordx4 v1, s[4:7], s77 offen offset:1024 sc1 lds
    buffer_load_dwordx4 v1, s[4:7], s77 offen offset:2048 sc1 lds
    buffer_load_dwordx4 v1, s[4:7], s77 offen offset:3072 sc1 lds
    s_add_u32 m0, s76, 8192
    s_add_u32 s77, s77, 4096
    buffer_load_dwordx4 v1, s[4:7], s77 offen offset:0 sc1 lds
    buffer_load_dwordx4 v1, s[4:7], s77 offen offset:1024 sc1 lds
    buffer_load_dwordx4 v1, s[4:7], s77 offen offset:2048 sc1 lds
    buffer_load_dwordx4 v1, s[4:7], s77 offen offset:3072 sc1 lds
    s_add_u32 m0, s76, 12288
    s_add_u32 s77, s77, 4096
    buffer_load_dwordx4 v1, s[4:7], s77 offen offset:0 sc1 lds
    buffer_load_dwordx4 v1, s[4:7], s77 offen offset:1024 sc1 lds
    s_mul_i32 s40, s34, 2
    s_add_u32 s40, s40, s32
    s_min_u32 s40, s40, 63
    s_mul_i32 s40, s40, 6144
    s_add_u32 s65, s40, s53
    s_mul_i32 s40, s35, 2
    s_add_u32 s40, s40, s32
    s_min_u32 s40, s40, 63
    s_add_u32 s40, s40, 64
    s_mul_i32 s40, s40, 6144
    s_add_u32 s66, s40, s53
    buffer_load_dword v8, v5, s[4:7], s65 offen sc1
    buffer_load_dword v9, v5, s[4:7], s66 offen sc1
    s_mov_b32 s83, 0
s5job_69:
    s_cmp_eq_u32 s83, 2
    s_cbranch_scc1 s5w2_71
    s_cmp_eq_u32 s83, 0
    s_cbranch_scc1 s5w_70
    s_waitcnt vmcnt(7)
    s_branch s5w2_71
s5w_70:
    s_waitcnt vmcnt(0)
s5w2_71:
    s_barrier
    ds_read_b128 v[32:35], v7 offset:0
    ds_read_b128 v[36:39], v7 offset:1024
    ds_read_b128 v[40:43], v7 offset:2048
    ds_read_b128 v[44:47], v7 offset:3072
    ds_read_b128 v[48:51], v7 offset:4096
    ds_read_b128 v[52:55], v7 offset:5120
    s_waitcnt lgkmcnt(5)
    v_mfma_f32_32x32x16_bf16 v[16:31], a[0:3], v[32:35], 0
    ds_read_b128 v[56:59], v7 offset:6144
    s_waitcnt lgkmcnt(5)
    v_mfma_f32_32x32x16_bf16 v[16:31], a[4:7], v[36:39], v[16:31]
    ds_read_b128 v[60:63], v7 offset:7168
    s_cmp_eq_u32 s83, 2
    s_nop 8
    s_cbranch_scc1 s5hs_77
    s_waitcnt vmcnt(4)
s5hs_77:
    v_readfirstlane_b32 s40, v8
    v_readfirstlane_b32 s41, v9
    s_waitcnt lgkmcnt(5)
    v_mfma_f32_32x32x16_bf16 v[16:31], a[8:11], v[40:43], v[16:31]
    ds_read_b128 v[32:35], v7 offset:8192
    s_cmp_ge_u32 s40, 7
    s_cselect_b32 s40, 1, 0
    s_cmp_lt_u32 s34, s38
    s_cselect_b32 s40, s40, 0
    s_waitcnt lgkmcnt(5)
    v_mfma_f32_32x32x16_bf16 v[16:31], a[12:15], v[44:47], v[16:31]
    ds_read_b128 v[36:39], v7 offset:9216
    s_cmp_ge_u32 s41, 7
    s_cselect_b32 s41, 2, 0
    s_cmp_lt_u32 s35, s38
    s_cselect_b32 s41, s41, 0
    s_waitcnt lgkmcnt(5)
    v_mfma_f32_32x32x16_bf16 v[16:31], a[16:19], v[48:51], v[16:31]
    ds_read_b128 v[40:43], v7 offset:10240
    s_cmp_lg_u32 s40, 0
    s_cselect_b32 s67, s40, s41
    s_add_u32 s42, s34, s35
    s_lshl_b32 s43, s38, 1
    s_waitcnt lgkmcnt(5)
    v_mfma_f32_32x32x16_bf16 v[16:31], a[20:23], v[52:55], v[16:31]
    ds_read_b128 v[44:47], v7 offset:11264
    s_cmp_ge_u32 s42, s43
    s_cselect_b32 s67, 3, s67
    s_waitcnt lgkmcnt(5)
    v_mfma_f32_32x32x16_bf16 v[16:31], a[24:27], v[56:59], v[16:31]
    ds_read_b128 v[48:51], v7 offset:12288
    s_lshl_b32 s40, s30, 2
    s_add_u32 s40, s40, 163792
    v_mov_b32 v13, s40
    v_mov_b32 v14, s67
    s_waitcnt lgkmcnt(5)
    v_mfma_f32_32x32x16_bf16 v[16:31], a[28:31], v[60:63], v[16:31]
    ds_read_b128 v[52:55], v7 offset:13312
    ds_write_b32 v13, v14
    s_waitcnt lgkmcnt(6)
    v_mfma_f32_32x32x16_bf16 v[16:31], a[32:35], v[32:35], v[16:31]
    ds_read_b128 v[56:59], v7 offset:14336
    s_waitcnt lgkmcnt(6)
    v_mfma_f32_32x32x16_bf16 v[16:31], a[36:39], v[36:39], v[16:31]
    ds_read_b128 v[60:63], v7 offset:15360
    s_waitcnt lgkmcnt(2)
    s_barrier
    v_mov_b32 v13, 163792
    ds_read_b32 v8, v13
    s_waitcnt lgkmcnt(7)
    v_mfma_f32_32x32x16_bf16 v[16:31], a[40:43], v[40:43], v[16:31]
    ds_read_b128 v[32:35], v7 offset:16384
    s_waitcnt lgkmcnt(7)
    v_mfma_f32_32x32x16_bf16 v[16:31], a[44:47], v[44:47], v[16:31]
    ds_read_b128 v[36:39], v7 offset:17408
    s_waitcnt lgkmcnt(2)
    v_readfirstlane_b32 s67, v8
    s_waitcnt lgkmcnt(7)
    v_mfma_f32_32x32x16_bf16 v[16:31], a[48:51], v[48:51], v[16:31]
    ds_read_b128 v[40:43], v7 offset:18432
    s_nop 0
    s_sub_u32 s40, s67, 1
    s_cmp_lt_u32 s40, 2
    s_cselect_b32 s62, 1, 0
    s_cselect_b32 s56, s40, 0
    s_waitcnt lgkmcnt(7)
    v_mfma_f32_32x32x16_bf16 v[16:31], a[52:55], v[52:55], v[16:31]
    ds_read_b128 v[44:47], v7 offset:19456
    s_cmp_eq_u32 s56, 0
    s_cselect_b32 s40, s34, s35
    s_mul_i32 s57, s40, 2
    s_add_u32 s57, s57, s32
    s_waitcnt lgkmcnt(6)
    v_mfma_f32_32x32x16_bf16 v[16:31], a[56:59], v[56:59], v[16:31]
    ds_read_b128 v[48:51], v7 offset:20480
    s_min_u32 s57, s57, 63
    s_xor_b32 s40, s56, 1
    s_and_b32 s40, s40, s62
    s_add_u32 s34, s34, s40
    s_waitcnt lgkmcnt(6)
    v_mfma_f32_32x32x16_bf16 v[16:31], a[60:63], v[60:63], v[16:31]
    ds_read_b128 v[52:55], v7 offset:21504
    s_and_b32 s40, s56, s62
    s_add_u32 s35, s35, s40
    s_lshl_b32 s40, s56, 6
    s_add_u32 s40, s40, s57
    s_waitcnt lgkmcnt(5)
    v_mfma_f32_32x32x16_bf16 v[16:31], a[64:67], v[32:35], v[16:31]
    ds_read_b128 v[56:59], v7 offset:22528
    s_mul_i32 s58, s40, 6144
    s_xor_b32 s68, s61, 65536
    s_waitcnt lgkmcnt(5)
    v_mfma_f32_32x32x16_bf16 v[16:31], a[68:71], v[36:39], v[16:31]
    ds_read_b128 v[60:63], v7 offset:23552
    s_mul_i32 s64, s57, 114688
    s_add_u32 s64, s64, 111149056
    s_add_u32 s64, s64, s54
    s_waitcnt lgkmcnt(5)
    v_mfma_f32_32x32x16_bf16 v[16:31], a[72:75], v[40:43], v[16:31]
    ds_read_b128 v[32:35], v7 offset:24576
    s_cmp_eq_u32 s62, 1
    s_cselect_b32 s64, s64, s71
    s_cselect_b64 s[84:85], -1, 0
    s_mov_b32 s75, s64
    s_waitcnt lgkmcnt(5)
    v_mfma_f32_32x32x16_bf16 v[16:31], a[76:79], v[44:47], v[16:31]
    ds_read_b128 v[36:39], v7 offset:25600
    s_mul_i32 s76, s30, 14336
    s_add_u32 s77, s64, s76
    s_add_u32 s76, s76, s68
    s_waitcnt lgkmcnt(5)
    v_mfma_f32_32x32x16_bf16 v[16:31], a[80:83], v[48:51], v[16:31]
    ds_read_b128 v[40:43], v7 offset:26624
    s_add_u32 m0, s76, 0
    s_mov_b64 exec, s[84:85]
    buffer_load_dwordx4 v1, s[4:7], s77 offen offset:0 sc1 lds
    s_mov_b64 exec, -1
    s_waitcnt lgkmcnt(5)
    v_mfma_f32_32x32x16_bf16 v[16:31], a[84:87], v[52:55], v[16:31]
    ds_read_b128 v[44:47], v7 offset:27648
    s_mov_b64 exec, s[84:85]
    buffer_load_dwordx4 v1, s[4:7], s77 offen offset:1024 sc1 lds
    s_mov_b64 exec, -1
    s_waitcnt lgkmcnt(5)
    v_mfma_f32_32x32x16_bf16 v[16:31], a[88:91], v[56:59], v[16:31]
    ds_read_b128 v[48:51], v7 offset:28672
    s_mov_b64 exec, s[84:85]
    buffer_load_dwordx4 v1, s[4:7], s77 offen offset:2048 sc1 lds
    s_mov_b64 exec, -1
    s_waitcnt lgkmcnt(5)
    v_mfma_f32_32x32x16_bf16 v[16:31], a[92:95], v[60:63], v[16:31]
    ds_read_b128 v[52:55], v7 offset:29696
    s_mov_b64 exec, s[84:85]
    buffer_load_dwordx4 v1, s[4:7], s77 offen offset:3072 sc1 lds
    s_mov_b64 exec, -1
    s_waitcnt lgkmcnt(5)
    v_mfma_f32_32x32x16_bf16 v[16:31], a[96:99], v[32:35], v[16:31]
    ds_read_b128 v[56:59], v7 offset:30720
    s_add_u32 m0, s76, 4096
    s_add_u32 s77, s77, 4096
    s_mov_b64 exec, s[84:85]
    buffer_load_dwordx4 v1, s[4:7], s77 offen offset:0 sc1 lds
    s_mov_b64 exec, -1
    s_waitcnt lgkmcnt(5)
    v_mfma_f32_32x32x16_bf16 v[16:31], a[100:103], v[36:39], v[16:31]
    ds_read_b128 v[60:63], v7 offset:31744
    s_mov_b64 exec, s[84:85]
    buffer_load_dwordx4 v1, s[4:7], s77 offen offset:1024 sc1 lds
    s_mov_b64 exec, -1
    s_waitcnt lgkmcnt(5)
    v_mfma_f32_32x32x16_bf16 v[16:31], a[104:107], v[40:43], v[16:31]
    ds_read_b128 v[32:35], v7 offset:32768
    s_mov_b64 exec, s[84:85]
    buffer_load_dwordx4 v1, s[4:7], s77 offen offset:2048 sc1 lds
    s_mov_b64 exec, -1
    s_waitcnt lgkmcnt(5)
    v_mfma_f32_32x32x16_bf16 v[16:31], a[108:111], v[44:47], v[16:31]
    ds_read_b128 v[36:39], v7 offset:33792
    s_mov_b64 exec, s[84:85]
    buffer_load_dwordx4 v1, s[4:7], s77 offen offset:3072 sc1 lds
    s_mov_b64 exec, -1
    s_waitcnt lgkmcnt(5)
    v_mfma_f32_32x32x16_bf16 v[16:31], a[112:115], v[48:51], v[16:31]
    ds_read_b128 v[40:43], v7 offset:34816
    s_add_u32 m0, s76, 8192
    s_add_u32 s77, s77, 4096
    s_mov_b64 exec, s[84:85]
    buffer_load_dwordx4 v1, s[4:7], s77 offen offset:0 sc1 lds
    s_mov_b64 exec, -1
    s_waitcnt lgkmcnt(5)
    v_mfma_f32_32x32x16_bf16 v[16:31], a[116:119], v[52:55], v[16:31]
    ds_read_b128 v[44:47], v7 offset:35840
    s_mov_b64 exec, s[84:85]
    buffer_load_dwordx4 v1, s[4:7], s77 offen offset:1024 sc1 lds
    s_mov_b64 exec, -1
    s_waitcnt lgkmcnt(5)
    v_mfma_f32_32x32x16_bf16 v[16:31], a[120:123], v[56:59], v[16:31]
    ds_read_b128 v[48:51], v7 offset:36864
    s_mov_b64 exec, s[84:85]
    buffer_load_dwordx4 v1, s[4:7], s77 offen offset:2048 sc1 lds
    s_mov_b64 exec, -1
    s_waitcnt lgkmcnt(5)
    v_mfma_f32_32x32x16_bf16 v[16:31], a[124:127], v[60:63], v[16:31]
    ds_read_b128 v[52:55], v7 offset:37888
    s_mov_b64 exec, s[84:85]
    buffer_load_dwordx4 v1, s[4:7], s77 offen offset:3072 sc1 lds
    s_mov_b64 exec, -1
    s_waitcnt lgkmcnt(5)
    v_mfma_f32_32x32x16_bf16 v[16:31], a[128:131], v[32:35], v[16:31]
    ds_read_b128 v[56:59], v7 offset:38912
    s_add_u32 m0, s76, 12288
    s_add_u32 s77, s77, 4096
    s_mov_b64 exec, s[84:85]
    buffer_load_dwordx4 v1, s[4:7], s77 offen offset:0 sc1 lds
    s_mov_b64 exec, -1
    s_waitcnt lgkmcnt(5)
    v_mfma_f32_32x32x16_bf16 v[16:31], a[132:135], v[36:39], v[16:31]
    ds_read_b128 v[60:63], v7 offset:39936
    s_mov_b64 exec, s[84:85]
    buffer_load_dwordx4 v1, s[4:7], s77 offen offset:1024 sc1 lds
    s_mov_b64 exec, -1
    s_waitcnt lgkmcnt(5)
    v_mfma_f32_32x32x16_bf16 v[16:31], a[136:139], v[40:43], v[16:31]
    ds_read_b128 v[32:35], v7 offset:40960
    s_waitcnt vmcnt(14)
    s_barrier
    s_cmp_lg_u32 s60, 0
    s_cselect_b32 s72, s74, 0
    v_mov_b32 v14, 1
    s_waitcnt lgkmcnt(5)
    v_mfma_f32_32x32x16_bf16 v[16:31], a[140:143], v[44:47], v[16:31]
    ds_read_b128 v[36:39], v7 offset:41984
    s_mov_b64 exec, s[72:73]
    buffer_atomic_add v14, v5, s[4:7], s60 offen
    s_mov_b64 exec, -1
    s_mov_b32 s60, 0
    s_waitcnt lgkmcnt(5)
    v_mfma_f32_32x32x16_bf16 v[16:31], a[144:147], v[48:51], v[16:31]
    ds_read_b128 v[40:43], v7 offset:43008
    s_mul_i32 s40, s34, 2
    s_add_u32 s40, s40, s32
    s_min_u32 s40, s40, 63
    s_mul_i32 s40, s40, 6144
    s_waitcnt lgkmcnt(5)
    v_mfma_f32_32x32x16_bf16 v[16:31], a[148:151], v[52:55], v[16:31]
    ds_read_b128 v[44:47], v7 offset:44032
    s_add_u32 s65, s40, s53
    s_mul_i32 s40, s35, 2
    s_add_u32 s40, s40, s32
    s_min_u32 s40, s40, 63
    s_waitcnt lgkmcnt(5)
    v_mfma_f32_32x32x16_bf16 v[16:31], a[152:155], v[56:59], v[16:31]
    ds_read_b128 v[48:51], v7 offset:45056
    s_add_u32 s40, s40, 64
    s_mul_i32 s40, s40, 6144
    s_add_u32 s66, s40, s53
    s_waitcnt lgkmcnt(5)
    v_mfma_f32_32x32x16_bf16 v[16:31], a[156:159], v[60:63], v[16:31]
    ds_read_b128 v[52:55], v7 offset:46080
    buffer_load_dword v8, v5, s[4:7], s65 offen sc1
    buffer_load_dword v9, v5, s[4:7], s66 offen sc1
    s_waitcnt lgkmcnt(5)
    v_mfma_f32_32x32x16_bf16 v[16:31], a[160:163], v[32:35], v[16:31]
    ds_read_b128 v[56:59], v7 offset:47104
    s_waitcnt lgkmcnt(5)
    v_mfma_f32_32x32x16_bf16 v[16:31], a[164:167], v[36:39], v[16:31]
    ds_read_b128 v[60:63], v7 offset:48128
    s_waitcnt lgkmcnt(5)
    v_mfma_f32_32x32x16_bf16 v[16:31], a[168:171], v[40:43], v[16:31]
    ds_read_b128 v[32:35], v7 offset:49152
    s_waitcnt lgkmcnt(5)
    v_mfma_f32_32x32x16_bf16 v[16:31], a[172:175], v[44:47], v[16:31]
    ds_read_b128 v[36:39], v7 offset:50176
    s_waitcnt lgkmcnt(5)
    v_mfma_f32_32x32x16_bf16 v[16:31], a[176:179], v[48:51], v[16:31]
    ds_read_b128 v[40:43], v7 offset:51200
    s_waitcnt lgkmcnt(5)
    v_mfma_f32_32x32x16_bf16 v[16:31], a[180:183], v[52:55], v[16:31]
    ds_read_b128 v[44:47], v7 offset:52224
    s_waitcnt lgkmcnt(5)
    v_mfma_f32_32x32x16_bf16 v[16:31], a[184:187], v[56:59], v[16:31]
    ds_read_b128 v[48:51], v7 offset:53248
    s_waitcnt lgkmcnt(5)
    v_mfma_f32_32x32x16_bf16 v[16:31], a[188:191], v[60:63], v[16:31]
    ds_read_b128 v[52:55], v7 offset:54272
    s_waitcnt lgkmcnt(5)
    v_mfma_f32_32x32x16_bf16 v[16:31], a[192:195], v[32:35], v[16:31]
    ds_read_b128 v[56:59], v7 offset:55296
    s_waitcnt lgkmcnt(5)
    v_mfma_f32_32x32x16_bf16 v[16:31], a[196:199], v[36:39], v[16:31]
    ds_read_b128 v[60:63], v7 offset:56320
    s_waitcnt lgkmcnt(5)
    v_mfma_f32_32x32x16_bf16 v[16:31], a[200:203], v[40:43], v[16:31]
    s_waitcnt lgkmcnt(4)
    v_mfma_f32_32x32x16_bf16 v[16:31], a[204:207], v[44:47], v[16:31]
    s_waitcnt lgkmcnt(3)
    v_mfma_f32_32x32x16_bf16 v[16:31], a[208:211], v[48:51], v[16:31]
    s_waitcnt lgkmcnt(2)
    v_mfma_f32_32x32x16_bf16 v[16:31], a[212:215], v[52:55], v[16:31]
    s_mul_i32 s80, s37, 131072
    s_add_u32 s80, s80, 118489088
    s_lshl_b32 s44, s33, 16
    s_add_u32 s80, s80, s44
    s_waitcnt lgkmcnt(1)
    v_mfma_f32_32x32x16_bf16 v[16:31], a[216:219], v[56:59], v[16:31]
    s_lshl_b32 s44, s45, 9
    s_add_u32 s80, s80, s44
    s_lshl_b32 s44, s30, 7
    s_add_u32 s80, s80, s44
    s_waitcnt lgkmcnt(0)
    v_mfma_f32_32x32x16_bf16 v[16:31], a[220:223], v[60:63], v[16:31]
    s_nop 11
    v_mov_b64 v[80:81], v[16:17]
    v_mov_b64 v[82:83], v[18:19]
    v_mov_b64 v[84:85], v[20:21]
    v_mov_b64 v[86:87], v[22:23]
    v_mov_b64 v[88:89], v[24:25]
    v_mov_b64 v[90:91], v[26:27]
    v_mov_b64 v[92:93], v[28:29]
    v_mov_b64 v[94:95], v[30:31]
    s_add_u32 s43, s47, 5248
    s_mov_b32 s60, s43
    s_mov_b32 s78, s80
    s_mov_b64 s[86:87], -1
    ds_write_b128 v2, v[80:83]
    v_xor_b32 v10, 32, v2
    ds_write_b128 v10, v[84:87]
    s_nop 1
    v_xor_b32 v10, 64, v2
    ds_write_b128 v10, v[88:91]
    s_nop 1
    v_xor_b32 v10, 96, v2
    ds_write_b128 v10, v[92:95]
    s_waitcnt lgkmcnt(0)
    ds_read_b128 v[64:67], v3 offset:0
    ds_read_b128 v[68:71], v3 offset:1024
    ds_read_b128 v[72:75], v3 offset:2048
    ds_read_b128 v[76:79], v3 offset:3072
    s_mov_b32 s79, s78
    s_waitcnt lgkmcnt(3)
    buffer_store_dwordx4 v[64:67], v4, s[4:7], s79 offen sc1
    s_add_u32 s79, s79, 16384
    s_waitcnt lgkmcnt(2)
    buffer_store_dwordx4 v[68:71], v4, s[4:7], s79 offen sc1
    s_add_u32 s79, s79, 16384
    s_waitcnt lgkmcnt(1)
    buffer_store_dwordx4 v[72:75], v4, s[4:7], s79 offen sc1
    s_add_u32 s79, s79, 16384
    s_waitcnt lgkmcnt(0)
    buffer_store_dwordx4 v[76:79], v4, s[4:7], s79 offen sc1
    s_add_u32 s79, s79, 16384
    s_mov_b32 s83, 1
    s_cmp_eq_u32 s62, 0
    s_cbranch_scc0 s5nx_72
    s_mul_i32 s40, s34, 2
    s_add_u32 s40, s40, s32
    s_min_u32 s40, s40, 63
    s_mul_i32 s40, s40, 6144
    s_add_u32 s65, s40, s53
    s_mul_i32 s40, s35, 2
    s_add_u32 s40, s40, s32
    s_min_u32 s40, s40, 63
    s_add_u32 s40, s40, 64
    s_mul_i32 s40, s40, 6144
    s_add_u32 s66, s40, s53
    buffer_load_dword v8, v5, s[4:7], s65 offen sc1
    buffer_load_dword v9, v5, s[4:7], s66 offen sc1
    s_waitcnt vmcnt(2)
    s_barrier
    s_cmp_lg_u32 s60, 0
    s_cselect_b32 s72, s74, 0
    v_mov_b32 v14, 1
    s_mov_b64 exec, s[72:73]
    buffer_atomic_add v14, v5, s[4:7], s60 offen
    s_mov_b64 exec, -1
    s_mov_b32 s60, 0
    s_mov_b32 s78, 5505024
    s_mov_b64 s[86:87], 0
    s_mov_b32 s83, 2
    s_cmp_eq_u32 s62, 0
    s_cbranch_scc0 s5nx_72
    s_mov_b32 s83, 0
    s_cmp_eq_u32 s30, 0
    s_cbranch_scc0 s5q_78
    s_waitcnt vmcnt(1)
    v_readfirstlane_b32 s40, v8
    v_readfirstlane_b32 s41, v9
    s_nop 2
    s_cmp_ge_u32 s40, 7
    s_cselect_b32 s40, 1, 0
    s_cmp_lt_u32 s34, s38
    s_cselect_b32 s40, s40, 0
    s_cmp_ge_u32 s41, 7
    s_cselect_b32 s41, 2, 0
    s_cmp_lt_u32 s35, s38
    s_cselect_b32 s41, s41, 0
    s_cmp_lg_u32 s40, 0
    s_cselect_b32 s67, s40, s41
    s_add_u32 s42, s34, s35
    s_lshl_b32 s43, s38, 1
    s_cmp_ge_u32 s42, s43
    s_cselect_b32 s67, 3, s67
    v_mov_b32 v13, 163792
    v_mov_b32 v14, s67
    ds_write_b32 v13, v14
    s_waitcnt lgkmcnt(0)
s5q_78:
    s_barrier
    v_mov_b32 v13, 163792
    ds_read_b32 v14, v13
    s_waitcnt lgkmcnt(0)
    v_readfirstlane_b32 s67, v14
    s_nop 3
    s_cmp_lg_u32 s67, 0
    s_cbranch_scc1 s5q2_79
    s_barrier
    s_cmp_eq_u32 s30, 0
    s_cbranch_scc0 s5bp_80
    s_mul_i32 s40, s34, 2
    s_add_u32 s40, s40, s32
    s_min_u32 s40, s40, 63
    s_mul_i32 s40, s40, 6144
    s_add_u32 s65, s40, s53
    s_mul_i32 s40, s35, 2
    s_add_u32 s40, s40, s32
    s_min_u32 s40, s40, 63
    s_add_u32 s40, s40, 64
    s_mul_i32 s40, s40, 6144
    s_add_u32 s66, s40, s53
s5bpl_81:
    buffer_load_dword v8, v5, s[4:7], s65 offen sc1
    buffer_load_dword v9, v5, s[4:7], s66 offen sc1
    s_waitcnt vmcnt(0)
    v_readfirstlane_b32 s40, v8
    v_readfirstlane_b32 s41, v9
    s_nop 2
    s_cmp_ge_u32 s40, 7
    s_cselect_b32 s40, 1, 0
    s_cmp_lt_u32 s34, s38
    s_cselect_b32 s40, s40, 0
    s_cmp_ge_u32 s41, 7
    s_cselect_b32 s41, 2, 0
    s_cmp_lt_u32 s35, s38
    s_cselect_b32 s41, s41, 0
    s_cmp_lg_u32 s40, 0
    s_cselect_b32 s67, s40, s41
    s_add_u32 s42, s34, s35
    s_lshl_b32 s43, s38, 1
    s_cmp_ge_u32 s42, s43
    s_cselect_b32 s67, 3, s67
    s_cmp_lg_u32 s67, 0
    s_cbranch_scc1 s5bpd_82
    s_add_u32 s31, s31, 1
    s_cmp_gt_u32 s31, 300000
    s_cselect_b32 s67, 3, 0
    s_cbranch_scc1 s5bpd_82
    s_sleep 1
    s_branch s5bpl_81
s5bpd_82:
    v_mov_b32 v13, 163792
    v_mov_b32 v14, s67
    ds_write_b32 v13, v14
    s_waitcnt lgkmcnt(0)
s5bp_80:
    s_barrier
    v_mov_b32 v13, 163792
    ds_read_b32 v14, v13
    s_waitcnt lgkmcnt(0)
    v_readfirstlane_b32 s67, v14
    s_nop 4
s5q2_79:
    s_cmp_eq_u32 s67, 3
    s_cbranch_scc1 s5fin_73
    s_sub_u32 s56, s67, 1
    s_cmp_eq_u32 s56, 0
    s_cselect_b32 s40, s34, s35
    s_mul_i32 s57, s40, 2
    s_add_u32 s57, s57, s32
    s_xor_b32 s40, s56, 1
    s_add_u32 s34, s34, s40
    s_add_u32 s35, s35, s56
    s_lshl_b32 s40, s56, 6
    s_add_u32 s40, s40, s57
    s_mul_i32 s58, s40, 6144
    s_xor_b32 s68, s61, 65536
    s_mul_i32 s75, s57, 114688
    s_add_u32 s75, s75, 111149056
    s_add_u32 s75, s75, s54
    s_mov_b32 s64, s75
    s_mul_i32 s76, s30, 14336
    s_add_u32 s77, s64, s76
    s_add_u32 s76, s76, s68
    s_add_u32 m0, s76, 0
    s_nop 0
    buffer_load_dwordx4 v1, s[4:7], s77 offen offset:0 sc1 lds
    buffer_load_dwordx4 v1, s[4:7], s77 offen offset:1024 sc1 lds
    buffer_load_dwordx4 v1, s[4:7], s77 offen offset:2048 sc1 lds
    buffer_load_dwordx4 v1, s[4:7], s77 offen offset:3072 sc1 lds
    s_add_u32 m0, s76, 4096
    s_add_u32 s77, s77, 4096
    buffer_load_dwordx4 v1, s[4:7], s77 offen offset:0 sc1 lds
    buffer_load_dwordx4 v1, s[4:7], s77 offen offset:1024 sc1 lds
    buffer_load_dwordx4 v1, s[4:7], s77 offen offset:2048 sc1 lds
    buffer_load_dwordx4 v1, s[4:7], s77 offen offset:3072 sc1 lds
    s_add_u32 m0, s76, 8192
    s_add_u32 s77, s77, 4096
    buffer_load_dwordx4 v1, s[4:7], s77 offen offset:0 sc1 lds
    buffer_load_dwordx4 v1, s[4:7], s77 offen offset:1024 sc1 lds
    buffer_load_dwordx4 v1, s[4:7], s77 offen offset:2048 sc1 lds
    buffer_load_dwordx4 v1, s[4:7], s77 offen offset:3072 sc1 lds
    s_add_u32 m0, s76, 12288
    s_add_u32 s77, s77, 4096
    buffer_load_dwordx4 v1, s[4:7], s77 offen offset:0 sc1 lds
    buffer_load_dwordx4 v1, s[4:7], s77 offen offset:1024 sc1 lds
    s_mul_i32 s40, s34, 2
    s_add_u32 s40, s40, s32
    s_min_u32 s40, s40, 63
    s_mul_i32 s40, s40, 6144
    s_add_u32 s65, s40, s53
    s_mul_i32 s40, s35, 2
    s_add_u32 s40, s40, s32
    s_min_u32 s40, s40, 63
    s_add_u32 s40, s40, 64
    s_mul_i32 s40, s40, 6144
    s_add_u32 s66, s40, s53
    buffer_load_dword v8, v5, s[4:7], s65 offen sc1
    buffer_load_dword v9, v5, s[4:7], s66 offen sc1
s5nx_72:
    s_mov_b32 s36, s56
    s_mov_b32 s37, s57
    s_mov_b32 s47, s58
    s_mov_b32 s61, s68
    s_mov_b32 s71, s75
    v_xor_b32 v7, 0x10000, v7
    s_nop 0
    s_branch s5job_69
s5fin_73:
    s_waitcnt vmcnt(0)
    s_branch L_exit
L_s4j:
    s_mov_b32 s32, s52
    s_mov_b32 s34, 0
    s_mov_b32 s35, 0
    s_mov_b32 s38, 32
    s_mov_b32 s39, 0
    s_mov_b32 s33, s53
    s_load_dwordx2 s[12:13], s[0:1], 64
    s_load_dwordx2 s[16:17], s[0:1], 72
    s_waitcnt vmcnt(0)
    s_barrier
    s_cmp_eq_u32 s30, 0
    s_cbranch_scc0 sinit_83
    s_mov_b64 exec, 1
    v_mov_b32 v13, 1
    v_mov_b32 v14, 64
    buffer_atomic_add v13, v14, s[8:11], 0 offen
    s_mov_b64 exec, -1
sinit_83:
    s_waitcnt lgkmcnt(0)
    s_mov_b32 s14, 0x1c0000
    s_mov_b32 s15, 0x20000
    s_mov_b32 s18, 0x1c0000
    s_mov_b32 s19, 0x20000
    s_cmp_eq_u32 s30, 0
    s_cbranch_scc0 gwb_84
    v_mov_b32 v14, 192
    s_nop 1
wd_85:
    buffer_load_dword v13, v14, s[8:11], 0 offen sc1
    s_waitcnt vmcnt(0)
    v_cmp_le_u32 vcc, 8, v13
    s_nop 3
    s_cbranch_vccnz wdd_86
    s_add_u32 s31, s31, 1
    s_cmp_gt_u32 s31, 300000
    s_cbranch_scc1 wdd_86
    s_sleep 16
    s_branch wd_85
wdd_86:
gwb_84:
    s_barrier
    s_lshl_b32 s51, s30, 15
    v_lshrrev_b32 v13, 5, v0
    v_lshlrev_b32 v13, 3, v13
    v_bfe_u32 v14, v0, 2, 2
    v_add_u32 v13, v13, v14
    v_lshlrev_b32 v13, 6, v13
    v_bfe_u32 v14, v0, 4, 1
    v_lshl_add_u32 v13, v14, 5, v13
    v_and_b32 v14, 3, v0
    v_lshl_add_u32 v13, v14, 3, v13
    v_add_u32 v21, s51, v13
    v_lshrrev_b32 v13, 2, v0
    s_movk_i32 s40, 3584
    v_mul_lo_u32 v13, s40, v13
    v_and_b32 v14, 3, v0
    v_lshl_add_u32 v20, v14, 4, v13
    s_lshl_b32 s52, s33, 8
    s_lshl_b32 s40, s30, 6
    s_add_u32 s52, s52, s40
    s_waitcnt vmcnt(0)
    s_add_u32 s50, s52, 0
    s_add_u32 m0, s51, 0
    s_nop 0
    buffer_load_dwordx4 v20, s[12:15], s50 offen lds
    s_add_u32 s50, s52, 57344
    s_add_u32 m0, s51, 1024
    s_nop 0
    buffer_load_dwordx4 v20, s[12:15], s50 offen lds
    s_add_u32 s50, s52, 114688
    s_add_u32 m0, s51, 2048
    s_nop 0
    buffer_load_dwordx4 v20, s[12:15], s50 offen lds
    s_add_u32 s50, s52, 172032
    s_add_u32 m0, s51, 3072
    s_nop 0
    buffer_load_dwordx4 v20, s[12:15], s50 offen lds
    s_add_u32 s50, s52, 229376
    s_add_u32 m0, s51, 4096
    s_nop 0
    buffer_load_dwordx4 v20, s[12:15], s50 offen lds
    s_add_u32 s50, s52, 286720
    s_add_u32 m0, s51, 5120
    s_nop 0
    buffer_load_dwordx4 v20, s[12:15], s50 offen lds
    s_add_u32 s50, s52, 344064
    s_add_u32 m0, s51, 6144
    s_nop 0
    buffer_load_dwordx4 v20, s[12:15], s50 offen lds
    s_add_u32 s50, s52, 401408
    s_add_u32 m0, s51, 7168
    s_nop 0
    buffer_load_dwordx4 v20, s[12:15], s50 offen lds
    s_add_u32 s50, s52, 458752
    s_add_u32 m0, s51, 8192
    s_nop 0
    buffer_load_dwordx4 v20, s[12:15], s50 offen lds
    s_add_u32 s50, s52, 516096
    s_add_u32 m0, s51, 9216
    s_nop 0
    buffer_load_dwordx4 v20, s[12:15], s50 offen lds
    s_add_u32 s50, s52, 573440
    s_add_u32 m0, s51, 10240
    s_nop 0
    buffer_load_dwordx4 v20, s[12:15], s50 offen lds
    s_add_u32 s50, s52, 630784
    s_add_u32 m0, s51, 11264
    s_nop 0
    buffer_load_dwordx4 v20, s[12:15], s50 offen lds
    s_add_u32 s50, s52, 688128
    s_add_u32 m0, s51, 12288
    s_nop 0
    buffer_load_dwordx4 v20, s[12:15], s50 offen lds
    s_add_u32 s50, s52, 745472
    s_add_u32 m0, s51, 13312
    s_nop 0
    buffer_load_dwordx4 v20, s[12:15], s50 offen lds
    s_add_u32 s50, s52, 802816
    s_add_u32 m0, s51, 14336
    s_nop 0
    buffer_load_dwordx4 v20, s[12:15], s50 offen lds
    s_add_u32 s50, s52, 860160
    s_add_u32 m0, s51, 15360
    s_nop 0
    buffer_load_dwordx4 v20, s[12:15], s50 offen lds
    s_add_u32 s50, s52, 917504
    s_add_u32 m0, s51, 16384
    s_nop 0
    buffer_load_dwordx4 v20, s[12:15], s50 offen lds
    s_add_u32 s50, s52, 974848
    s_add_u32 m0, s51, 17408
    s_nop 0
    buffer_load_dwordx4 v20, s[12:15], s50 offen lds
    s_add_u32 s50, s52, 1032192
    s_add_u32 m0, s51, 18432
    s_nop 0
    buffer_load_dwordx4 v20, s[12:15], s50 offen lds
    s_add_u32 s50, s52, 1089536
    s_add_u32 m0, s51, 19456
    s_nop 0
    buffer_load_dwordx4 v20, s[12:15], s50 offen lds
    s_add_u32 s50, s52, 1146880
    s_add_u32 m0, s51, 20480
    s_nop 0
    buffer_load_dwordx4 v20, s[12:15], s50 offen lds
    s_add_u32 s50, s52, 1204224
    s_add_u32 m0, s51, 21504
    s_nop 0
    buffer_load_dwordx4 v20, s[12:15], s50 offen lds
    s_add_u32 s50, s52, 1261568
    s_add_u32 m0, s51, 22528
    s_nop 0
    buffer_load_dwordx4 v20, s[12:15], s50 offen lds
    s_add_u32 s50, s52, 1318912
    s_add_u32 m0, s51, 23552
    s_nop 0
    buffer_load_dwordx4 v20, s[12:15], s50 offen lds
    s_add_u32 s50, s52, 1376256
    s_add_u32 m0, s51, 24576
    s_nop 0
    buffer_load_dwordx4 v20, s[12:15], s50 offen lds
    s_add_u32 s50, s52, 1433600
    s_add_u32 m0, s51, 25600
    s_nop 0
    buffer_load_dwordx4 v20, s[12:15], s50 offen lds
    s_add_u32 s50, s52, 1490944
    s_add_u32 m0, s51, 26624
    s_nop 0
    buffer_load_dwordx4 v20, s[12:15], s50 offen lds
    s_add_u32 s50, s52, 1548288
    s_add_u32 m0, s51, 27648
    s_nop 0
    buffer_load_dwordx4 v20, s[12:15], s50 offen lds
    s_add_u32 s50, s52, 1605632
    s_add_u32 m0, s51, 28672
    s_nop 0
    buffer_load_dwordx4 v20, s[12:15], s50 offen lds
    s_add_u32 s50, s52, 1662976
    s_add_u32 m0, s51, 29696
    s_nop 0
    buffer_load_dwordx4 v20, s[12:15], s50 offen lds
    s_add_u32 s50, s52, 1720320
    s_add_u32 m0, s51, 30720
    s_nop 0
    buffer_load_dwordx4 v20, s[12:15], s50 offen lds
    s_add_u32 s50, s52, 1777664
    s_add_u32 m0, s51, 31744
    s_nop 0
    buffer_load_dwordx4 v20, s[12:15], s50 offen lds
    s_waitcnt vmcnt(28)
    ds_read_b64_tr_b16 a[0:1], v21 offset:0
    ds_read_b64_tr_b16 a[2:3], v21 offset:256
    ds_read_b64_tr_b16 a[4:5], v21 offset:1024
    ds_read_b64_tr_b16 a[6:7], v21 offset:1280
    ds_read_b64_tr_b16 a[8:9], v21 offset:2048
    ds_read_b64_tr_b16 a[10:11], v21 offset:2304
    ds_read_b64_tr_b16 a[12:13], v21 offset:3072
    ds_read_b64_tr_b16 a[14:15], v21 offset:3328
    s_waitcnt lgkmcnt(0)
    s_add_u32 s50, s52, 0
    s_add_u32 m0, s51, 0
    s_nop 0
    buffer_load_dwordx4 v20, s[16:19], s50 offen lds
    s_add_u32 s50, s52, 57344
    s_add_u32 m0, s51, 1024
    s_nop 0
    buffer_load_dwordx4 v20, s[16:19], s50 offen lds
    s_add_u32 s50, s52, 114688
    s_add_u32 m0, s51, 2048
    s_nop 0
    buffer_load_dwordx4 v20, s[16:19], s50 offen lds
    s_add_u32 s50, s52, 172032
    s_add_u32 m0, s51, 3072
    s_nop 0
    buffer_load_dwordx4 v20, s[16:19], s50 offen lds
    s_waitcnt vmcnt(28)
    ds_read_b64_tr_b16 a[16:17], v21 offset:4096
    ds_read_b64_tr_b16 a[18:19], v21 offset:4352
    ds_read_b64_tr_b16 a[20:21], v21 offset:5120
    ds_read_b64_tr_b16 a[22:23], v21 offset:5376
    ds_read_b64_tr_b16 a[24:25], v21 offset:6144
    ds_read_b64_tr_b16 a[26:27], v21 offset:6400
    ds_read_b64_tr_b16 a[28:29], v21 offset:7168
    ds_read_b64_tr_b16 a[30:31], v21 offset:7424
    s_waitcnt lgkmcnt(0)
    s_add_u32 s50, s52, 229376
    s_add_u32 m0, s51, 4096
    s_nop 0
    buffer_load_dwordx4 v20, s[16:19], s50 offen lds
    s_add_u32 s50, s52, 286720
    s_add_u32 m0, s51, 5120
    s_nop 0
    buffer_load_dwordx4 v20, s[16:19], s50 offen lds
    s_add_u32 s50, s52, 344064
    s_add_u32 m0, s51, 6144
    s_nop 0
    buffer_load_dwordx4 v20, s[16:19], s50 offen lds
    s_add_u32 s50, s52, 401408
    s_add_u32 m0, s51, 7168
    s_nop 0
    buffer_load_dwordx4 v20, s[16:19], s50 offen lds
    s_waitcnt vmcnt(28)
    ds_read_b64_tr_b16 a[32:33], v21 offset:8192
    ds_read_b64_tr_b16 a[34:35], v21 offset:8448
    ds_read_b64_tr_b16 a[36:37], v21 offset:9216
    ds_read_b64_tr_b16 a[38:39], v21 offset:9472
    ds_read_b64_tr_b16 a[40:41], v21 offset:10240
    ds_read_b64_tr_b16 a[42:43], v21 offset:10496
    ds_read_b64_tr_b16 a[44:45], v21 offset:11264
    ds_read_b64_tr_b16 a[46:47], v21 offset:11520
    s_waitcnt lgkmcnt(0)
    s_add_u32 s50, s52, 458752
    s_add_u32 m0, s51, 8192
    s_nop 0
    buffer_load_dwordx4 v20, s[16:19], s50 offen lds
    s_add_u32 s50, s52, 516096
    s_add_u32 m0, s51, 9216
    s_nop 0
    buffer_load_dwordx4 v20, s[16:19], s50 offen lds
    s_add_u32 s50, s52, 573440
    s_add_u32 m0, s51, 10240
    s_nop 0
    buffer_load_dwordx4 v20, s[16:19], s50 offen lds
    s_add_u32 s50, s52, 630784
    s_add_u32 m0, s51, 11264
    s_nop 0
    buffer_load_dwordx4 v20, s[16:19], s50 offen lds
    s_waitcnt vmcnt(28)
    ds_read_b64_tr_b16 a[48:49], v21 offset:12288
    ds_read_b64_tr_b16 a[50:51], v21 offset:12544
    ds_read_b64_tr_b16 a[52:53], v21 offset:13312
    ds_read_b64_tr_b16 a[54:55], v21 offset:13568
    ds_read_b64_tr_b16 a[56:57], v21 offset:14336
    ds_read_b64_tr_b16 a[58:59], v21 offset:14592
    ds_read_b64_tr_b16 a[60:61], v21 offset:15360
    ds_read_b64_tr_b16 a[62:63], v21 offset:15616
    s_waitcnt lgkmcnt(0)
    s_add_u32 s50, s52, 688128
    s_add_u32 m0, s51, 12288
    s_nop 0
    buffer_load_dwordx4 v20, s[16:19], s50 offen lds
    s_add_u32 s50, s52, 745472
    s_add_u32 m0, s51, 13312
    s_nop 0
    buffer_load_dwordx4 v20, s[16:19], s50 offen lds
    s_add_u32 s50, s52, 802816
    s_add_u32 m0, s51, 14336
    s_nop 0
    buffer_load_dwordx4 v20, s[16:19], s50 offen lds
    s_add_u32 s50, s52, 860160
    s_add_u32 m0, s51, 15360
    s_nop 0
    buffer_load_dwordx4 v20, s[16:19], s50 offen lds
    s_waitcnt vmcnt(28)
    ds_read_b64_tr_b16 a[64:65], v21 offset:16384
    ds_read_b64_tr_b16 a[66:67], v21 offset:16640
    ds_read_b64_tr_b16 a[68:69], v21 offset:17408
    ds_read_b64_tr_b16 a[70:71], v21 offset:17664
    ds_read_b64_tr_b16 a[72:73], v21 offset:18432
    ds_read_b64_tr_b16 a[74:75], v21 offset:18688
    ds_read_b64_tr_b16 a[76:77], v21 offset:19456
    ds_read_b64_tr_b16 a[78:79], v21 offset:19712
    s_waitcnt lgkmcnt(0)
    s_add_u32 s50, s52, 917504
    s_add_u32 m0, s51, 16384
    s_nop 0
    buffer_load_dwordx4 v20, s[16:19], s50 offen lds
    s_add_u32 s50, s52, 974848
    s_add_u32 m0, s51, 17408
    s_nop 0
    buffer_load_dwordx4 v20, s[16:19], s50 offen lds
    s_add_u32 s50, s52, 1032192
    s_add_u32 m0, s51, 18432
    s_nop 0
    buffer_load_dwordx4 v20, s[16:19], s50 offen lds
    s_add_u32 s50, s52, 1089536
    s_add_u32 m0, s51, 19456
    s_nop 0
    buffer_load_dwordx4 v20, s[16:19], s50 offen lds
    s_waitcnt vmcnt(28)
    ds_read_b64_tr_b16 a[80:81], v21 offset:20480
    ds_read_b64_tr_b16 a[82:83], v21 offset:20736
    ds_read_b64_tr_b16 a[84:85], v21 offset:21504
    ds_read_b64_tr_b16 a[86:87], v21 offset:21760
    ds_read_b64_tr_b16 a[88:89], v21 offset:22528
    ds_read_b64_tr_b16 a[90:91], v21 offset:22784
    ds_read_b64_tr_b16 a[92:93], v21 offset:23552
    ds_read_b64_tr_b16 a[94:95], v21 offset:23808
    s_waitcnt lgkmcnt(0)
    s_add_u32 s50, s52, 1146880
    s_add_u32 m0, s51, 20480
    s_nop 0
    buffer_load_dwordx4 v20, s[16:19], s50 offen lds
    s_add_u32 s50, s52, 1204224
    s_add_u32 m0, s51, 21504
    s_nop 0
    buffer_load_dwordx4 v20, s[16:19], s50 offen lds
    s_add_u32 s50, s52, 1261568
    s_add_u32 m0, s51, 22528
    s_nop 0
    buffer_load_dwordx4 v20, s[16:19], s50 offen lds
    s_add_u32 s50, s52, 1318912
    s_add_u32 m0, s51, 23552
    s_nop 0
    buffer_load_dwordx4 v20, s[16:19], s50 offen lds
    s_waitcnt vmcnt(28)
    ds_read_b64_tr_b16 a[96:97], v21 offset:24576
    ds_read_b64_tr_b16 a[98:99], v21 offset:24832
    ds_read_b64_tr_b16 a[100:101], v21 offset:25600
    ds_read_b64_tr_b16 a[102:103], v21 offset:25856
    ds_read_b64_tr_b16 a[104:105], v21 offset:26624
    ds_read_b64_tr_b16 a[106:107], v21 offset:26880
    ds_read_b64_tr_b16 a[108:109], v21 offset:27648
    ds_read_b64_tr_b16 a[110:111], v21 offset:27904
    s_waitcnt lgkmcnt(0)
    s_add_u32 s50, s52, 1376256
    s_add_u32 m0, s51, 24576
    s_nop 0
    buffer_load_dwordx4 v20, s[16:19], s50 offen lds
    s_add_u32 s50, s52, 1433600
    s_add_u32 m0, s51, 25600
    s_nop 0
    buffer_load_dwordx4 v20, s[16:19], s50 offen lds
    s_add_u32 s50, s52, 1490944
    s_add_u32 m0, s51, 26624
    s_nop 0
    buffer_load_dwordx4 v20, s[16:19], s50 offen lds
    s_add_u32 s50, s52, 1548288
    s_add_u32 m0, s51, 27648
    s_nop 0
    buffer_load_dwordx4 v20, s[16:19], s50 offen lds
    s_waitcnt vmcnt(28)
    ds_read_b64_tr_b16 a[112:113], v21 offset:28672
    ds_read_b64_tr_b16 a[114:115], v21 offset:28928
    ds_read_b64_tr_b16 a[116:117], v21 offset:29696
    ds_read_b64_tr_b16 a[118:119], v21 offset:29952
    ds_read_b64_tr_b16 a[120:121], v21 offset:30720
    ds_read_b64_tr_b16 a[122:123], v21 offset:30976
    ds_read_b64_tr_b16 a[124:125], v21 offset:31744
    ds_read_b64_tr_b16 a[126:127], v21 offset:32000
    s_waitcnt lgkmcnt(0)
    s_add_u32 s50, s52, 1605632
    s_add_u32 m0, s51, 28672
    s_nop 0
    buffer_load_dwordx4 v20, s[16:19], s50 offen lds
    s_add_u32 s50, s52, 1662976
    s_add_u32 m0, s51, 29696
    s_nop 0
    buffer_load_dwordx4 v20, s[16:19], s50 offen lds
    s_add_u32 s50, s52, 1720320
    s_add_u32 m0, s51, 30720
    s_nop 0
    buffer_load_dwordx4 v20, s[16:19], s50 offen lds
    s_add_u32 s50, s52, 1777664
    s_add_u32 m0, s51, 31744
    s_nop 0
    buffer_load_dwordx4 v20, s[16:19], s50 offen lds
    s_waitcnt vmcnt(28)
    ds_read_b64_tr_b16 a[128:129], v21 offset:0
    ds_read_b64_tr_b16 a[130:131], v21 offset:256
    ds_read_b64_tr_b16 a[132:133], v21 offset:1024
    ds_read_b64_tr_b16 a[134:135], v21 offset:1280
    ds_read_b64_tr_b16 a[136:137], v21 offset:2048
    ds_read_b64_tr_b16 a[138:139], v21 offset:2304
    ds_read_b64_tr_b16 a[140:141], v21 offset:3072
    ds_read_b64_tr_b16 a[142:143], v21 offset:3328
    s_waitcnt lgkmcnt(0)
    s_waitcnt vmcnt(24)
    ds_read_b64_tr_b16 a[144:145], v21 offset:4096
    ds_read_b64_tr_b16 a[146:147], v21 offset:4352
    ds_read_b64_tr_b16 a[148:149], v21 offset:5120
    ds_read_b64_tr_b16 a[150:151], v21 offset:5376
    ds_read_b64_tr_b16 a[152:153], v21 offset:6144
    ds_read_b64_tr_b16 a[154:155], v21 offset:6400
    ds_read_b64_tr_b16 a[156:157], v21 offset:7168
    ds_read_b64_tr_b16 a[158:159], v21 offset:7424
    s_waitcnt lgkmcnt(0)
    s_waitcnt vmcnt(20)
    ds_read_b64_tr_b16 a[160:161], v21 offset:8192
    ds_read_b64_tr_b16 a[162:163], v21 offset:8448
    ds_read_b64_tr_b16 a[164:165], v21 offset:9216
    ds_read_b64_tr_b16 a[166:167], v21 offset:9472
    ds_read_b64_tr_b16 a[168:169], v21 offset:10240
    ds_read_b64_tr_b16 a[170:171], v21 offset:10496
    ds_read_b64_tr_b16 a[172:173], v21 offset:11264
    ds_read_b64_tr_b16 a[174:175], v21 offset:11520
    s_waitcnt lgkmcnt(0)
    s_waitcnt vmcnt(16)
    ds_read_b64_tr_b16 a[176:177], v21 offset:12288
    ds_read_b64_tr_b16 a[178:179], v21 offset:12544
    ds_read_b64_tr_b16 a[180:181], v21 offset:13312
    ds_read_b64_tr_b16 a[182:183], v21 offset:13568
    ds_read_b64_tr_b16 a[184:185], v21 offset:14336
    ds_read_b64_tr_b16 a[186:187], v21 offset:14592
    ds_read_b64_tr_b16 a[188:189], v21 offset:15360
    ds_read_b64_tr_b16 a[190:191], v21 offset:15616
    s_waitcnt lgkmcnt(0)
    s_waitcnt vmcnt(12)
    ds_read_b64_tr_b16 a[192:193], v21 offset:16384
    ds_read_b64_tr_b16 a[194:195], v21 offset:16640
    ds_read_b64_tr_b16 a[196:197], v21 offset:17408
    ds_read_b64_tr_b16 a[198:199], v21 offset:17664
    ds_read_b64_tr_b16 a[200:201], v21 offset:18432
    ds_read_b64_tr_b16 a[202:203], v21 offset:18688
    ds_read_b64_tr_b16 a[204:205], v21 offset:19456
    ds_read_b64_tr_b16 a[206:207], v21 offset:19712
    s_waitcnt lgkmcnt(0)
    s_waitcnt vmcnt(8)
    ds_read_b64_tr_b16 a[208:209], v21 offset:20480
    ds_read_b64_tr_b16 a[210:211], v21 offset:20736
    ds_read_b64_tr_b16 a[212:213], v21 offset:21504
    ds_read_b64_tr_b16 a[214:215], v21 offset:21760
    ds_read_b64_tr_b16 a[216:217], v21 offset:22528
    ds_read_b64_tr_b16 a[218:219], v21 offset:22784
    ds_read_b64_tr_b16 a[220:221], v21 offset:23552
    ds_read_b64_tr_b16 a[222:223], v21 offset:23808
    s_waitcnt lgkmcnt(0)
    s_waitcnt vmcnt(4)
    ds_read_b64_tr_b16 a[224:225], v21 offset:24576
    ds_read_b64_tr_b16 a[226:227], v21 offset:24832
    ds_read_b64_tr_b16 a[228:229], v21 offset:25600
    ds_read_b64_tr_b16 a[230:231], v21 offset:25856
    ds_read_b64_tr_b16 a[232:233], v21 offset:26624
    ds_read_b64_tr_b16 a[234:235], v21 offset:26880
    ds_read_b64_tr_b16 a[236:237], v21 offset:27648
    ds_read_b64_tr_b16 a[238:239], v21 offset:27904
    s_waitcnt lgkmcnt(0)
    s_waitcnt vmcnt(0)
    ds_read_b64_tr_b16 a[240:241], v21 offset:28672
    ds_read_b64_tr_b16 a[242:243], v21 offset:28928
    ds_read_b64_tr_b16 a[244:245], v21 offset:29696
    ds_read_b64_tr_b16 a[246:247], v21 offset:29952
    ds_read_b64_tr_b16 a[248:249], v21 offset:30720
    ds_read_b64_tr_b16 a[250:251], v21 offset:30976
    ds_read_b64_tr_b16 a[252:253], v21 offset:31744
    ds_read_b64_tr_b16 a[254:255], v21 offset:32000
    s_waitcnt lgkmcnt(0)
    v_and_b32 v13, 31, v0
    v_lshrrev_b32 v14, 5, v0
    v_and_b32 v15, 15, v0
    v_add_u32 v2, 0, v14
    v_xor_b32 v2, v2, v15
    v_lshlrev_b32 v2, 4, v2
    v_lshl_add_u32 v2, v13, 8, v2
    v_add_u32 v3, 2, v14
    v_xor_b32 v3, v3, v15
    v_lshlrev_b32 v3, 4, v3
    v_lshl_add_u32 v3, v13, 8, v3
    v_add_u32 v4, 4, v14
    v_xor_b32 v4, v4, v15
    v_lshlrev_b32 v4, 4, v4
    v_lshl_add_u32 v4, v13, 8, v4
    v_add_u32 v5, 6, v14
    v_xor_b32 v5, v5, v15
    v_lshlrev_b32 v5, 4, v5
    v_lshl_add_u32 v5, v13, 8, v5
    v_add_u32 v6, 8, v14
    v_xor_b32 v6, v6, v15
    v_lshlrev_b32 v6, 4, v6
    v_lshl_add_u32 v6, v13, 8, v6
    v_add_u32 v7, 10, v14
    v_xor_b32 v7, v7, v15
    v_lshlrev_b32 v7, 4, v7
    v_lshl_add_u32 v7, v13, 8, v7
    v_add_u32 v8, 12, v14
    v_xor_b32 v8, v8, v15
    v_lshlrev_b32 v8, 4, v8
    v_lshl_add_u32 v8, v13, 8, v8
    v_add_u32 v9, 14, v14
    v_xor_b32 v9, v9, v15
    v_lshlrev_b32 v9, 4, v9
    v_lshl_add_u32 v9, v13, 8, v9
    v_lshrrev_b32 v13, 4, v0
    v_add_u32 v13, 0, v13
    s_lshl_b32 s40, s30, 3
    v_add_u32 v14, s40, v13
    v_and_b32 v14, 15, v14
    v_xor_b32 v14, v14, v15
    v_lshlrev_b32 v14, 4, v14
    v_lshl_add_u32 v10, v13, 10, v14
    v_lshrrev_b32 v13, 4, v0
    v_add_u32 v13, 4, v13
    s_lshl_b32 s40, s30, 3
    v_add_u32 v14, s40, v13
    v_and_b32 v14, 15, v14
    v_xor_b32 v14, v14, v15
    v_lshlrev_b32 v14, 4, v14
    v_lshl_add_u32 v11, v13, 10, v14
    v_lshlrev_b32 v12, 4, v0
    v_mov_b32 v1, 0
    s_mov_b32 s55, 0xbfb8aa3b
    s_cmp_eq_u32 s30, 0
    s_cbranch_scc0 winitb_87
    v_mov_b32 v14, 64
    s_nop 1
wd_88:
    buffer_load_dword v13, v14, s[8:11], 0 offen sc1
    s_waitcnt vmcnt(0)
    v_cmp_le_u32 vcc, 0x80, v13
    s_nop 3
    s_cbranch_vccnz wdd_89
    s_add_u32 s31, s31, 1
    s_cmp_gt_u32 s31, 300000
    s_cbranch_scc1 wdd_89
    s_sleep 6
    s_branch wd_88
wdd_89:
winitb_87:
    s_barrier
    s_barrier
    s_mov_b32 s60, 0
    s_mov_b32 s81, 0
    s_mov_b32 s78, 5505024
    s_mov_b64 s[86:87], 0
    s_mov_b32 s61, 0
    s_cmp_eq_u32 s30, 0
    s_cselect_b32 s74, 1, 0
    s_mov_b32 s73, 0
    s_cmp_eq_u32 s30, 0
    s_cbranch_scc0 s4bp_95
    s_mul_i32 s40, s34, 2
    s_add_u32 s40, s40, s32
    s_min_u32 s40, s40, 63
    s_mul_i32 s40, s40, 6144
    s_add_u32 s65, s40, 4864
    s_mul_i32 s40, s35, 2
    s_add_u32 s40, s40, s32
    s_min_u32 s40, s40, 63
    s_add_u32 s40, s40, 64
    s_mul_i32 s40, s40, 6144
    s_add_u32 s66, s40, 4864
s4bpl_96:
    buffer_load_dword v124, v1, s[4:7], s65 offen sc1
    buffer_load_dword v125, v1, s[4:7], s66 offen sc1
    s_waitcnt vmcnt(0)
    v_readfirstlane_b32 s40, v124
    v_readfirstlane_b32 s41, v125
    s_nop 2
    s_cmp_ge_u32 s40, 8
    s_cselect_b32 s40, 1, 0
    s_cmp_lt_u32 s34, s38
    s_cselect_b32 s40, s40, 0
    s_cmp_ge_u32 s41, 8
    s_cselect_b32 s41, 2, 0
    s_cmp_lt_u32 s35, s38
    s_cselect_b32 s41, s41, 0
    s_cmp_lg_u32 s40, 0
    s_cselect_b32 s67, s40, s41
    s_add_u32 s42, s34, s35
    s_lshl_b32 s43, s38, 1
    s_cmp_ge_u32 s42, s43
    s_cselect_b32 s67, 3, s67
    s_cmp_lg_u32 s67, 0
    s_cbranch_scc1 s4bpd_97
    s_add_u32 s31, s31, 1
    s_cmp_gt_u32 s31, 300000
    s_cselect_b32 s67, 3, 0
    s_cbranch_scc1 s4bpd_97
    s_sleep 1
    s_branch s4bpl_96
s4bpd_97:
    v_mov_b32 v13, 163792
    v_mov_b32 v14, s67
    ds_write_b32 v13, v14
    s_waitcnt lgkmcnt(0)
s4bp_95:
    s_barrier
    v_mov_b32 v13, 163792
    ds_read_b32 v14, v13
    s_waitcnt lgkmcnt(0)
    v_readfirstlane_b32 s67, v14
    s_nop 3
    s_cmp_eq_u32 s67, 3
    s_cbranch_scc1 s4fin_94
    s_sub_u32 s36, s67, 1
    s_cmp_eq_u32 s36, 0
    s_cselect_b32 s40, s34, s35
    s_mul_i32 s37, s40, 2
    s_add_u32 s37, s37, s32
    s_xor_b32 s40, s36, 1
    s_add_u32 s34, s34, s40
    s_add_u32 s35, s35, s36
    s_lshl_b32 s40, s36, 6
    s_add_u32 s40, s40, s37
    s_mul_i32 s47, s40, 6144
    s_mul_i32 s71, s37, 32768
    s_add_u32 s71, s71, 109051904
    s_lshl_b32 s77, s30, 13
    s_add_u32 s77, s77, s71
    s_lshl_b32 s76, s30, 11
    s_add_u32 s76, s76, s61
    s_add_u32 m0, s76, 0
    s_nop 0
    buffer_load_dwordx4 v10, s[4:7], s77 offen sc1 lds
    s_add_u32 m0, s76, 1024
    s_nop 0
    buffer_load_dwordx4 v11, s[4:7], s77 offen sc1 lds
    s_add_u32 s77, s77, 256
    s_add_u32 m0, s76, 8192
    s_nop 0
    buffer_load_dwordx4 v10, s[4:7], s77 offen sc1 lds
    s_add_u32 m0, s76, 9216
    s_nop 0
    buffer_load_dwordx4 v11, s[4:7], s77 offen sc1 lds
    s_add_u32 s77, s77, 256
    s_add_u32 m0, s76, 16384
    s_nop 0
    buffer_load_dwordx4 v10, s[4:7], s77 offen sc1 lds
    s_add_u32 m0, s76, 17408
    s_nop 0
    buffer_load_dwordx4 v11, s[4:7], s77 offen sc1 lds
    s_add_u32 s77, s77, 256
    s_add_u32 m0, s76, 24576
    s_nop 0
    buffer_load_dwordx4 v10, s[4:7], s77 offen sc1 lds
    s_add_u32 m0, s76, 25600
    s_nop 0
    buffer_load_dwordx4 v11, s[4:7], s77 offen sc1 lds
    s_mul_i32 s40, s34, 2
    s_add_u32 s40, s40, s32
    s_min_u32 s40, s40, 63
    s_mul_i32 s40, s40, 6144
    s_add_u32 s65, s40, 4864
    s_mul_i32 s40, s35, 2
    s_add_u32 s40, s40, s32
    s_min_u32 s40, s40, 63
    s_add_u32 s40, s40, 64
    s_mul_i32 s40, s40, 6144
    s_add_u32 s66, s40, 4864
    buffer_load_dword v124, v1, s[4:7], s65 offen sc1
    buffer_load_dword v125, v1, s[4:7], s66 offen sc1
    s_mov_b32 s83, 0
s4job_90:
    s_cmp_eq_u32 s83, 2
    s_cbranch_scc1 s4w2_92
    s_cmp_eq_u32 s83, 0
    s_cbranch_scc1 s4w_91
    s_waitcnt vmcnt(5)
    s_branch s4w2_92
s4w_91:
    s_waitcnt vmcnt(0)
s4w2_92:
    s_barrier
    ds_read_b128 v[48:51], v2 offset:0
    ds_read_b128 v[52:55], v3 offset:0
    ds_read_b128 v[56:59], v4 offset:0
    s_waitcnt lgkmcnt(2)
    v_mfma_f32_32x32x16_bf16 v[16:31], a[0:3], v[48:51], 0
    ds_read_b128 v[60:63], v5 offset:0
    v_mfma_f32_32x32x16_bf16 v[32:47], a[128:131], v[48:51], 0
    s_cmp_eq_u32 s83, 2
    s_nop 9
    s_cbranch_scc1 s4hs_98
    s_waitcnt vmcnt(2)
s4hs_98:
    v_readfirstlane_b32 s40, v124
    v_readfirstlane_b32 s41, v125
    s_waitcnt lgkmcnt(2)
    v_mfma_f32_32x32x16_bf16 v[16:31], a[4:7], v[52:55], v[16:31]
    ds_read_b128 v[48:51], v6 offset:0
    s_cmp_ge_u32 s40, 8
    s_cselect_b32 s40, 1, 0
    s_cmp_lt_u32 s34, s38
    s_cselect_b32 s40, s40, 0
    v_mfma_f32_32x32x16_bf16 v[32:47], a[132:135], v[52:55], v[32:47]
    s_cmp_ge_u32 s41, 8
    s_cselect_b32 s41, 2, 0
    s_cmp_lt_u32 s35, s38
    s_cselect_b32 s41, s41, 0
    s_waitcnt lgkmcnt(2)
    v_mfma_f32_32x32x16_bf16 v[16:31], a[8:11], v[56:59], v[16:31]
    ds_read_b128 v[52:55], v7 offset:0
    s_cmp_lg_u32 s40, 0
    s_cselect_b32 s67, s40, s41
    s_add_u32 s42, s34, s35
    s_lshl_b32 s43, s38, 1
    v_mfma_f32_32x32x16_bf16 v[32:47], a[136:139], v[56:59], v[32:47]
    s_cmp_ge_u32 s42, s43
    s_cselect_b32 s67, 3, s67
    s_waitcnt lgkmcnt(2)
    v_mfma_f32_32x32x16_bf16 v[16:31], a[12:15], v[60:63], v[16:31]
    ds_read_b128 v[56:59], v8 offset:0
    s_lshl_b32 s40, s30, 2
    s_add_u32 s40, s40, 163792
    v_mov_b32 v13, s40
    v_mov_b32 v14, s67
    v_mfma_f32_32x32x16_bf16 v[32:47], a[140:143], v[60:63], v[32:47]
    ds_write_b32 v13, v14
    s_waitcnt lgkmcnt(3)
    v_mfma_f32_32x32x16_bf16 v[16:31], a[16:19], v[48:51], v[16:31]
    ds_read_b128 v[60:63], v9 offset:0
    v_mfma_f32_32x32x16_bf16 v[32:47], a[144:147], v[48:51], v[32:47]
    s_waitcnt lgkmcnt(1)
    s_barrier
    v_mov_b32 v13, 163792
    ds_read_b32 v124, v13
    s_waitcnt lgkmcnt(4)
    v_mfma_f32_32x32x16_bf16 v[16:31], a[20:23], v[52:55], v[16:31]
    ds_read_b128 v[48:51], v2 offset:8192
    v_mfma_f32_32x32x16_bf16 v[32:47], a[148:151], v[52:55], v[32:47]
    s_waitcnt lgkmcnt(1)
    v_readfirstlane_b32 s67, v124
    s_waitcnt lgkmcnt(4)
    v_mfma_f32_32x32x16_bf16 v[16:31], a[24:27], v[56:59], v[16:31]
    ds_read_b128 v[52:55], v3 offset:8192
    s_nop 0
    s_sub_u32 s40, s67, 1
    s_cmp_lt_u32 s40, 2
    s_cselect_b32 s62, 1, 0
    s_cselect_b32 s56, s40, 0
    v_mfma_f32_32x32x16_bf16 v[32:47], a[152:155], v[56:59], v[32:47]
    s_cmp_eq_u32 s56, 0
    s_cselect_b32 s40, s34, s35
    s_mul_i32 s57, s40, 2
    s_add_u32 s57, s57, s32
    s_waitcnt lgkmcnt(3)
    v_mfma_f32_32x32x16_bf16 v[16:31], a[28:31], v[60:63], v[16:31]
    ds_read_b128 v[56:59], v4 offset:8192
    s_min_u32 s57, s57, 63
    s_xor_b32 s40, s56, 1
    s_and_b32 s40, s40, s62
    s_add_u32 s34, s34, s40
    v_mfma_f32_32x32x16_bf16 v[32:47], a[156:159], v[60:63], v[32:47]
    s_and_b32 s40, s56, s62
    s_add_u32 s35, s35, s40
    s_lshl_b32 s40, s56, 6
    s_add_u32 s40, s40, s57
    s_waitcnt lgkmcnt(2)
    v_mfma_f32_32x32x16_bf16 v[16:31], a[32:35], v[48:51], v[16:31]
    ds_read_b128 v[60:63], v5 offset:8192
    s_mul_i32 s58, s40, 6144
    s_xor_b32 s68, s61, 32768
    s_mul_i32 s64, s57, 32768
    s_add_u32 s64, s64, 109051904
    v_mfma_f32_32x32x16_bf16 v[32:47], a[160:163], v[48:51], v[32:47]
    s_cmp_eq_u32 s62, 1
    s_cselect_b32 s64, s64, s71
    s_cselect_b64 s[84:85], -1, 0
    s_mov_b32 s75, s64
    s_waitcnt lgkmcnt(2)
    v_mfma_f32_32x32x16_bf16 v[16:31], a[36:39], v[52:55], v[16:31]
    ds_read_b128 v[48:51], v6 offset:8192
    s_lshl_b32 s77, s30, 13
    s_add_u32 s77, s77, s64
    s_lshl_b32 s76, s30, 11
    s_add_u32 s76, s76, s68
    v_mfma_f32_32x32x16_bf16 v[32:47], a[164:167], v[52:55], v[32:47]
    s_add_u32 m0, s76, 0
    s_mov_b64 exec, s[84:85]
    buffer_load_dwordx4 v10, s[4:7], s77 offen sc1 lds
    s_mov_b64 exec, -1
    s_waitcnt lgkmcnt(2)
    v_mfma_f32_32x32x16_bf16 v[16:31], a[40:43], v[56:59], v[16:31]
    ds_read_b128 v[52:55], v7 offset:8192
    s_add_u32 m0, s76, 1024
    s_mov_b64 exec, s[84:85]
    buffer_load_dwordx4 v11, s[4:7], s77 offen sc1 lds
    s_mov_b64 exec, -1
    s_add_u32 s77, s77, 256
    v_mfma_f32_32x32x16_bf16 v[32:47], a[168:171], v[56:59], v[32:47]
    s_add_u32 m0, s76, 8192
    s_mov_b64 exec, s[84:85]
    buffer_load_dwordx4 v10, s[4:7], s77 offen sc1 lds
    s_mov_b64 exec, -1
    s_waitcnt lgkmcnt(2)
    v_mfma_f32_32x32x16_bf16 v[16:31], a[44:47], v[60:63], v[16:31]
    ds_read_b128 v[56:59], v8 offset:8192
    s_add_u32 m0, s76, 9216
    s_mov_b64 exec, s[84:85]
    buffer_load_dwordx4 v11, s[4:7], s77 offen sc1 lds
    s_mov_b64 exec, -1
    s_add_u32 s77, s77, 256
    v_mfma_f32_32x32x16_bf16 v[32:47], a[172:175], v[60:63], v[32:47]
    s_add_u32 m0, s76, 16384
    s_mov_b64 exec, s[84:85]
    buffer_load_dwordx4 v10, s[4:7], s77 offen sc1 lds
    s_mov_b64 exec, -1
    s_waitcnt lgkmcnt(2)
    v_mfma_f32_32x32x16_bf16 v[16:31], a[48:51], v[48:51], v[16:31]
    ds_read_b128 v[60:63], v9 offset:8192
    s_add_u32 m0, s76, 17408
    s_mov_b64 exec, s[84:85]
    buffer_load_dwordx4 v11, s[4:7], s77 offen sc1 lds
    s_mov_b64 exec, -1
    s_add_u32 s77, s77, 256
    v_mfma_f32_32x32x16_bf16 v[32:47], a[176:179], v[48:51], v[32:47]
    s_add_u32 m0, s76, 24576
    s_mov_b64 exec, s[84:85]
    buffer_load_dwordx4 v10, s[4:7], s77 offen sc1 lds
    s_mov_b64 exec, -1
    s_waitcnt lgkmcnt(2)
    v_mfma_f32_32x32x16_bf16 v[16:31], a[52:55], v[52:55], v[16:31]
    ds_read_b128 v[48:51], v2 offset:16384
    s_add_u32 m0, s76, 25600
    s_mov_b64 exec, s[84:85]
    buffer_load_dwordx4 v11, s[4:7], s77 offen sc1 lds
    s_mov_b64 exec, -1
    v_mfma_f32_32x32x16_bf16 v[32:47], a[180:183], v[52:55], v[32:47]
    s_waitcnt vmcnt(8)
    s_barrier
    s_cmp_lg_u32 s60, 0
    s_cselect_b32 s72, s74, 0
    v_mov_b32 v14, 1
    s_waitcnt lgkmcnt(2)
    v_mfma_f32_32x32x16_bf16 v[16:31], a[56:59], v[56:59], v[16:31]
    ds_read_b128 v[52:55], v3 offset:16384
    s_mov_b64 exec, s[72:73]
    buffer_atomic_add v14, v1, s[4:7], s60 offen
    s_mov_b64 exec, -1
    s_mov_b32 s60, 0
    v_mfma_f32_32x32x16_bf16 v[32:47], a[184:187], v[56:59], v[32:47]
    s_waitcnt lgkmcnt(2)
    v_mfma_f32_32x32x16_bf16 v[16:31], a[60:63], v[60:63], v[16:31]
    ds_read_b128 v[56:59], v4 offset:16384
    v_mfma_f32_32x32x16_bf16 v[32:47], a[188:191], v[60:63], v[32:47]
    s_waitcnt lgkmcnt(2)
    v_mfma_f32_32x32x16_bf16 v[16:31], a[64:67], v[48:51], v[16:31]
    ds_read_b128 v[60:63], v5 offset:16384
    v_mfma_f32_32x32x16_bf16 v[32:47], a[192:195], v[48:51], v[32:47]
    s_waitcnt lgkmcnt(2)
    v_mfma_f32_32x32x16_bf16 v[16:31], a[68:71], v[52:55], v[16:31]
    ds_read_b128 v[48:51], v6 offset:16384
    v_mfma_f32_32x32x16_bf16 v[32:47], a[196:199], v[52:55], v[32:47]
    s_waitcnt lgkmcnt(2)
    v_mfma_f32_32x32x16_bf16 v[16:31], a[72:75], v[56:59], v[16:31]
    ds_read_b128 v[52:55], v7 offset:16384
    v_mfma_f32_32x32x16_bf16 v[32:47], a[200:203], v[56:59], v[32:47]
    s_waitcnt lgkmcnt(2)
    v_mfma_f32_32x32x16_bf16 v[16:31], a[76:79], v[60:63], v[16:31]
    ds_read_b128 v[56:59], v8 offset:16384
    s_mul_i32 s40, s34, 2
    s_add_u32 s40, s40, s32
    s_min_u32 s40, s40, 63
    s_mul_i32 s40, s40, 6144
    v_mfma_f32_32x32x16_bf16 v[32:47], a[204:207], v[60:63], v[32:47]
    s_add_u32 s65, s40, 4864
    s_mul_i32 s40, s35, 2
    s_add_u32 s40, s40, s32
    s_min_u32 s40, s40, 63
    s_waitcnt lgkmcnt(2)
    v_mfma_f32_32x32x16_bf16 v[16:31], a[80:83], v[48:51], v[16:31]
    ds_read_b128 v[60:63], v9 offset:16384
    s_add_u32 s40, s40, 64
    s_mul_i32 s40, s40, 6144
    s_add_u32 s66, s40, 4864
    v_mfma_f32_32x32x16_bf16 v[32:47], a[208:211], v[48:51], v[32:47]
    buffer_load_dword v124, v1, s[4:7], s65 offen sc1
    buffer_load_dword v125, v1, s[4:7], s66 offen sc1
    s_waitcnt lgkmcnt(2)
    v_mfma_f32_32x32x16_bf16 v[16:31], a[84:87], v[52:55], v[16:31]
    ds_read_b128 v[48:51], v2 offset:24576
    v_mfma_f32_32x32x16_bf16 v[32:47], a[212:215], v[52:55], v[32:47]
    s_waitcnt lgkmcnt(2)
    v_mfma_f32_32x32x16_bf16 v[16:31], a[88:91], v[56:59], v[16:31]
    ds_read_b128 v[52:55], v3 offset:24576
    v_mfma_f32_32x32x16_bf16 v[32:47], a[216:219], v[56:59], v[32:47]
    s_waitcnt lgkmcnt(2)
    v_mfma_f32_32x32x16_bf16 v[16:31], a[92:95], v[60:63], v[16:31]
    ds_read_b128 v[56:59], v4 offset:24576
    v_mfma_f32_32x32x16_bf16 v[32:47], a[220:223], v[60:63], v[32:47]
    s_waitcnt lgkmcnt(2)
    v_mfma_f32_32x32x16_bf16 v[16:31], a[96:99], v[48:51], v[16:31]
    ds_read_b128 v[60:63], v5 offset:24576
    v_mfma_f32_32x32x16_bf16 v[32:47], a[224:227], v[48:51], v[32:47]
    s_waitcnt lgkmcnt(2)
    v_mfma_f32_32x32x16_bf16 v[16:31], a[100:103], v[52:55], v[16:31]
    ds_read_b128 v[48:51], v6 offset:24576
    v_mfma_f32_32x32x16_bf16 v[32:47], a[228:231], v[52:55], v[32:47]
    s_waitcnt lgkmcnt(2)
    v_mfma_f32_32x32x16_bf16 v[16:31], a[104:107], v[56:59], v[16:31]
    ds_read_b128 v[52:55], v7 offset:24576
    v_mfma_f32_32x32x16_bf16 v[32:47], a[232:235], v[56:59], v[32:47]
    s_waitcnt lgkmcnt(2)
    v_mfma_f32_32x32x16_bf16 v[16:31], a[108:111], v[60:63], v[16:31]
    ds_read_b128 v[56:59], v8 offset:24576
    v_mfma_f32_32x32x16_bf16 v[32:47], a[236:239], v[60:63], v[32:47]
    s_waitcnt lgkmcnt(2)
    v_mfma_f32_32x32x16_bf16 v[16:31], a[112:115], v[48:51], v[16:31]
    ds_read_b128 v[60:63], v9 offset:24576
    v_mfma_f32_32x32x16_bf16 v[32:47], a[240:243], v[48:51], v[32:47]
    s_waitcnt lgkmcnt(2)
    v_mfma_f32_32x32x16_bf16 v[16:31], a[116:119], v[52:55], v[16:31]
    v_mfma_f32_32x32x16_bf16 v[32:47], a[244:247], v[52:55], v[32:47]
    s_waitcnt lgkmcnt(1)
    v_mfma_f32_32x32x16_bf16 v[16:31], a[120:123], v[56:59], v[16:31]
    v_mfma_f32_32x32x16_bf16 v[32:47], a[248:251], v[56:59], v[32:47]
    s_mul_i32 s80, s37, 114688
    s_add_u32 s80, s80, 111149056
    s_lshl_b32 s44, s33, 13
    s_add_u32 s80, s80, s44
    s_waitcnt lgkmcnt(0)
    v_mfma_f32_32x32x16_bf16 v[16:31], a[124:127], v[60:63], v[16:31]
    s_lshl_b32 s44, s30, 11
    s_add_u32 s80, s80, s44
    v_mfma_f32_32x32x16_bf16 v[32:47], a[252:255], v[60:63], v[32:47]
    s_nop 8
    v_cvt_pk_bf16_f32 v64, v16, v17
    s_nop 1
    v_cvt_pk_bf16_f32 v72, v32, v33
    v_cvt_pk_bf16_f32 v65, v18, v19
    v_cvt_pk_bf16_f32 v73, v34, v35
    v_cvt_pk_bf16_f32 v66, v20, v21
    v_cvt_pk_bf16_f32 v74, v36, v37
    v_cvt_pk_bf16_f32 v67, v22, v23
    v_cvt_pk_bf16_f32 v75, v38, v39
    v_cvt_pk_bf16_f32 v68, v24, v25
    v_cvt_pk_bf16_f32 v76, v40, v41
    v_cvt_pk_bf16_f32 v69, v26, v27
    v_cvt_pk_bf16_f32 v77, v42, v43
    v_cvt_pk_bf16_f32 v70, v28, v29
    v_cvt_pk_bf16_f32 v78, v44, v45
    v_cvt_pk_bf16_f32 v71, v30, v31
    v_cvt_pk_bf16_f32 v79, v46, v47
    s_cmp_ge_u32 s33, 7
    s_cselect_b32 s43, 128, 0
    s_add_u32 s43, s43, s47
    s_add_u32 s43, s43, 4992
    s_mov_b32 s60, s43
    s_mov_b32 s78, s80
    s_mov_b64 s[86:87], -1
    v_lshlrev_b32 v80, 16, v64
    v_and_b32 v81, 0xffff0000, v64
    v_mul_f32 v84, s55, v80
    v_mul_f32 v85, s55, v81
    v_exp_f32 v84, v84
    v_exp_f32 v85, v85
    v_lshlrev_b32 v82, 16, v72
    v_and_b32 v83, 0xffff0000, v72
    v_add_f32 v84, 1.0, v84
    v_add_f32 v85, 1.0, v85
    v_rcp_f32 v84, v84
    v_rcp_f32 v85, v85
    v_mul_f32 v80, v80, v84
    v_mul_f32 v81, v81, v85
    v_cvt_pk_bf16_f32 v86, v80, v81
    v_lshlrev_b32 v80, 16, v86
    v_and_b32 v81, 0xffff0000, v86
    v_mul_f32 v80, v80, v82
    v_mul_f32 v81, v81, v83
    v_cvt_pk_bf16_f32 v112, v80, v81
    v_lshlrev_b32 v88, 16, v65
    v_and_b32 v89, 0xffff0000, v65
    v_mul_f32 v92, s55, v88
    v_mul_f32 v93, s55, v89
    v_exp_f32 v92, v92
    v_exp_f32 v93, v93
    v_lshlrev_b32 v90, 16, v73
    v_and_b32 v91, 0xffff0000, v73
    v_add_f32 v92, 1.0, v92
    v_add_f32 v93, 1.0, v93
    v_rcp_f32 v92, v92
    v_rcp_f32 v93, v93
    v_mul_f32 v88, v88, v92
    v_mul_f32 v89, v89, v93
    v_cvt_pk_bf16_f32 v94, v88, v89
    v_lshlrev_b32 v88, 16, v94
    v_and_b32 v89, 0xffff0000, v94
    v_mul_f32 v88, v88, v90
    v_mul_f32 v89, v89, v91
    v_cvt_pk_bf16_f32 v113, v88, v89
    v_lshlrev_b32 v80, 16, v66
    v_and_b32 v81, 0xffff0000, v66
    v_mul_f32 v84, s55, v80
    v_mul_f32 v85, s55, v81
    v_exp_f32 v84, v84
    v_exp_f32 v85, v85
    v_lshlrev_b32 v82, 16, v74
    v_and_b32 v83, 0xffff0000, v74
    v_add_f32 v84, 1.0, v84
    v_add_f32 v85, 1.0, v85
    v_rcp_f32 v84, v84
    v_rcp_f32 v85, v85
    v_mul_f32 v80, v80, v84
    v_mul_f32 v81, v81, v85
    v_cvt_pk_bf16_f32 v86, v80, v81
    v_lshlrev_b32 v80, 16, v86
    v_and_b32 v81, 0xffff0000, v86
    v_mul_f32 v80, v80, v82
    v_mul_f32 v81, v81, v83
    v_cvt_pk_bf16_f32 v114, v80, v81
    v_lshlrev_b32 v88, 16, v67
    v_and_b32 v89, 0xffff0000, v67
    v_mul_f32 v92, s55, v88
    v_mul_f32 v93, s55, v89
    v_exp_f32 v92, v92
    v_exp_f32 v93, v93
    v_lshlrev_b32 v90, 16, v75
    v_and_b32 v91, 0xffff0000, v75
    v_add_f32 v92, 1.0, v92
    v_add_f32 v93, 1.0, v93
    v_rcp_f32 v92, v92
    v_rcp_f32 v93, v93
    v_mul_f32 v88, v88, v92
    v_mul_f32 v89, v89, v93
    v_cvt_pk_bf16_f32 v94, v88, v89
    v_lshlrev_b32 v88, 16, v94
    v_and_b32 v89, 0xffff0000, v94
    v_mul_f32 v88, v88, v90
    v_mul_f32 v89, v89, v91
    v_cvt_pk_bf16_f32 v115, v88, v89
    buffer_store_dwordx4 v[112:115], v12, s[4:7], s78 offen offset:0 sc1
    v_lshlrev_b32 v80, 16, v68
    v_and_b32 v81, 0xffff0000, v68
    v_mul_f32 v84, s55, v80
    v_mul_f32 v85, s55, v81
    v_exp_f32 v84, v84
    v_exp_f32 v85, v85
    v_lshlrev_b32 v82, 16, v76
    v_and_b32 v83, 0xffff0000, v76
    v_add_f32 v84, 1.0, v84
    v_add_f32 v85, 1.0, v85
    v_rcp_f32 v84, v84
    v_rcp_f32 v85, v85
    v_mul_f32 v80, v80, v84
    v_mul_f32 v81, v81, v85
    v_cvt_pk_bf16_f32 v86, v80, v81
    v_lshlrev_b32 v80, 16, v86
    v_and_b32 v81, 0xffff0000, v86
    v_mul_f32 v80, v80, v82
    v_mul_f32 v81, v81, v83
    v_cvt_pk_bf16_f32 v116, v80, v81
    v_lshlrev_b32 v88, 16, v69
    v_and_b32 v89, 0xffff0000, v69
    v_mul_f32 v92, s55, v88
    v_mul_f32 v93, s55, v89
    v_exp_f32 v92, v92
    v_exp_f32 v93, v93
    v_lshlrev_b32 v90, 16, v77
    v_and_b32 v91, 0xffff0000, v77
    v_add_f32 v92, 1.0, v92
    v_add_f32 v93, 1.0, v93
    v_rcp_f32 v92, v92
    v_rcp_f32 v93, v93
    v_mul_f32 v88, v88, v92
    v_mul_f32 v89, v89, v93
    v_cvt_pk_bf16_f32 v94, v88, v89
    v_lshlrev_b32 v88, 16, v94
    v_and_b32 v89, 0xffff0000, v94
    v_mul_f32 v88, v88, v90
    v_mul_f32 v89, v89, v91
    v_cvt_pk_bf16_f32 v117, v88, v89
    v_lshlrev_b32 v80, 16, v70
    v_and_b32 v81, 0xffff0000, v70
    v_mul_f32 v84, s55, v80
    v_mul_f32 v85, s55, v81
    v_exp_f32 v84, v84
    v_exp_f32 v85, v85
    v_lshlrev_b32 v82, 16, v78
    v_and_b32 v83, 0xffff0000, v78
    v_add_f32 v84, 1.0, v84
    v_add_f32 v85, 1.0, v85
    v_rcp_f32 v84, v84
    v_rcp_f32 v85, v85
    v_mul_f32 v80, v80, v84
    v_mul_f32 v81, v81, v85
    v_cvt_pk_bf16_f32 v86, v80, v81
    v_lshlrev_b32 v80, 16, v86
    v_and_b32 v81, 0xffff0000, v86
    v_mul_f32 v80, v80, v82
    v_mul_f32 v81, v81, v83
    v_cvt_pk_bf16_f32 v118, v80, v81
    v_lshlrev_b32 v88, 16, v71
    v_and_b32 v89, 0xffff0000, v71
    v_mul_f32 v92, s55, v88
    v_mul_f32 v93, s55, v89
    v_exp_f32 v92, v92
    v_exp_f32 v93, v93
    v_lshlrev_b32 v90, 16, v79
    v_and_b32 v91, 0xffff0000, v79
    v_add_f32 v92, 1.0, v92
    v_add_f32 v93, 1.0, v93
    v_rcp_f32 v92, v92
    v_rcp_f32 v93, v93
    v_mul_f32 v88, v88, v92
    v_mul_f32 v89, v89, v93
    v_cvt_pk_bf16_f32 v94, v88, v89
    v_lshlrev_b32 v88, 16, v94
    v_and_b32 v89, 0xffff0000, v94
    v_mul_f32 v88, v88, v90
    v_mul_f32 v89, v89, v91
    v_cvt_pk_bf16_f32 v119, v88, v89
    buffer_store_dwordx4 v[116:119], v12, s[4:7], s78 offen offset:1024 sc1
    s_mov_b32 s83, 1
    s_cmp_eq_u32 s62, 0
    s_cbranch_scc0 s4nx_93
    s_mul_i32 s40, s34, 2
    s_add_u32 s40, s40, s32
    s_min_u32 s40, s40, 63
    s_mul_i32 s40, s40, 6144
    s_add_u32 s65, s40, 4864
    s_mul_i32 s40, s35, 2
    s_add_u32 s40, s40, s32
    s_min_u32 s40, s40, 63
    s_add_u32 s40, s40, 64
    s_mul_i32 s40, s40, 6144
    s_add_u32 s66, s40, 4864
    buffer_load_dword v124, v1, s[4:7], s65 offen sc1
    buffer_load_dword v125, v1, s[4:7], s66 offen sc1
    s_waitcnt vmcnt(2)
    s_barrier
    s_cmp_lg_u32 s60, 0
    s_cselect_b32 s72, s74, 0
    v_mov_b32 v14, 1
    s_mov_b64 exec, s[72:73]
    buffer_atomic_add v14, v1, s[4:7], s60 offen
    s_mov_b64 exec, -1
    s_mov_b32 s60, 0
    s_mov_b32 s78, 5505024
    s_mov_b64 s[86:87], 0
    s_mov_b32 s83, 2
    s_cmp_eq_u32 s62, 0
    s_cbranch_scc0 s4nx_93
    s_mov_b32 s83, 0
    s_cmp_eq_u32 s30, 0
    s_cbranch_scc0 s4q_99
    s_waitcnt vmcnt(1)
    v_readfirstlane_b32 s40, v124
    v_readfirstlane_b32 s41, v125
    s_nop 2
    s_cmp_ge_u32 s40, 8
    s_cselect_b32 s40, 1, 0
    s_cmp_lt_u32 s34, s38
    s_cselect_b32 s40, s40, 0
    s_cmp_ge_u32 s41, 8
    s_cselect_b32 s41, 2, 0
    s_cmp_lt_u32 s35, s38
    s_cselect_b32 s41, s41, 0
    s_cmp_lg_u32 s40, 0
    s_cselect_b32 s67, s40, s41
    s_add_u32 s42, s34, s35
    s_lshl_b32 s43, s38, 1
    s_cmp_ge_u32 s42, s43
    s_cselect_b32 s67, 3, s67
    v_mov_b32 v13, 163792
    v_mov_b32 v14, s67
    ds_write_b32 v13, v14
    s_waitcnt lgkmcnt(0)
s4q_99:
    s_barrier
    v_mov_b32 v13, 163792
    ds_read_b32 v14, v13
    s_waitcnt lgkmcnt(0)
    v_readfirstlane_b32 s67, v14
    s_nop 3
    s_cmp_lg_u32 s67, 0
    s_cbranch_scc1 s4q2_100
    s_barrier
    s_cmp_eq_u32 s30, 0
    s_cbranch_scc0 s4bp_101
    s_mul_i32 s40, s34, 2
    s_add_u32 s40, s40, s32
    s_min_u32 s40, s40, 63
    s_mul_i32 s40, s40, 6144
    s_add_u32 s65, s40, 4864
    s_mul_i32 s40, s35, 2
    s_add_u32 s40, s40, s32
    s_min_u32 s40, s40, 63
    s_add_u32 s40, s40, 64
    s_mul_i32 s40, s40, 6144
    s_add_u32 s66, s40, 4864
s4bpl_102:
    buffer_load_dword v124, v1, s[4:7], s65 offen sc1
    buffer_load_dword v125, v1, s[4:7], s66 offen sc1
    s_waitcnt vmcnt(0)
    v_readfirstlane_b32 s40, v124
    v_readfirstlane_b32 s41, v125
    s_nop 2
    s_cmp_ge_u32 s40, 8
    s_cselect_b32 s40, 1, 0
    s_cmp_lt_u32 s34, s38
    s_cselect_b32 s40, s40, 0
    s_cmp_ge_u32 s41, 8
    s_cselect_b32 s41, 2, 0
    s_cmp_lt_u32 s35, s38
    s_cselect_b32 s41, s41, 0
    s_cmp_lg_u32 s40, 0
    s_cselect_b32 s67, s40, s41
    s_add_u32 s42, s34, s35
    s_lshl_b32 s43, s38, 1
    s_cmp_ge_u32 s42, s43
    s_cselect_b32 s67, 3, s67
    s_cmp_lg_u32 s67, 0
    s_cbranch_scc1 s4bpd_103
    s_add_u32 s31, s31, 1
    s_cmp_gt_u32 s31, 300000
    s_cselect_b32 s67, 3, 0
    s_cbranch_scc1 s4bpd_103
    s_sleep 1
    s_branch s4bpl_102
s4bpd_103:
    v_mov_b32 v13, 163792
    v_mov_b32 v14, s67
    ds_write_b32 v13, v14
    s_waitcnt lgkmcnt(0)
s4bp_101:
    s_barrier
    v_mov_b32 v13, 163792
    ds_read_b32 v14, v13
    s_waitcnt lgkmcnt(0)
    v_readfirstlane_b32 s67, v14
    s_nop 4
s4q2_100:
    s_cmp_eq_u32 s67, 3
    s_cbranch_scc1 s4fin_94
    s_sub_u32 s56, s67, 1
    s_cmp_eq_u32 s56, 0
    s_cselect_b32 s40, s34, s35
    s_mul_i32 s57, s40, 2
    s_add_u32 s57, s57, s32
    s_xor_b32 s40, s56, 1
    s_add_u32 s34, s34, s40
    s_add_u32 s35, s35, s56
    s_lshl_b32 s40, s56, 6
    s_add_u32 s40, s40, s57
    s_mul_i32 s58, s40, 6144
    s_xor_b32 s68, s61, 32768
    s_mul_i32 s75, s57, 32768
    s_add_u32 s75, s75, 109051904
    s_mov_b32 s64, s75
    s_lshl_b32 s77, s30, 13
    s_add_u32 s77, s77, s64
    s_lshl_b32 s76, s30, 11
    s_add_u32 s76, s76, s68
    s_add_u32 m0, s76, 0
    s_nop 0
    buffer_load_dwordx4 v10, s[4:7], s77 offen sc1 lds
    s_add_u32 m0, s76, 1024
    s_nop 0
    buffer_load_dwordx4 v11, s[4:7], s77 offen sc1 lds
    s_add_u32 s77, s77, 256
    s_add_u32 m0, s76, 8192
    s_nop 0
    buffer_load_dwordx4 v10, s[4:7], s77 offen sc1 lds
    s_add_u32 m0, s76, 9216
    s_nop 0
    buffer_load_dwordx4 v11, s[4:7], s77 offen sc1 lds
    s_add_u32 s77, s77, 256
    s_add_u32 m0, s76, 16384
    s_nop 0
    buffer_load_dwordx4 v10, s[4:7], s77 offen sc1 lds
    s_add_u32 m0, s76, 17408
    s_nop 0
    buffer_load_dwordx4 v11, s[4:7], s77 offen sc1 lds
    s_add_u32 s77, s77, 256
    s_add_u32 m0, s76, 24576
    s_nop 0
    buffer_load_dwordx4 v10, s[4:7], s77 offen sc1 lds
    s_add_u32 m0, s76, 25600
    s_nop 0
    buffer_load_dwordx4 v11, s[4:7], s77 offen sc1 lds
    s_mul_i32 s40, s34, 2
    s_add_u32 s40, s40, s32
    s_min_u32 s40, s40, 63
    s_mul_i32 s40, s40, 6144
    s_add_u32 s65, s40, 4864
    s_mul_i32 s40, s35, 2
    s_add_u32 s40, s40, s32
    s_min_u32 s40, s40, 63
    s_add_u32 s40, s40, 64
    s_mul_i32 s40, s40, 6144
    s_add_u32 s66, s40, 4864
    buffer_load_dword v124, v1, s[4:7], s65 offen sc1
    buffer_load_dword v125, v1, s[4:7], s66 offen sc1
s4nx_93:
    s_mov_b32 s36, s56
    s_mov_b32 s37, s57
    s_mov_b32 s47, s58
    s_mov_b32 s61, s68
    s_mov_b32 s71, s75
    v_xor_b32 v2, 0x8000, v2
    v_xor_b32 v3, 0x8000, v3
    v_xor_b32 v4, 0x8000, v4
    v_xor_b32 v5, 0x8000, v5
    v_xor_b32 v6, 0x8000, v6
    v_xor_b32 v7, 0x8000, v7
    v_xor_b32 v8, 0x8000, v8
    v_xor_b32 v9, 0x8000, v9
    s_nop 0
    s_branch s4job_90
s4fin_94:
    s_waitcnt vmcnt(0)
    s_branch L_exit
L_miscj:
    s_mov_b32 s46, s52
    s_load_dwordx2 s[16:17], s[0:1], 0
    s_load_dwordx2 s[20:21], s[0:1], 88
    s_waitcnt vmcnt(0)
    s_barrier
    s_cmp_eq_u32 s30, 0
    s_cbranch_scc0 sinit_104
    s_mov_b64 exec, 1
    v_mov_b32 v13, 1
    v_mov_b32 v14, 64
    buffer_atomic_add v13, v14, s[8:11], 0 offen
    s_mov_b64 exec, -1
sinit_104:
    s_waitcnt lgkmcnt(0)
    s_mov_b32 s18, 0x200000
    s_mov_b32 s19, 0x20000
    s_mov_b32 s22, 0x200000
    s_mov_b32 s23, 0x20000
    v_lshlrev_b32 v1, 3, v0
    v_lshlrev_b32 v2, 4, v0
    s_cmp_eq_u32 s30, 0
    s_cbranch_scc0 winitb_105
    v_mov_b32 v14, 64
    s_nop 1
wd_106:
    buffer_load_dword v13, v14, s[8:11], 0 offen sc1
    s_waitcnt vmcnt(0)
    v_cmp_le_u32 vcc, 0x80, v13
    s_nop 3
    s_cbranch_vccnz wdd_107
    s_add_u32 s31, s31, 1
    s_cmp_gt_u32 s31, 300000
    s_cbranch_scc1 wdd_107
    s_sleep 6
    s_branch wd_106
wdd_107:
winitb_105:
    s_barrier
    s_lshl_b32 s45, s46, 2
    s_add_u32 s45, s45, s30
    s_mov_b32 s52, s45
    s_mov_b32 s70, 0
r0_108:
    s_cmp_ge_u32 s52, 2048
    s_cbranch_scc1 r0d_109
    s_lshl_b32 s40, s52, 10
    buffer_load_dwordx2 v[48:49], v1, s[16:19], s40 offen
    buffer_load_dwordx2 v[50:51], v1, s[16:19], s40 offen offset:512
    s_waitcnt vmcnt(0)
    v_lshlrev_b32 v52, 16, v48
    v_and_b32 v53, 0xffff0000, v48
    v_lshlrev_b32 v54, 16, v49
    v_and_b32 v55, 0xffff0000, v49
    v_lshlrev_b32 v56, 16, v50
    v_and_b32 v57, 0xffff0000, v50
    v_lshlrev_b32 v58, 16, v51
    v_and_b32 v59, 0xffff0000, v51
    v_add_f32 v80, v52, v53
    v_add_f32 v82, v54, v55
    v_add_f32 v81, v56, v57
    v_add_f32 v80, v80, v82
    v_add_f32 v82, v58, v59
    v_add_f32 v81, v81, v82
    v_add_f32 v80, v80, v81
    s_nop 1
    v_add_f32_dpp v80, v80, v80 row_ror:8 row_mask:0xf bank_mask:0xf
    s_nop 1
    v_add_f32_dpp v80, v80, v80 row_ror:4 row_mask:0xf bank_mask:0xf
    s_nop 1
    v_add_f32_dpp v80, v80, v80 row_ror:2 row_mask:0xf bank_mask:0xf
    s_nop 1
    v_add_f32_dpp v80, v80, v80 row_ror:1 row_mask:0xf bank_mask:0xf
    v_mov_b32 v82, v80
    s_nop 1
    v_permlane16_swap_b32 v80, v82
    v_add_f32 v80, v80, v82
    v_mov_b32 v82, v80
    s_nop 1
    v_permlane32_swap_b32 v80, v82
    v_add_f32 v80, v80, v82
    v_mul_f32 v80, 0x3b000000, v80
    v_sub_f32 v68, v52, v80
    v_sub_f32 v69, v53, v80
    v_sub_f32 v70, v54, v80
    v_sub_f32 v71, v55, v80
    v_sub_f32 v72, v56, v80
    v_sub_f32 v73, v57, v80
    v_sub_f32 v74, v58, v80
    v_sub_f32 v75, v59, v80
    v_mul_f32 v81, v68, v68
    v_fmac_f32 v81, v69, v69
    v_fmac_f32 v81, v70, v70
    v_fmac_f32 v81, v71, v71
    v_fmac_f32 v81, v72, v72
    v_fmac_f32 v81, v73, v73
    v_fmac_f32 v81, v74, v74
    v_fmac_f32 v81, v75, v75
    s_nop 1
    v_add_f32_dpp v81, v81, v81 row_ror:8 row_mask:0xf bank_mask:0xf
    s_nop 1
    v_add_f32_dpp v81, v81, v81 row_ror:4 row_mask:0xf bank_mask:0xf
    s_nop 1
    v_add_f32_dpp v81, v81, v81 row_ror:2 row_mask:0xf bank_mask:0xf
    s_nop 1
    v_add_f32_dpp v81, v81, v81 row_ror:1 row_mask:0xf bank_mask:0xf
    v_mov_b32 v82, v81
    s_nop 1
    v_permlane16_swap_b32 v81, v82
    v_add_f32 v81, v81, v82
    v_mov_b32 v82, v81
    s_nop 1
    v_permlane32_swap_b32 v81, v82
    v_add_f32 v81, v81, v82
    v_mul_f32 v81, 0x3b000000, v81
    v_cvt_pk_bf16_f32 v80, v80, v80
    v_and_b32 v80, 0xffff0000, v80
    v_cvt_pk_bf16_f32 v81, v81, v81
    v_and_b32 v81, 0xffff0000, v81
    v_add_f32 v81, 0x3727c5ac, v81
    v_cvt_pk_bf16_f32 v81, v81, v81
    v_and_b32 v81, 0xffff0000, v81
    v_sqrt_f32 v81, v81
    s_nop 0
    v_cvt_pk_bf16_f32 v81, v81, v81
    v_and_b32 v81, 0xffff0000, v81
    v_rcp_f32 v81, v81
    v_sub_f32 v68, v52, v80
    v_sub_f32 v69, v53, v80
    v_sub_f32 v70, v54, v80
    v_sub_f32 v71, v55, v80
    v_sub_f32 v72, v56, v80
    v_sub_f32 v73, v57, v80
    v_sub_f32 v74, v58, v80
    v_sub_f32 v75, v59, v80
    v_cvt_pk_bf16_f32 v82, v68, v69
    v_lshlrev_b32 v68, 16, v82
    v_and_b32 v69, 0xffff0000, v82
    v_cvt_pk_bf16_f32 v82, v70, v71
    v_lshlrev_b32 v70, 16, v82
    v_and_b32 v71, 0xffff0000, v82
    v_cvt_pk_bf16_f32 v82, v72, v73
    v_lshlrev_b32 v72, 16, v82
    v_and_b32 v73, 0xffff0000, v82
    v_cvt_pk_bf16_f32 v82, v74, v75
    v_lshlrev_b32 v74, 16, v82
    v_and_b32 v75, 0xffff0000, v82
    v_mul_f32 v68, v68, v81
    v_mul_f32 v69, v69, v81
    v_mul_f32 v70, v70, v81
    v_mul_f32 v71, v71, v81
    v_mul_f32 v72, v72, v81
    v_mul_f32 v73, v73, v81
    v_mul_f32 v74, v74, v81
    v_mul_f32 v75, v75, v81
    v_cvt_pk_bf16_f32 v64, v68, v69
    v_cvt_pk_bf16_f32 v65, v70, v71
    v_cvt_pk_bf16_f32 v66, v72, v73
    v_cvt_pk_bf16_f32 v67, v74, v75
    s_add_u32 s40, s40, 126877696
    buffer_store_dwordx2 v[64:65], v1, s[4:7], s40 offen sc1
    buffer_store_dwordx2 v[66:67], v1, s[4:7], s40 offen offset:512 sc1
    s_lshr_b32 s41, s52, 5
    s_mul_i32 s41, s41, 6144
    s_add_u32 s41, s41, 5376
    s_waitcnt vmcnt(0)
    s_barrier
    s_cmp_eq_u32 s30, 0
    s_cbranch_scc0 ws_110
    s_mov_b64 exec, 1
    v_mov_b32 v13, 1
    v_mov_b32 v14, 0
    buffer_atomic_add v13, v14, s[4:7], s41 offen
    s_mov_b64 exec, -1
ws_110:
    s_add_u32 s52, s52, 208
    s_branch r0_108
r0d_109:
    s_cmp_lt_u32 s46, 14
    s_cbranch_scc0 rm_111
    s_sub_u32 s33, s46, 0
    s_branch L_s2
rm_111:
    s_cmp_lt_u32 s46, 25
    s_cbranch_scc0 rm_112
    s_sub_u32 s33, s46, 14
    s_branch L_r3
rm_112:
    s_cmp_lt_u32 s46, 32
    s_cbranch_scc0 rm_113
    s_sub_u32 s33, s46, 25
    s_branch L_r5
rm_113:
    s_cmp_lt_u32 s46, 34
    s_cbranch_scc0 rm_114
    s_sub_u32 s33, s46, 32
    s_add_u32 s33, s33, 11
    s_branch L_r3
rm_114:
    s_cmp_lt_u32 s46, 36
    s_cbranch_scc0 rm_115
    s_sub_u32 s33, s46, 34
    s_add_u32 s33, s33, 7
    s_branch L_r5
rm_115:
    s_cmp_lt_u32 s46, 50
    s_cbranch_scc0 rm_116
    s_sub_u32 s33, s46, 36
    s_add_u32 s33, s33, 14
    s_branch L_s2
rm_116:
    s_cmp_lt_u32 s46, 51
    s_cbranch_scc0 rm_117
    s_sub_u32 s33, s46, 50
    s_add_u32 s33, s33, 13
    s_branch L_r3
rm_117:
    s_cmp_lt_u32 s46, 52
    s_cbranch_scc0 rm_118
    s_sub_u32 s33, s46, 51
    s_add_u32 s33, s33, 9
    s_branch L_r5
rm_118:
L_r5:
    v_mov_b32 v3, 0
    s_mov_b32 s32, s33
    s_cmp_lt_u32 s32, 5
    s_cselect_b32 s34, 0, 512
    s_cselect_b32 s35, 512, 0
    s_cselect_b32 s40, 0, 5
    s_sub_u32 s32, s32, s40
    s_mul_i32 s68, s34, 5
    s_add_u32 s68, s68, s32
    s_mul_i32 s69, s35, 5
    s_add_u32 s69, s69, s32
    s_min_u32 s42, s68, 255
    s_lshr_b32 s65, s42, 2
    s_mul_i32 s65, s65, 6144
    s_add_u32 s65, s65, 5248
    s_min_u32 s42, s69, 255
    s_lshr_b32 s66, s42, 2
    s_add_u32 s66, s66, 64
    s_mul_i32 s66, s66, 6144
    s_add_u32 s66, s66, 5248
    s_cmp_eq_u32 s30, 0
    s_cbranch_scc0 r5mp_122
r5mpl_123:
    buffer_load_dword v90, v3, s[4:7], s65 offen sc1
    buffer_load_dword v91, v3, s[4:7], s66 offen sc1
    s_waitcnt vmcnt(0)
    v_cmp_le_u32 vcc, 8, v90
    s_nop 3
    s_cmp_eq_u64 vcc, -1
    s_cselect_b32 s40, 1, 0
    s_cmp_lt_u32 s68, 256
    s_cselect_b32 s40, s40, 0
    v_cmp_le_u32 vcc, 8, v91
    s_nop 3
    s_cmp_eq_u64 vcc, -1
    s_cselect_b32 s41, 2, 0
    s_cmp_lt_u32 s69, 256
    s_cselect_b32 s41, s41, 0
    s_cmp_lg_u32 s40, 0
    s_cselect_b32 s67, s40, s41
    s_min_u32 s42, s68, s69
    s_cmp_ge_u32 s42, 256
    s_cselect_b32 s67, 3, s67
    s_cmp_lg_u32 s67, 0
    s_cbranch_scc1 r5mpd_124
    s_add_u32 s31, s31, 1
    s_cmp_gt_u32 s31, 300000
    s_cselect_b32 s67, 3, 0
    s_cbranch_scc1 r5mpd_124
    s_sleep 1
    s_branch r5mpl_123
r5mpd_124:
    v_mov_b32 v13, 163792
    v_mov_b32 v14, s67
    ds_write_b32 v13, v14
    s_waitcnt lgkmcnt(0)
r5mp_122:
    s_barrier
    v_mov_b32 v13, 163792
    ds_read_b32 v14, v13
    s_waitcnt lgkmcnt(0)
    v_readfirstlane_b32 s67, v14
    s_nop 3
    s_cmp_eq_u32 s67, 3
    s_cbranch_scc1 r5done_119
    s_sub_u32 s74, s67, 1
    s_cmp_eq_u32 s74, 0
    s_cselect_b32 s40, s68, s69
    s_lshr_b32 s75, s40, 2
    s_and_b32 s77, s40, 3
    s_lshl_b32 s77, s77, 3
    s_add_u32 s77, s77, s30
    s_xor_b32 s40, s74, 1
    s_add_u32 s34, s34, s40
    s_add_u32 s35, s35, s74
    s_lshl_b32 s40, s74, 6
    s_add_u32 s40, s40, s75
    s_mul_i32 s76, s40, 6144
    s_mul_i32 s48, s75, 131072
    s_add_u32 s48, s48, 118489088
    s_lshl_b32 s40, s77, 11
    s_add_u32 s48, s48, s40
    buffer_load_dwordx4 v[16:19], v2, s[4:7], s48 offen sc1
    buffer_load_dwordx4 v[20:23], v2, s[4:7], s48 offen offset:1024 sc1
    s_add_u32 s48, s48, 65536
    buffer_load_dwordx4 v[24:27], v2, s[4:7], s48 offen sc1
    buffer_load_dwordx4 v[28:31], v2, s[4:7], s48 offen offset:1024 sc1
    s_lshl_b32 s41, s75, 5
    s_add_u32 s41, s41, s77
    s_lshl_b32 s41, s41, 10
    s_mul_i32 s40, s74, 0
    s_add_u32 s40, s40, s41
    s_add_u32 s40, s40, 106954752
    buffer_load_dwordx2 v[92:93], v1, s[4:7], s40 offen sc1
    buffer_load_dwordx2 v[94:95], v1, s[4:7], s40 offen offset:512 sc1
    s_add_u32 s77, s77, 4
    s_mul_i32 s48, s75, 131072
    s_add_u32 s48, s48, 118489088
    s_lshl_b32 s40, s77, 11
    s_add_u32 s48, s48, s40
    buffer_load_dwordx4 v[100:103], v2, s[4:7], s48 offen sc1
    buffer_load_dwordx4 v[104:107], v2, s[4:7], s48 offen offset:1024 sc1
    s_add_u32 s48, s48, 65536
    buffer_load_dwordx4 v[108:111], v2, s[4:7], s48 offen sc1
    buffer_load_dwordx4 v[112:115], v2, s[4:7], s48 offen offset:1024 sc1
    s_lshl_b32 s41, s75, 5
    s_add_u32 s41, s41, s77
    s_lshl_b32 s41, s41, 10
    s_mul_i32 s40, s74, 0
    s_add_u32 s40, s40, s41
    s_add_u32 s40, s40, 106954752
    buffer_load_dwordx2 v[96:97], v1, s[4:7], s40 offen sc1
    buffer_load_dwordx2 v[98:99], v1, s[4:7], s40 offen offset:512 sc1
    s_sub_u32 s77, s77, 4
    s_mul_i32 s68, s34, 5
    s_add_u32 s68, s68, s32
    s_mul_i32 s69, s35, 5
    s_add_u32 s69, s69, s32
    s_min_u32 s42, s68, 255
    s_lshr_b32 s65, s42, 2
    s_mul_i32 s65, s65, 6144
    s_add_u32 s65, s65, 5248
    s_min_u32 s42, s69, 255
    s_lshr_b32 s66, s42, 2
    s_add_u32 s66, s66, 64
    s_mul_i32 s66, s66, 6144
    s_add_u32 s66, s66, 5248
    buffer_load_dword v90, v3, s[4:7], s65 offen sc1
    buffer_load_dword v91, v3, s[4:7], s66 offen sc1
    s_waitcnt vmcnt(0)
    s_mov_b32 s78, 0
r5job0_120:
    s_mov_b32 s36, s74
    s_mov_b32 s37, s75
    s_mov_b32 s47, s76
    s_mov_b32 s53, s77
    s_cmp_eq_u32 s78, 0
    s_cbranch_scc1 r5v_130
    s_waitcnt vmcnt(1)
    s_branch r5v2_131
r5v_130:
    s_waitcnt vmcnt(0)
r5v2_131:
    s_cmp_eq_u32 s30, 0
    s_cbranch_scc0 r5w0_126
    v_cmp_le_u32 vcc, 8, v90
    s_nop 3
    s_cmp_eq_u64 vcc, -1
    s_cselect_b32 s40, 1, 0
    s_cmp_lt_u32 s68, 256
    s_cselect_b32 s40, s40, 0
    v_cmp_le_u32 vcc, 8, v91
    s_nop 3
    s_cmp_eq_u64 vcc, -1
    s_cselect_b32 s41, 2, 0
    s_cmp_lt_u32 s69, 256
    s_cselect_b32 s41, s41, 0
    s_cmp_lg_u32 s40, 0
    s_cselect_b32 s67, s40, s41
    s_min_u32 s42, s68, s69
    s_cmp_ge_u32 s42, 256
    s_cselect_b32 s67, 3, s67
    v_mov_b32 v13, 163792
    v_mov_b32 v14, s67
    ds_write_b32 v13, v14
    s_waitcnt lgkmcnt(0)
r5w0_126:
    s_barrier
    v_mov_b32 v13, 163792
    ds_read_b32 v14, v13
    s_waitcnt lgkmcnt(0)
    v_readfirstlane_b32 s67, v14
    s_mov_b32 s79, 0
    s_nop 2
    s_sub_u32 s40, s67, 1
    s_cmp_lt_u32 s40, 2
    s_cbranch_scc0 r5c_127
    s_sub_u32 s74, s67, 1
    s_cmp_eq_u32 s74, 0
    s_cselect_b32 s40, s68, s69
    s_lshr_b32 s75, s40, 2
    s_and_b32 s77, s40, 3
    s_lshl_b32 s77, s77, 3
    s_add_u32 s77, s77, s30
    s_xor_b32 s40, s74, 1
    s_add_u32 s34, s34, s40
    s_add_u32 s35, s35, s74
    s_lshl_b32 s40, s74, 6
    s_add_u32 s40, s40, s75
    s_mul_i32 s76, s40, 6144
    s_mul_i32 s48, s75, 131072
    s_add_u32 s48, s48, 118489088
    s_lshl_b32 s40, s77, 11
    s_add_u32 s48, s48, s40
    buffer_load_dwordx4 v[132:135], v2, s[4:7], s48 offen sc1
    buffer_load_dwordx4 v[136:139], v2, s[4:7], s48 offen offset:1024 sc1
    s_add_u32 s48, s48, 65536
    buffer_load_dwordx4 v[140:143], v2, s[4:7], s48 offen sc1
    buffer_load_dwordx4 v[144:147], v2, s[4:7], s48 offen offset:1024 sc1
    s_lshl_b32 s41, s75, 5
    s_add_u32 s41, s41, s77
    s_lshl_b32 s41, s41, 10
    s_mul_i32 s40, s74, 0
    s_add_u32 s40, s40, s41
    s_add_u32 s40, s40, 106954752
    buffer_load_dwordx2 v[196:197], v1, s[4:7], s40 offen sc1
    buffer_load_dwordx2 v[198:199], v1, s[4:7], s40 offen offset:512 sc1
    s_add_u32 s77, s77, 4
    s_mul_i32 s48, s75, 131072
    s_add_u32 s48, s48, 118489088
    s_lshl_b32 s40, s77, 11
    s_add_u32 s48, s48, s40
    buffer_load_dwordx4 v[164:167], v2, s[4:7], s48 offen sc1
    buffer_load_dwordx4 v[168:171], v2, s[4:7], s48 offen offset:1024 sc1
    s_add_u32 s48, s48, 65536
    buffer_load_dwordx4 v[172:175], v2, s[4:7], s48 offen sc1
    buffer_load_dwordx4 v[176:179], v2, s[4:7], s48 offen offset:1024 sc1
    s_lshl_b32 s41, s75, 5
    s_add_u32 s41, s41, s77
    s_lshl_b32 s41, s41, 10
    s_mul_i32 s40, s74, 0
    s_add_u32 s40, s40, s41
    s_add_u32 s40, s40, 106954752
    buffer_load_dwordx2 v[200:201], v1, s[4:7], s40 offen sc1
    buffer_load_dwordx2 v[202:203], v1, s[4:7], s40 offen offset:512 sc1
    s_sub_u32 s77, s77, 4
    s_mov_b32 s79, 1
r5c_127:
    s_lshl_b32 s54, s37, 5
    s_add_u32 s54, s54, s53
    s_lshl_b32 s54, s54, 10
    v_add_f32 v16, v16, v24
    v_add_f32 v17, v17, v25
    v_add_f32 v18, v18, v26
    v_add_f32 v19, v19, v27
    v_add_f32 v20, v20, v28
    v_add_f32 v21, v21, v29
    v_add_f32 v22, v22, v30
    v_add_f32 v23, v23, v31
    v_lshlrev_b32 v52, 16, v92
    v_and_b32 v53, 0xffff0000, v92
    v_lshlrev_b32 v54, 16, v93
    v_and_b32 v55, 0xffff0000, v93
    v_lshlrev_b32 v56, 16, v94
    v_and_b32 v57, 0xffff0000, v94
    v_lshlrev_b32 v58, 16, v95
    v_and_b32 v59, 0xffff0000, v95
    v_cvt_pk_bf16_f32 v82, v16, v17
    v_lshlrev_b32 v16, 16, v82
    v_and_b32 v17, 0xffff0000, v82
    v_cvt_pk_bf16_f32 v82, v18, v19
    v_lshlrev_b32 v18, 16, v82
    v_and_b32 v19, 0xffff0000, v82
    v_cvt_pk_bf16_f32 v82, v20, v21
    v_lshlrev_b32 v20, 16, v82
    v_and_b32 v21, 0xffff0000, v82
    v_cvt_pk_bf16_f32 v82, v22, v23
    v_lshlrev_b32 v22, 16, v82
    v_and_b32 v23, 0xffff0000, v82
    v_add_f32 v52, v52, v16
    v_add_f32 v53, v53, v17
    v_add_f32 v54, v54, v18
    v_add_f32 v55, v55, v19
    v_add_f32 v56, v56, v20
    v_add_f32 v57, v57, v21
    v_add_f32 v58, v58, v22
    v_add_f32 v59, v59, v23
    v_cvt_pk_bf16_f32 v48, v52, v53
    v_cvt_pk_bf16_f32 v49, v54, v55
    v_cvt_pk_bf16_f32 v50, v56, v57
    v_cvt_pk_bf16_f32 v51, v58, v59
    s_cmp_eq_u32 s36, 0
    s_cbranch_scc1 r5l1_133
    buffer_store_dwordx2 v[48:49], v1, s[20:23], s54 offen
    buffer_store_dwordx2 v[50:51], v1, s[20:23], s54 offen offset:512
    s_mov_b32 s78, 0
    s_branch rfin_132
r5l1_133:
    s_add_u32 s40, s54, 128974848
    buffer_store_dwordx2 v[48:49], v1, s[4:7], s40 offen sc1
    buffer_store_dwordx2 v[50:51], v1, s[4:7], s40 offen offset:512 sc1
    v_lshlrev_b32 v52, 16, v48
    v_and_b32 v53, 0xffff0000, v48
    v_lshlrev_b32 v54, 16, v49
    v_and_b32 v55, 0xffff0000, v49
    v_lshlrev_b32 v56, 16, v50
    v_and_b32 v57, 0xffff0000, v50
    v_lshlrev_b32 v58, 16, v51
    v_and_b32 v59, 0xffff0000, v51
    v_add_f32 v80, v52, v53
    v_add_f32 v82, v54, v55
    v_add_f32 v81, v56, v57
    v_add_f32 v80, v80, v82
    v_add_f32 v82, v58, v59
    v_add_f32 v81, v81, v82
    v_add_f32 v80, v80, v81
    s_nop 1
    v_add_f32_dpp v80, v80, v80 row_ror:8 row_mask:0xf bank_mask:0xf
    s_nop 1
    v_add_f32_dpp v80, v80, v80 row_ror:4 row_mask:0xf bank_mask:0xf
    s_nop 1
    v_add_f32_dpp v80, v80, v80 row_ror:2 row_mask:0xf bank_mask:0xf
    s_nop 1
    v_add_f32_dpp v80, v80, v80 row_ror:1 row_mask:0xf bank_mask:0xf
    v_mov_b32 v82, v80
    s_nop 1
    v_permlane16_swap_b32 v80, v82
    v_add_f32 v80, v80, v82
    v_mov_b32 v82, v80
    s_nop 1
    v_permlane32_swap_b32 v80, v82
    v_add_f32 v80, v80, v82
    v_mul_f32 v80, 0x3b000000, v80
    v_sub_f32 v68, v52, v80
    v_sub_f32 v69, v53, v80
    v_sub_f32 v70, v54, v80
    v_sub_f32 v71, v55, v80
    v_sub_f32 v72, v56, v80
    v_sub_f32 v73, v57, v80
    v_sub_f32 v74, v58, v80
    v_sub_f32 v75, v59, v80
    v_mul_f32 v81, v68, v68
    v_fmac_f32 v81, v69, v69
    v_fmac_f32 v81, v70, v70
    v_fmac_f32 v81, v71, v71
    v_fmac_f32 v81, v72, v72
    v_fmac_f32 v81, v73, v73
    v_fmac_f32 v81, v74, v74
    v_fmac_f32 v81, v75, v75
    s_nop 1
    v_add_f32_dpp v81, v81, v81 row_ror:8 row_mask:0xf bank_mask:0xf
    s_nop 1
    v_add_f32_dpp v81, v81, v81 row_ror:4 row_mask:0xf bank_mask:0xf
    s_nop 1
    v_add_f32_dpp v81, v81, v81 row_ror:2 row_mask:0xf bank_mask:0xf
    s_nop 1
    v_add_f32_dpp v81, v81, v81 row_ror:1 row_mask:0xf bank_mask:0xf
    v_mov_b32 v82, v81
    s_nop 1
    v_permlane16_swap_b32 v81, v82
    v_add_f32 v81, v81, v82
    v_mov_b32 v82, v81
    s_nop 1
    v_permlane32_swap_b32 v81, v82
    v_add_f32 v81, v81, v82
    v_mul_f32 v81, 0x3b000000, v81
    v_cvt_pk_bf16_f32 v80, v80, v80
    v_and_b32 v80, 0xffff0000, v80
    v_cvt_pk_bf16_f32 v81, v81, v81
    v_and_b32 v81, 0xffff0000, v81
    v_add_f32 v81, 0x3727c5ac, v81
    v_cvt_pk_bf16_f32 v81, v81, v81
    v_and_b32 v81, 0xffff0000, v81
    v_sqrt_f32 v81, v81
    s_nop 0
    v_cvt_pk_bf16_f32 v81, v81, v81
    v_and_b32 v81, 0xffff0000, v81
    v_rcp_f32 v81, v81
    v_sub_f32 v68, v52, v80
    v_sub_f32 v69, v53, v80
    v_sub_f32 v70, v54, v80
    v_sub_f32 v71, v55, v80
    v_sub_f32 v72, v56, v80
    v_sub_f32 v73, v57, v80
    v_sub_f32 v74, v58, v80
    v_sub_f32 v75, v59, v80
    v_cvt_pk_bf16_f32 v82, v68, v69
    v_lshlrev_b32 v68, 16, v82
    v_and_b32 v69, 0xffff0000, v82
    v_cvt_pk_bf16_f32 v82, v70, v71
    v_lshlrev_b32 v70, 16, v82
    v_and_b32 v71, 0xffff0000, v82
    v_cvt_pk_bf16_f32 v82, v72, v73
    v_lshlrev_b32 v72, 16, v82
    v_and_b32 v73, 0xffff0000, v82
    v_cvt_pk_bf16_f32 v82, v74, v75
    v_lshlrev_b32 v74, 16, v82
    v_and_b32 v75, 0xffff0000, v82
    v_mul_f32 v68, v68, v81
    v_mul_f32 v69, v69, v81
    v_mul_f32 v70, v70, v81
    v_mul_f32 v71, v71, v81
    v_mul_f32 v72, v72, v81
    v_mul_f32 v73, v73, v81
    v_mul_f32 v74, v74, v81
    v_mul_f32 v75, v75, v81
    v_cvt_pk_bf16_f32 v64, v68, v69
    v_cvt_pk_bf16_f32 v65, v70, v71
    v_cvt_pk_bf16_f32 v66, v72, v73
    v_cvt_pk_bf16_f32 v67, v74, v75
    s_add_u32 s40, s54, 126877696
    s_add_u32 s78, s47, 398592
    buffer_store_dwordx2 v[64:65], v1, s[4:7], s40 offen sc1
    buffer_store_dwordx2 v[66:67], v1, s[4:7], s40 offen offset:512 sc1
rfin_132:
    s_add_u32 s53, s53, 4
    s_lshl_b32 s54, s37, 5
    s_add_u32 s54, s54, s53
    s_lshl_b32 s54, s54, 10
    v_add_f32 v100, v100, v108
    v_add_f32 v101, v101, v109
    v_add_f32 v102, v102, v110
    v_add_f32 v103, v103, v111
    v_add_f32 v104, v104, v112
    v_add_f32 v105, v105, v113
    v_add_f32 v106, v106, v114
    v_add_f32 v107, v107, v115
    v_lshlrev_b32 v52, 16, v96
    v_and_b32 v53, 0xffff0000, v96
    v_lshlrev_b32 v54, 16, v97
    v_and_b32 v55, 0xffff0000, v97
    v_lshlrev_b32 v56, 16, v98
    v_and_b32 v57, 0xffff0000, v98
    v_lshlrev_b32 v58, 16, v99
    v_and_b32 v59, 0xffff0000, v99
    v_cvt_pk_bf16_f32 v82, v100, v101
    v_lshlrev_b32 v100, 16, v82
    v_and_b32 v101, 0xffff0000, v82
    v_cvt_pk_bf16_f32 v82, v102, v103
    v_lshlrev_b32 v102, 16, v82
    v_and_b32 v103, 0xffff0000, v82
    v_cvt_pk_bf16_f32 v82, v104, v105
    v_lshlrev_b32 v104, 16, v82
    v_and_b32 v105, 0xffff0000, v82
    v_cvt_pk_bf16_f32 v82, v106, v107
    v_lshlrev_b32 v106, 16, v82
    v_and_b32 v107, 0xffff0000, v82
    v_add_f32 v52, v52, v100
    v_add_f32 v53, v53, v101
    v_add_f32 v54, v54, v102
    v_add_f32 v55, v55, v103
    v_add_f32 v56, v56, v104
    v_add_f32 v57, v57, v105
    v_add_f32 v58, v58, v106
    v_add_f32 v59, v59, v107
    v_cvt_pk_bf16_f32 v208, v52, v53
    v_cvt_pk_bf16_f32 v209, v54, v55
    v_cvt_pk_bf16_f32 v210, v56, v57
    v_cvt_pk_bf16_f32 v211, v58, v59
    s_cmp_eq_u32 s36, 0
    s_cbranch_scc1 r5l1_135
    buffer_store_dwordx2 v[208:209], v1, s[20:23], s54 offen
    buffer_store_dwordx2 v[210:211], v1, s[20:23], s54 offen offset:512
    s_mov_b32 s78, 0
    s_branch rfin_134
r5l1_135:
    s_add_u32 s40, s54, 128974848
    buffer_store_dwordx2 v[208:209], v1, s[4:7], s40 offen sc1
    buffer_store_dwordx2 v[210:211], v1, s[4:7], s40 offen offset:512 sc1
    v_lshlrev_b32 v52, 16, v208
    v_and_b32 v53, 0xffff0000, v208
    v_lshlrev_b32 v54, 16, v209
    v_and_b32 v55, 0xffff0000, v209
    v_lshlrev_b32 v56, 16, v210
    v_and_b32 v57, 0xffff0000, v210
    v_lshlrev_b32 v58, 16, v211
    v_and_b32 v59, 0xffff0000, v211
    v_add_f32 v80, v52, v53
    v_add_f32 v82, v54, v55
    v_add_f32 v81, v56, v57
    v_add_f32 v80, v80, v82
    v_add_f32 v82, v58, v59
    v_add_f32 v81, v81, v82
    v_add_f32 v80, v80, v81
    s_nop 1
    v_add_f32_dpp v80, v80, v80 row_ror:8 row_mask:0xf bank_mask:0xf
    s_nop 1
    v_add_f32_dpp v80, v80, v80 row_ror:4 row_mask:0xf bank_mask:0xf
    s_nop 1
    v_add_f32_dpp v80, v80, v80 row_ror:2 row_mask:0xf bank_mask:0xf
    s_nop 1
    v_add_f32_dpp v80, v80, v80 row_ror:1 row_mask:0xf bank_mask:0xf
    v_mov_b32 v82, v80
    s_nop 1
    v_permlane16_swap_b32 v80, v82
    v_add_f32 v80, v80, v82
    v_mov_b32 v82, v80
    s_nop 1
    v_permlane32_swap_b32 v80, v82
    v_add_f32 v80, v80, v82
    v_mul_f32 v80, 0x3b000000, v80
    v_sub_f32 v220, v52, v80
    v_sub_f32 v221, v53, v80
    v_sub_f32 v222, v54, v80
    v_sub_f32 v223, v55, v80
    v_sub_f32 v224, v56, v80
    v_sub_f32 v225, v57, v80
    v_sub_f32 v226, v58, v80
    v_sub_f32 v227, v59, v80
    v_mul_f32 v81, v220, v220
    v_fmac_f32 v81, v221, v221
    v_fmac_f32 v81, v222, v222
    v_fmac_f32 v81, v223, v223
    v_fmac_f32 v81, v224, v224
    v_fmac_f32 v81, v225, v225
    v_fmac_f32 v81, v226, v226
    v_fmac_f32 v81, v227, v227
    s_nop 1
    v_add_f32_dpp v81, v81, v81 row_ror:8 row_mask:0xf bank_mask:0xf
    s_nop 1
    v_add_f32_dpp v81, v81, v81 row_ror:4 row_mask:0xf bank_mask:0xf
    s_nop 1
    v_add_f32_dpp v81, v81, v81 row_ror:2 row_mask:0xf bank_mask:0xf
    s_nop 1
    v_add_f32_dpp v81, v81, v81 row_ror:1 row_mask:0xf bank_mask:0xf
    v_mov_b32 v82, v81
    s_nop 1
    v_permlane16_swap_b32 v81, v82
    v_add_f32 v81, v81, v82
    v_mov_b32 v82, v81
    s_nop 1
    v_permlane32_swap_b32 v81, v82
    v_add_f32 v81, v81, v82
    v_mul_f32 v81, 0x3b000000, v81
    v_cvt_pk_bf16_f32 v80, v80, v80
    v_and_b32 v80, 0xffff0000, v80
    v_cvt_pk_bf16_f32 v81, v81, v81
    v_and_b32 v81, 0xffff0000, v81
    v_add_f32 v81, 0x3727c5ac, v81
    v_cvt_pk_bf16_f32 v81, v81, v81
    v_and_b32 v81, 0xffff0000, v81
    v_sqrt_f32 v81, v81
    s_nop 0
    v_cvt_pk_bf16_f32 v81, v81, v81
    v_and_b32 v81, 0xffff0000, v81
    v_rcp_f32 v81, v81
    v_sub_f32 v220, v52, v80
    v_sub_f32 v221, v53, v80
    v_sub_f32 v222, v54, v80
    v_sub_f32 v223, v55, v80
    v_sub_f32 v224, v56, v80
    v_sub_f32 v225, v57, v80
    v_sub_f32 v226, v58, v80
    v_sub_f32 v227, v59, v80
    v_cvt_pk_bf16_f32 v82, v220, v221
    v_lshlrev_b32 v220, 16, v82
    v_and_b32 v221, 0xffff0000, v82
    v_cvt_pk_bf16_f32 v82, v222, v223
    v_lshlrev_b32 v222, 16, v82
    v_and_b32 v223, 0xffff0000, v82
    v_cvt_pk_bf16_f32 v82, v224, v225
    v_lshlrev_b32 v224, 16, v82
    v_and_b32 v225, 0xffff0000, v82
    v_cvt_pk_bf16_f32 v82, v226, v227
    v_lshlrev_b32 v226, 16, v82
    v_and_b32 v227, 0xffff0000, v82
    v_mul_f32 v220, v220, v81
    v_mul_f32 v221, v221, v81
    v_mul_f32 v222, v222, v81
    v_mul_f32 v223, v223, v81
    v_mul_f32 v224, v224, v81
    v_mul_f32 v225, v225, v81
    v_mul_f32 v226, v226, v81
    v_mul_f32 v227, v227, v81
    v_cvt_pk_bf16_f32 v216, v220, v221
    v_cvt_pk_bf16_f32 v217, v222, v223
    v_cvt_pk_bf16_f32 v218, v224, v225
    v_cvt_pk_bf16_f32 v219, v226, v227
    s_add_u32 s40, s54, 126877696
    s_add_u32 s78, s47, 398592
    buffer_store_dwordx2 v[216:217], v1, s[4:7], s40 offen sc1
    buffer_store_dwordx2 v[218:219], v1, s[4:7], s40 offen offset:512 sc1
rfin_134:
    s_sub_u32 s53, s53, 4
    s_mul_i32 s68, s34, 5
    s_add_u32 s68, s68, s32
    s_mul_i32 s69, s35, 5
    s_add_u32 s69, s69, s32
    s_min_u32 s42, s68, 255
    s_lshr_b32 s65, s42, 2
    s_mul_i32 s65, s65, 6144
    s_add_u32 s65, s65, 5248
    s_min_u32 s42, s69, 255
    s_lshr_b32 s66, s42, 2
    s_add_u32 s66, s66, 64
    s_mul_i32 s66, s66, 6144
    s_add_u32 s66, s66, 5248
    buffer_load_dword v90, v3, s[4:7], s65 offen sc1
    buffer_load_dword v91, v3, s[4:7], s66 offen sc1
    s_waitcnt vmcnt(2)
    s_cmp_eq_u32 s78, 0
    s_cbranch_scc1 r5s1_128
    s_barrier
    s_cmp_eq_u32 s30, 0
    s_cbranch_scc0 ws_136
    s_mov_b64 exec, 1
    v_mov_b32 v13, 2
    v_mov_b32 v14, 0
    buffer_atomic_add v13, v14, s[4:7], s78 offen
    s_mov_b64 exec, -1
ws_136:
r5s1_128:
    s_cmp_eq_u32 s79, 1
    s_cbranch_scc1 r5go_129
    s_mul_i32 s68, s34, 5
    s_add_u32 s68, s68, s32
    s_mul_i32 s69, s35, 5
    s_add_u32 s69, s69, s32
    s_min_u32 s42, s68, 255
    s_lshr_b32 s65, s42, 2
    s_mul_i32 s65, s65, 6144
    s_add_u32 s65, s65, 5248
    s_min_u32 s42, s69, 255
    s_lshr_b32 s66, s42, 2
    s_add_u32 s66, s66, 64
    s_mul_i32 s66, s66, 6144
    s_add_u32 s66, s66, 5248
    s_cmp_eq_u32 s30, 0
    s_cbranch_scc0 r5mp_137
r5mpl_138:
    buffer_load_dword v90, v3, s[4:7], s65 offen sc1
    buffer_load_dword v91, v3, s[4:7], s66 offen sc1
    s_waitcnt vmcnt(0)
    v_cmp_le_u32 vcc, 8, v90
    s_nop 3
    s_cmp_eq_u64 vcc, -1
    s_cselect_b32 s40, 1, 0
    s_cmp_lt_u32 s68, 256
    s_cselect_b32 s40, s40, 0
    v_cmp_le_u32 vcc, 8, v91
    s_nop 3
    s_cmp_eq_u64 vcc, -1
    s_cselect_b32 s41, 2, 0
    s_cmp_lt_u32 s69, 256
    s_cselect_b32 s41, s41, 0
    s_cmp_lg_u32 s40, 0
    s_cselect_b32 s67, s40, s41
    s_min_u32 s42, s68, s69
    s_cmp_ge_u32 s42, 256
    s_cselect_b32 s67, 3, s67
    s_cmp_lg_u32 s67, 0
    s_cbranch_scc1 r5mpd_139
    s_add_u32 s31, s31, 1
    s_cmp_gt_u32 s31, 300000
    s_cselect_b32 s67, 3, 0
    s_cbranch_scc1 r5mpd_139
    s_sleep 1
    s_branch r5mpl_138
r5mpd_139:
    v_mov_b32 v13, 163792
    v_mov_b32 v14, s67
    ds_write_b32 v13, v14
    s_waitcnt lgkmcnt(0)
r5mp_137:
    s_barrier
    v_mov_b32 v13, 163792
    ds_read_b32 v14, v13
    s_waitcnt lgkmcnt(0)
    v_readfirstlane_b32 s67, v14
    s_nop 3
    s_cmp_eq_u32 s67, 3
    s_cbranch_scc1 r5done_119
    s_sub_u32 s74, s67, 1
    s_cmp_eq_u32 s74, 0
    s_cselect_b32 s40, s68, s69
    s_lshr_b32 s75, s40, 2
    s_and_b32 s77, s40, 3
    s_lshl_b32 s77, s77, 3
    s_add_u32 s77, s77, s30
    s_xor_b32 s40, s74, 1
    s_add_u32 s34, s34, s40
    s_add_u32 s35, s35, s74
    s_lshl_b32 s40, s74, 6
    s_add_u32 s40, s40, s75
    s_mul_i32 s76, s40, 6144
    s_mul_i32 s48, s75, 131072
    s_add_u32 s48, s48, 118489088
    s_lshl_b32 s40, s77, 11
    s_add_u32 s48, s48, s40
    buffer_load_dwordx4 v[132:135], v2, s[4:7], s48 offen sc1
    buffer_load_dwordx4 v[136:139], v2, s[4:7], s48 offen offset:1024 sc1
    s_add_u32 s48, s48, 65536
    buffer_load_dwordx4 v[140:143], v2, s[4:7], s48 offen sc1
    buffer_load_dwordx4 v[144:147], v2, s[4:7], s48 offen offset:1024 sc1
    s_lshl_b32 s41, s75, 5
    s_add_u32 s41, s41, s77
    s_lshl_b32 s41, s41, 10
    s_mul_i32 s40, s74, 0
    s_add_u32 s40, s40, s41
    s_add_u32 s40, s40, 106954752
    buffer_load_dwordx2 v[196:197], v1, s[4:7], s40 offen sc1
    buffer_load_dwordx2 v[198:199], v1, s[4:7], s40 offen offset:512 sc1
    s_add_u32 s77, s77, 4
    s_mul_i32 s48, s75, 131072
    s_add_u32 s48, s48, 118489088
    s_lshl_b32 s40, s77, 11
    s_add_u32 s48, s48, s40
    buffer_load_dwordx4 v[164:167], v2, s[4:7], s48 offen sc1
    buffer_load_dwordx4 v[168:171], v2, s[4:7], s48 offen offset:1024 sc1
    s_add_u32 s48, s48, 65536
    buffer_load_dwordx4 v[172:175], v2, s[4:7], s48 offen sc1
    buffer_load_dwordx4 v[176:179], v2, s[4:7], s48 offen offset:1024 sc1
    s_lshl_b32 s41, s75, 5
    s_add_u32 s41, s41, s77
    s_lshl_b32 s41, s41, 10
    s_mul_i32 s40, s74, 0
    s_add_u32 s40, s40, s41
    s_add_u32 s40, s40, 106954752
    buffer_load_dwordx2 v[200:201], v1, s[4:7], s40 offen sc1
    buffer_load_dwordx2 v[202:203], v1, s[4:7], s40 offen offset:512 sc1
    s_sub_u32 s77, s77, 4
    s_mul_i32 s68, s34, 5
    s_add_u32 s68, s68, s32
    s_mul_i32 s69, s35, 5
    s_add_u32 s69, s69, s32
    s_min_u32 s42, s68, 255
    s_lshr_b32 s65, s42, 2
    s_mul_i32 s65, s65, 6144
    s_add_u32 s65, s65, 5248
    s_min_u32 s42, s69, 255
    s_lshr_b32 s66, s42, 2
    s_add_u32 s66, s66, 64
    s_mul_i32 s66, s66, 6144
    s_add_u32 s66, s66, 5248
    buffer_load_dword v90, v3, s[4:7], s65 offen sc1
    buffer_load_dword v91, v3, s[4:7], s66 offen sc1
    s_waitcnt vmcnt(0)
r5go_129:
r5job1_121:
    s_mov_b32 s36, s74
    s_mov_b32 s37, s75
    s_mov_b32 s47, s76
    s_mov_b32 s53, s77
    s_cmp_eq_u32 s78, 0
    s_cbranch_scc1 r5v_145
    s_waitcnt vmcnt(1)
    s_branch r5v2_146
r5v_145:
    s_waitcnt vmcnt(0)
r5v2_146:
    s_cmp_eq_u32 s30, 0
    s_cbranch_scc0 r5w0_141
    v_cmp_le_u32 vcc, 8, v90
    s_nop 3
    s_cmp_eq_u64 vcc, -1
    s_cselect_b32 s40, 1, 0
    s_cmp_lt_u32 s68, 256
    s_cselect_b32 s40, s40, 0
    v_cmp_le_u32 vcc, 8, v91
    s_nop 3
    s_cmp_eq_u64 vcc, -1
    s_cselect_b32 s41, 2, 0
    s_cmp_lt_u32 s69, 256
    s_cselect_b32 s41, s41, 0
    s_cmp_lg_u32 s40, 0
    s_cselect_b32 s67, s40, s41
    s_min_u32 s42, s68, s69
    s_cmp_ge_u32 s42, 256
    s_cselect_b32 s67, 3, s67
    v_mov_b32 v13, 163792
    v_mov_b32 v14, s67
    ds_write_b32 v13, v14
    s_waitcnt lgkmcnt(0)
r5w0_141:
    s_barrier
    v_mov_b32 v13, 163792
    ds_read_b32 v14, v13
    s_waitcnt lgkmcnt(0)
    v_readfirstlane_b32 s67, v14
    s_mov_b32 s79, 0
    s_nop 2
    s_sub_u32 s40, s67, 1
    s_cmp_lt_u32 s40, 2
    s_cbranch_scc0 r5c_142
    s_sub_u32 s74, s67, 1
    s_cmp_eq_u32 s74, 0
    s_cselect_b32 s40, s68, s69
    s_lshr_b32 s75, s40, 2
    s_and_b32 s77, s40, 3
    s_lshl_b32 s77, s77, 3
    s_add_u32 s77, s77, s30
    s_xor_b32 s40, s74, 1
    s_add_u32 s34, s34, s40
    s_add_u32 s35, s35, s74
    s_lshl_b32 s40, s74, 6
    s_add_u32 s40, s40, s75
    s_mul_i32 s76, s40, 6144
    s_mul_i32 s48, s75, 131072
    s_add_u32 s48, s48, 118489088
    s_lshl_b32 s40, s77, 11
    s_add_u32 s48, s48, s40
    buffer_load_dwordx4 v[16:19], v2, s[4:7], s48 offen sc1
    buffer_load_dwordx4 v[20:23], v2, s[4:7], s48 offen offset:1024 sc1
    s_add_u32 s48, s48, 65536
    buffer_load_dwordx4 v[24:27], v2, s[4:7], s48 offen sc1
    buffer_load_dwordx4 v[28:31], v2, s[4:7], s48 offen offset:1024 sc1
    s_lshl_b32 s41, s75, 5
    s_add_u32 s41, s41, s77
    s_lshl_b32 s41, s41, 10
    s_mul_i32 s40, s74, 0
    s_add_u32 s40, s40, s41
    s_add_u32 s40, s40, 106954752
    buffer_load_dwordx2 v[92:93], v1, s[4:7], s40 offen sc1
    buffer_load_dwordx2 v[94:95], v1, s[4:7], s40 offen offset:512 sc1
    s_add_u32 s77, s77, 4
    s_mul_i32 s48, s75, 131072
    s_add_u32 s48, s48, 118489088
    s_lshl_b32 s40, s77, 11
    s_add_u32 s48, s48, s40
    buffer_load_dwordx4 v[100:103], v2, s[4:7], s48 offen sc1
    buffer_load_dwordx4 v[104:107], v2, s[4:7], s48 offen offset:1024 sc1
    s_add_u32 s48, s48, 65536
    buffer_load_dwordx4 v[108:111], v2, s[4:7], s48 offen sc1
    buffer_load_dwordx4 v[112:115], v2, s[4:7], s48 offen offset:1024 sc1
    s_lshl_b32 s41, s75, 5
    s_add_u32 s41, s41, s77
    s_lshl_b32 s41, s41, 10
    s_mul_i32 s40, s74, 0
    s_add_u32 s40, s40, s41
    s_add_u32 s40, s40, 106954752
    buffer_load_dwordx2 v[96:97], v1, s[4:7], s40 offen sc1
    buffer_load_dwordx2 v[98:99], v1, s[4:7], s40 offen offset:512 sc1
    s_sub_u32 s77, s77, 4
    s_mov_b32 s79, 1
r5c_142:
    s_lshl_b32 s54, s37, 5
    s_add_u32 s54, s54, s53
    s_lshl_b32 s54, s54, 10
    v_add_f32 v132, v132, v140
    v_add_f32 v133, v133, v141
    v_add_f32 v134, v134, v142
    v_add_f32 v135, v135, v143
    v_add_f32 v136, v136, v144
    v_add_f32 v137, v137, v145
    v_add_f32 v138, v138, v146
    v_add_f32 v139, v139, v147
    v_lshlrev_b32 v52, 16, v196
    v_and_b32 v53, 0xffff0000, v196
    v_lshlrev_b32 v54, 16, v197
    v_and_b32 v55, 0xffff0000, v197
    v_lshlrev_b32 v56, 16, v198
    v_and_b32 v57, 0xffff0000, v198
    v_lshlrev_b32 v58, 16, v199
    v_and_b32 v59, 0xffff0000, v199
    v_cvt_pk_bf16_f32 v82, v132, v133
    v_lshlrev_b32 v132, 16, v82
    v_and_b32 v133, 0xffff0000, v82
    v_cvt_pk_bf16_f32 v82, v134, v135
    v_lshlrev_b32 v134, 16, v82
    v_and_b32 v135, 0xffff0000, v82
    v_cvt_pk_bf16_f32 v82, v136, v137
    v_lshlrev_b32 v136, 16, v82
    v_and_b32 v137, 0xffff0000, v82
    v_cvt_pk_bf16_f32 v82, v138, v139
    v_lshlrev_b32 v138, 16, v82
    v_and_b32 v139, 0xffff0000, v82
    v_add_f32 v52, v52, v132
    v_add_f32 v53, v53, v133
    v_add_f32 v54, v54, v134
    v_add_f32 v55, v55, v135
    v_add_f32 v56, v56, v136
    v_add_f32 v57, v57, v137
    v_add_f32 v58, v58, v138
    v_add_f32 v59, v59, v139
    v_cvt_pk_bf16_f32 v48, v52, v53
    v_cvt_pk_bf16_f32 v49, v54, v55
    v_cvt_pk_bf16_f32 v50, v56, v57
    v_cvt_pk_bf16_f32 v51, v58, v59
    s_cmp_eq_u32 s36, 0
    s_cbranch_scc1 r5l1_148
    buffer_store_dwordx2 v[48:49], v1, s[20:23], s54 offen
    buffer_store_dwordx2 v[50:51], v1, s[20:23], s54 offen offset:512
    s_mov_b32 s78, 0
    s_branch rfin_147
r5l1_148:
    s_add_u32 s40, s54, 128974848
    buffer_store_dwordx2 v[48:49], v1, s[4:7], s40 offen sc1
    buffer_store_dwordx2 v[50:51], v1, s[4:7], s40 offen offset:512 sc1
    v_lshlrev_b32 v52, 16, v48
    v_and_b32 v53, 0xffff0000, v48
    v_lshlrev_b32 v54, 16, v49
    v_and_b32 v55, 0xffff0000, v49
    v_lshlrev_b32 v56, 16, v50
    v_and_b32 v57, 0xffff0000, v50
    v_lshlrev_b32 v58, 16, v51
    v_and_b32 v59, 0xffff0000, v51
    v_add_f32 v80, v52, v53
    v_add_f32 v82, v54, v55
    v_add_f32 v81, v56, v57
    v_add_f32 v80, v80, v82
    v_add_f32 v82, v58, v59
    v_add_f32 v81, v81, v82
    v_add_f32 v80, v80, v81
    s_nop 1
    v_add_f32_dpp v80, v80, v80 row_ror:8 row_mask:0xf bank_mask:0xf
    s_nop 1
    v_add_f32_dpp v80, v80, v80 row_ror:4 row_mask:0xf bank_mask:0xf
    s_nop 1
    v_add_f32_dpp v80, v80, v80 row_ror:2 row_mask:0xf bank_mask:0xf
    s_nop 1
    v_add_f32_dpp v80, v80, v80 row_ror:1 row_mask:0xf bank_mask:0xf
    v_mov_b32 v82, v80
    s_nop 1
    v_permlane16_swap_b32 v80, v82
    v_add_f32 v80, v80, v82
    v_mov_b32 v82, v80
    s_nop 1
    v_permlane32_swap_b32 v80, v82
    v_add_f32 v80, v80, v82
    v_mul_f32 v80, 0x3b000000, v80
    v_sub_f32 v68, v52, v80
    v_sub_f32 v69, v53, v80
    v_sub_f32 v70, v54, v80
    v_sub_f32 v71, v55, v80
    v_sub_f32 v72, v56, v80
    v_sub_f32 v73, v57, v80
    v_sub_f32 v74, v58, v80
    v_sub_f32 v75, v59, v80
    v_mul_f32 v81, v68, v68
    v_fmac_f32 v81, v69, v69
    v_fmac_f32 v81, v70, v70
    v_fmac_f32 v81, v71, v71
    v_fmac_f32 v81, v72, v72
    v_fmac_f32 v81, v73, v73
    v_fmac_f32 v81, v74, v74
    v_fmac_f32 v81, v75, v75
    s_nop 1
    v_add_f32_dpp v81, v81, v81 row_ror:8 row_mask:0xf bank_mask:0xf
    s_nop 1
    v_add_f32_dpp v81, v81, v81 row_ror:4 row_mask:0xf bank_mask:0xf
    s_nop 1
    v_add_f32_dpp v81, v81, v81 row_ror:2 row_mask:0xf bank_mask:0xf
    s_nop 1
    v_add_f32_dpp v81, v81, v81 row_ror:1 row_mask:0xf bank_mask:0xf
    v_mov_b32 v82, v81
    s_nop 1
    v_permlane16_swap_b32 v81, v82
    v_add_f32 v81, v81, v82
    v_mov_b32 v82, v81
    s_nop 1
    v_permlane32_swap_b32 v81, v82
    v_add_f32 v81, v81, v82
    v_mul_f32 v81, 0x3b000000, v81
    v_cvt_pk_bf16_f32 v80, v80, v80
    v_and_b32 v80, 0xffff0000, v80
    v_cvt_pk_bf16_f32 v81, v81, v81
    v_and_b32 v81, 0xffff0000, v81
    v_add_f32 v81, 0x3727c5ac, v81
    v_cvt_pk_bf16_f32 v81, v81, v81
    v_and_b32 v81, 0xffff0000, v81
    v_sqrt_f32 v81, v81
    s_nop 0
    v_cvt_pk_bf16_f32 v81, v81, v81
    v_and_b32 v81, 0xffff0000, v81
    v_rcp_f32 v81, v81
    v_sub_f32 v68, v52, v80
    v_sub_f32 v69, v53, v80
    v_sub_f32 v70, v54, v80
    v_sub_f32 v71, v55, v80
    v_sub_f32 v72, v56, v80
    v_sub_f32 v73, v57, v80
    v_sub_f32 v74, v58, v80
    v_sub_f32 v75, v59, v80
    v_cvt_pk_bf16_f32 v82, v68, v69
    v_lshlrev_b32 v68, 16, v82
    v_and_b32 v69, 0xffff0000, v82
    v_cvt_pk_bf16_f32 v82, v70, v71
    v_lshlrev_b32 v70, 16, v82
    v_and_b32 v71, 0xffff0000, v82
    v_cvt_pk_bf16_f32 v82, v72, v73
    v_lshlrev_b32 v72, 16, v82
    v_and_b32 v73, 0xffff0000, v82
    v_cvt_pk_bf16_f32 v82, v74, v75
    v_lshlrev_b32 v74, 16, v82
    v_and_b32 v75, 0xffff0000, v82
    v_mul_f32 v68, v68, v81
    v_mul_f32 v69, v69, v81
    v_mul_f32 v70, v70, v81
    v_mul_f32 v71, v71, v81
    v_mul_f32 v72, v72, v81
    v_mul_f32 v73, v73, v81
    v_mul_f32 v74, v74, v81
    v_mul_f32 v75, v75, v81
    v_cvt_pk_bf16_f32 v64, v68, v69
    v_cvt_pk_bf16_f32 v65, v70, v71
    v_cvt_pk_bf16_f32 v66, v72, v73
    v_cvt_pk_bf16_f32 v67, v74, v75
    s_add_u32 s40, s54, 126877696
    s_add_u32 s78, s47, 398592
    buffer_store_dwordx2 v[64:65], v1, s[4:7], s40 offen sc1
    buffer_store_dwordx2 v[66:67], v1, s[4:7], s40 offen offset:512 sc1
rfin_147:
    s_add_u32 s53, s53, 4
    s_lshl_b32 s54, s37, 5
    s_add_u32 s54, s54, s53
    s_lshl_b32 s54, s54, 10
    v_add_f32 v164, v164, v172
    v_add_f32 v165, v165, v173
    v_add_f32 v166, v166, v174
    v_add_f32 v167, v167, v175
    v_add_f32 v168, v168, v176
    v_add_f32 v169, v169, v177
    v_add_f32 v170, v170, v178
    v_add_f32 v171, v171, v179
    v_lshlrev_b32 v52, 16, v200
    v_and_b32 v53, 0xffff0000, v200
    v_lshlrev_b32 v54, 16, v201
    v_and_b32 v55, 0xffff0000, v201
    v_lshlrev_b32 v56, 16, v202
    v_and_b32 v57, 0xffff0000, v202
    v_lshlrev_b32 v58, 16, v203
    v_and_b32 v59, 0xffff0000, v203
    v_cvt_pk_bf16_f32 v82, v164, v165
    v_lshlrev_b32 v164, 16, v82
    v_and_b32 v165, 0xffff0000, v82
    v_cvt_pk_bf16_f32 v82, v166, v167
    v_lshlrev_b32 v166, 16, v82
    v_and_b32 v167, 0xffff0000, v82
    v_cvt_pk_bf16_f32 v82, v168, v169
    v_lshlrev_b32 v168, 16, v82
    v_and_b32 v169, 0xffff0000, v82
    v_cvt_pk_bf16_f32 v82, v170, v171
    v_lshlrev_b32 v170, 16, v82
    v_and_b32 v171, 0xffff0000, v82
    v_add_f32 v52, v52, v164
    v_add_f32 v53, v53, v165
    v_add_f32 v54, v54, v166
    v_add_f32 v55, v55, v167
    v_add_f32 v56, v56, v168
    v_add_f32 v57, v57, v169
    v_add_f32 v58, v58, v170
    v_add_f32 v59, v59, v171
    v_cvt_pk_bf16_f32 v208, v52, v53
    v_cvt_pk_bf16_f32 v209, v54, v55
    v_cvt_pk_bf16_f32 v210, v56, v57
    v_cvt_pk_bf16_f32 v211, v58, v59
    s_cmp_eq_u32 s36, 0
    s_cbranch_scc1 r5l1_150
    buffer_store_dwordx2 v[208:209], v1, s[20:23], s54 offen
    buffer_store_dwordx2 v[210:211], v1, s[20:23], s54 offen offset:512
    s_mov_b32 s78, 0
    s_branch rfin_149
r5l1_150:
    s_add_u32 s40, s54, 128974848
    buffer_store_dwordx2 v[208:209], v1, s[4:7], s40 offen sc1
    buffer_store_dwordx2 v[210:211], v1, s[4:7], s40 offen offset:512 sc1
    v_lshlrev_b32 v52, 16, v208
    v_and_b32 v53, 0xffff0000, v208
    v_lshlrev_b32 v54, 16, v209
    v_and_b32 v55, 0xffff0000, v209
    v_lshlrev_b32 v56, 16, v210
    v_and_b32 v57, 0xffff0000, v210
    v_lshlrev_b32 v58, 16, v211
    v_and_b32 v59, 0xffff0000, v211
    v_add_f32 v80, v52, v53
    v_add_f32 v82, v54, v55
    v_add_f32 v81, v56, v57
    v_add_f32 v80, v80, v82
    v_add_f32 v82, v58, v59
    v_add_f32 v81, v81, v82
    v_add_f32 v80, v80, v81
    s_nop 1
    v_add_f32_dpp v80, v80, v80 row_ror:8 row_mask:0xf bank_mask:0xf
    s_nop 1
    v_add_f32_dpp v80, v80, v80 row_ror:4 row_mask:0xf bank_mask:0xf
    s_nop 1
    v_add_f32_dpp v80, v80, v80 row_ror:2 row_mask:0xf bank_mask:0xf
    s_nop 1
    v_add_f32_dpp v80, v80, v80 row_ror:1 row_mask:0xf bank_mask:0xf
    v_mov_b32 v82, v80
    s_nop 1
    v_permlane16_swap_b32 v80, v82
    v_add_f32 v80, v80, v82
    v_mov_b32 v82, v80
    s_nop 1
    v_permlane32_swap_b32 v80, v82
    v_add_f32 v80, v80, v82
    v_mul_f32 v80, 0x3b000000, v80
    v_sub_f32 v220, v52, v80
    v_sub_f32 v221, v53, v80
    v_sub_f32 v222, v54, v80
    v_sub_f32 v223, v55, v80
    v_sub_f32 v224, v56, v80
    v_sub_f32 v225, v57, v80
    v_sub_f32 v226, v58, v80
    v_sub_f32 v227, v59, v80
    v_mul_f32 v81, v220, v220
    v_fmac_f32 v81, v221, v221
    v_fmac_f32 v81, v222, v222
    v_fmac_f32 v81, v223, v223
    v_fmac_f32 v81, v224, v224
    v_fmac_f32 v81, v225, v225
    v_fmac_f32 v81, v226, v226
    v_fmac_f32 v81, v227, v227
    s_nop 1
    v_add_f32_dpp v81, v81, v81 row_ror:8 row_mask:0xf bank_mask:0xf
    s_nop 1
    v_add_f32_dpp v81, v81, v81 row_ror:4 row_mask:0xf bank_mask:0xf
    s_nop 1
    v_add_f32_dpp v81, v81, v81 row_ror:2 row_mask:0xf bank_mask:0xf
    s_nop 1
    v_add_f32_dpp v81, v81, v81 row_ror:1 row_mask:0xf bank_mask:0xf
    v_mov_b32 v82, v81
    s_nop 1
    v_permlane16_swap_b32 v81, v82
    v_add_f32 v81, v81, v82
    v_mov_b32 v82, v81
    s_nop 1
    v_permlane32_swap_b32 v81, v82
    v_add_f32 v81, v81, v82
    v_mul_f32 v81, 0x3b000000, v81
    v_cvt_pk_bf16_f32 v80, v80, v80
    v_and_b32 v80, 0xffff0000, v80
    v_cvt_pk_bf16_f32 v81, v81, v81
    v_and_b32 v81, 0xffff0000, v81
    v_add_f32 v81, 0x3727c5ac, v81
    v_cvt_pk_bf16_f32 v81, v81, v81
    v_and_b32 v81, 0xffff0000, v81
    v_sqrt_f32 v81, v81
    s_nop 0
    v_cvt_pk_bf16_f32 v81, v81, v81
    v_and_b32 v81, 0xffff0000, v81
    v_rcp_f32 v81, v81
    v_sub_f32 v220, v52, v80
    v_sub_f32 v221, v53, v80
    v_sub_f32 v222, v54, v80
    v_sub_f32 v223, v55, v80
    v_sub_f32 v224, v56, v80
    v_sub_f32 v225, v57, v80
    v_sub_f32 v226, v58, v80
    v_sub_f32 v227, v59, v80
    v_cvt_pk_bf16_f32 v82, v220, v221
    v_lshlrev_b32 v220, 16, v82
    v_and_b32 v221, 0xffff0000, v82
    v_cvt_pk_bf16_f32 v82, v222, v223
    v_lshlrev_b32 v222, 16, v82
    v_and_b32 v223, 0xffff0000, v82
    v_cvt_pk_bf16_f32 v82, v224, v225
    v_lshlrev_b32 v224, 16, v82
    v_and_b32 v225, 0xffff0000, v82
    v_cvt_pk_bf16_f32 v82, v226, v227
    v_lshlrev_b32 v226, 16, v82
    v_and_b32 v227, 0xffff0000, v82
    v_mul_f32 v220, v220, v81
    v_mul_f32 v221, v221, v81
    v_mul_f32 v222, v222, v81
    v_mul_f32 v223, v223, v81
    v_mul_f32 v224, v224, v81
    v_mul_f32 v225, v225, v81
    v_mul_f32 v226, v226, v81
    v_mul_f32 v227, v227, v81
    v_cvt_pk_bf16_f32 v216, v220, v221
    v_cvt_pk_bf16_f32 v217, v222, v223
    v_cvt_pk_bf16_f32 v218, v224, v225
    v_cvt_pk_bf16_f32 v219, v226, v227
    s_add_u32 s40, s54, 126877696
    s_add_u32 s78, s47, 398592
    buffer_store_dwordx2 v[216:217], v1, s[4:7], s40 offen sc1
    buffer_store_dwordx2 v[218:219], v1, s[4:7], s40 offen offset:512 sc1
rfin_149:
    s_sub_u32 s53, s53, 4
    s_mul_i32 s68, s34, 5
    s_add_u32 s68, s68, s32
    s_mul_i32 s69, s35, 5
    s_add_u32 s69, s69, s32
    s_min_u32 s42, s68, 255
    s_lshr_b32 s65, s42, 2
    s_mul_i32 s65, s65, 6144
    s_add_u32 s65, s65, 5248
    s_min_u32 s42, s69, 255
    s_lshr_b32 s66, s42, 2
    s_add_u32 s66, s66, 64
    s_mul_i32 s66, s66, 6144
    s_add_u32 s66, s66, 5248
    buffer_load_dword v90, v3, s[4:7], s65 offen sc1
    buffer_load_dword v91, v3, s[4:7], s66 offen sc1
    s_waitcnt vmcnt(2)
    s_cmp_eq_u32 s78, 0
    s_cbranch_scc1 r5s1_143
    s_barrier
    s_cmp_eq_u32 s30, 0
    s_cbranch_scc0 ws_151
    s_mov_b64 exec, 1
    v_mov_b32 v13, 2
    v_mov_b32 v14, 0
    buffer_atomic_add v13, v14, s[4:7], s78 offen
    s_mov_b64 exec, -1
ws_151:
r5s1_143:
    s_cmp_eq_u32 s79, 1
    s_cbranch_scc1 r5go_144
    s_mul_i32 s68, s34, 5
    s_add_u32 s68, s68, s32
    s_mul_i32 s69, s35, 5
    s_add_u32 s69, s69, s32
    s_min_u32 s42, s68, 255
    s_lshr_b32 s65, s42, 2
    s_mul_i32 s65, s65, 6144
    s_add_u32 s65, s65, 5248
    s_min_u32 s42, s69, 255
    s_lshr_b32 s66, s42, 2
    s_add_u32 s66, s66, 64
    s_mul_i32 s66, s66, 6144
    s_add_u32 s66, s66, 5248
    s_cmp_eq_u32 s30, 0
    s_cbranch_scc0 r5mp_152
r5mpl_153:
    buffer_load_dword v90, v3, s[4:7], s65 offen sc1
    buffer_load_dword v91, v3, s[4:7], s66 offen sc1
    s_waitcnt vmcnt(0)
    v_cmp_le_u32 vcc, 8, v90
    s_nop 3
    s_cmp_eq_u64 vcc, -1
    s_cselect_b32 s40, 1, 0
    s_cmp_lt_u32 s68, 256
    s_cselect_b32 s40, s40, 0
    v_cmp_le_u32 vcc, 8, v91
    s_nop 3
    s_cmp_eq_u64 vcc, -1
    s_cselect_b32 s41, 2, 0
    s_cmp_lt_u32 s69, 256
    s_cselect_b32 s41, s41, 0
    s_cmp_lg_u32 s40, 0
    s_cselect_b32 s67, s40, s41
    s_min_u32 s42, s68, s69
    s_cmp_ge_u32 s42, 256
    s_cselect_b32 s67, 3, s67
    s_cmp_lg_u32 s67, 0
    s_cbranch_scc1 r5mpd_154
    s_add_u32 s31, s31, 1
    s_cmp_gt_u32 s31, 300000
    s_cselect_b32 s67, 3, 0
    s_cbranch_scc1 r5mpd_154
    s_sleep 1
    s_branch r5mpl_153
r5mpd_154:
    v_mov_b32 v13, 163792
    v_mov_b32 v14, s67
    ds_write_b32 v13, v14
    s_waitcnt lgkmcnt(0)
r5mp_152:
    s_barrier
    v_mov_b32 v13, 163792
    ds_read_b32 v14, v13
    s_waitcnt lgkmcnt(0)
    v_readfirstlane_b32 s67, v14
    s_nop 3
    s_cmp_eq_u32 s67, 3
    s_cbranch_scc1 r5done_119
    s_sub_u32 s74, s67, 1
    s_cmp_eq_u32 s74, 0
    s_cselect_b32 s40, s68, s69
    s_lshr_b32 s75, s40, 2
    s_and_b32 s77, s40, 3
    s_lshl_b32 s77, s77, 3
    s_add_u32 s77, s77, s30
    s_xor_b32 s40, s74, 1
    s_add_u32 s34, s34, s40
    s_add_u32 s35, s35, s74
    s_lshl_b32 s40, s74, 6
    s_add_u32 s40, s40, s75
    s_mul_i32 s76, s40, 6144
    s_mul_i32 s48, s75, 131072
    s_add_u32 s48, s48, 118489088
    s_lshl_b32 s40, s77, 11
    s_add_u32 s48, s48, s40
    buffer_load_dwordx4 v[16:19], v2, s[4:7], s48 offen sc1
    buffer_load_dwordx4 v[20:23], v2, s[4:7], s48 offen offset:1024 sc1
    s_add_u32 s48, s48, 65536
    buffer_load_dwordx4 v[24:27], v2, s[4:7], s48 offen sc1
    buffer_load_dwordx4 v[28:31], v2, s[4:7], s48 offen offset:1024 sc1
    s_lshl_b32 s41, s75, 5
    s_add_u32 s41, s41, s77
    s_lshl_b32 s41, s41, 10
    s_mul_i32 s40, s74, 0
    s_add_u32 s40, s40, s41
    s_add_u32 s40, s40, 106954752
    buffer_load_dwordx2 v[92:93], v1, s[4:7], s40 offen sc1
    buffer_load_dwordx2 v[94:95], v1, s[4:7], s40 offen offset:512 sc1
    s_add_u32 s77, s77, 4
    s_mul_i32 s48, s75, 131072
    s_add_u32 s48, s48, 118489088
    s_lshl_b32 s40, s77, 11
    s_add_u32 s48, s48, s40
    buffer_load_dwordx4 v[100:103], v2, s[4:7], s48 offen sc1
    buffer_load_dwordx4 v[104:107], v2, s[4:7], s48 offen offset:1024 sc1
    s_add_u32 s48, s48, 65536
    buffer_load_dwordx4 v[108:111], v2, s[4:7], s48 offen sc1
    buffer_load_dwordx4 v[112:115], v2, s[4:7], s48 offen offset:1024 sc1
    s_lshl_b32 s41, s75, 5
    s_add_u32 s41, s41, s77
    s_lshl_b32 s41, s41, 10
    s_mul_i32 s40, s74, 0
    s_add_u32 s40, s40, s41
    s_add_u32 s40, s40, 106954752
    buffer_load_dwordx2 v[96:97], v1, s[4:7], s40 offen sc1
    buffer_load_dwordx2 v[98:99], v1, s[4:7], s40 offen offset:512 sc1
    s_sub_u32 s77, s77, 4
    s_mul_i32 s68, s34, 5
    s_add_u32 s68, s68, s32
    s_mul_i32 s69, s35, 5
    s_add_u32 s69, s69, s32
    s_min_u32 s42, s68, 255
    s_lshr_b32 s65, s42, 2
    s_mul_i32 s65, s65, 6144
    s_add_u32 s65, s65, 5248
    s_min_u32 s42, s69, 255
    s_lshr_b32 s66, s42, 2
    s_add_u32 s66, s66, 64
    s_mul_i32 s66, s66, 6144
    s_add_u32 s66, s66, 5248
    buffer_load_dword v90, v3, s[4:7], s65 offen sc1
    buffer_load_dword v91, v3, s[4:7], s66 offen sc1
    s_waitcnt vmcnt(0)
r5go_144:
    s_branch r5job0_120
r5done_119:
    s_waitcnt vmcnt(0)
    s_branch L_exit
L_r3:
    v_mov_b32 v3, 0
    s_mov_b32 s32, s33
    s_cmp_lt_u32 s32, 7
    s_cselect_b32 s34, 0, 512
    s_cselect_b32 s35, 512, 0
    s_cselect_b32 s40, 0, 7
    s_sub_u32 s32, s32, s40
    s_mul_i32 s68, s34, 7
    s_add_u32 s68, s68, s32
    s_mul_i32 s69, s35, 7
    s_add_u32 s69, s69, s32
    s_min_u32 s42, s68, 255
    s_lshr_b32 s65, s42, 2
    s_mul_i32 s65, s65, 6144
    s_add_u32 s65, s65, 4736
    s_min_u32 s42, s69, 255
    s_lshr_b32 s66, s42, 2
    s_add_u32 s66, s66, 64
    s_mul_i32 s66, s66, 6144
    s_add_u32 s66, s66, 4736
    s_cmp_eq_u32 s30, 0
    s_cbranch_scc0 r3mp_158
r3mpl_159:
    buffer_load_dword v90, v3, s[4:7], s65 offen sc1
    buffer_load_dword v91, v3, s[4:7], s66 offen sc1
    s_waitcnt vmcnt(0)
    v_cmp_le_u32 vcc, 16, v90
    s_nop 3
    s_cmp_eq_u64 vcc, -1
    s_cselect_b32 s40, 1, 0
    s_cmp_lt_u32 s68, 256
    s_cselect_b32 s40, s40, 0
    v_cmp_le_u32 vcc, 16, v91
    s_nop 3
    s_cmp_eq_u64 vcc, -1
    s_cselect_b32 s41, 2, 0
    s_cmp_lt_u32 s69, 256
    s_cselect_b32 s41, s41, 0
    s_cmp_lg_u32 s40, 0
    s_cselect_b32 s67, s40, s41
    s_min_u32 s42, s68, s69
    s_cmp_ge_u32 s42, 256
    s_cselect_b32 s67, 3, s67
    s_cmp_lg_u32 s67, 0
    s_cbranch_scc1 r3mpd_160
    s_add_u32 s31, s31, 1
    s_cmp_gt_u32 s31, 300000
    s_cselect_b32 s67, 3, 0
    s_cbranch_scc1 r3mpd_160
    s_sleep 1
    s_branch r3mpl_159
r3mpd_160:
    v_mov_b32 v13, 163792
    v_mov_b32 v14, s67
    ds_write_b32 v13, v14
    s_waitcnt lgkmcnt(0)
r3mp_158:
    s_barrier
    v_mov_b32 v13, 163792
    ds_read_b32 v14, v13
    s_waitcnt lgkmcnt(0)
    v_readfirstlane_b32 s67, v14
    s_nop 3
    s_cmp_eq_u32 s67, 3
    s_cbranch_scc1 r3done_155
    s_sub_u32 s74, s67, 1
    s_cmp_eq_u32 s74, 0
    s_cselect_b32 s40, s68, s69
    s_lshr_b32 s75, s40, 2
    s_and_b32 s77, s40, 3
    s_lshl_b32 s77, s77, 3
    s_add_u32 s77, s77, s30
    s_xor_b32 s40, s74, 1
    s_add_u32 s34, s34, s40
    s_add_u32 s35, s35, s74
    s_lshl_b32 s40, s74, 6
    s_add_u32 s40, s40, s75
    s_mul_i32 s76, s40, 6144
    s_mul_i32 s48, s75, 262144
    s_add_u32 s48, s48, 90177536
    s_lshl_b32 s40, s77, 11
    s_add_u32 s48, s48, s40
    buffer_load_dwordx4 v[16:19], v2, s[4:7], s48 offen sc1
    buffer_load_dwordx4 v[20:23], v2, s[4:7], s48 offen offset:1024 sc1
    s_add_u32 s48, s48, 65536
    buffer_load_dwordx4 v[24:27], v2, s[4:7], s48 offen sc1
    buffer_load_dwordx4 v[28:31], v2, s[4:7], s48 offen offset:1024 sc1
    s_add_u32 s48, s48, 65536
    buffer_load_dwordx4 v[32:35], v2, s[4:7], s48 offen sc1
    buffer_load_dwordx4 v[36:39], v2, s[4:7], s48 offen offset:1024 sc1
    s_add_u32 s48, s48, 65536
    buffer_load_dwordx4 v[40:43], v2, s[4:7], s48 offen sc1
    buffer_load_dwordx4 v[44:47], v2, s[4:7], s48 offen offset:1024 sc1
    s_lshl_b32 s41, s75, 5
    s_add_u32 s41, s41, s77
    s_lshl_b32 s41, s41, 10
    s_cmp_eq_u32 s74, 0
    s_cbranch_scc0 rin_161
    buffer_load_dwordx2 v[92:93], v1, s[16:19], s41 offen
    buffer_load_dwordx2 v[94:95], v1, s[16:19], s41 offen offset:512
    s_branch rin_162
rin_161:
    s_add_u32 s40, s41, 128974848
    buffer_load_dwordx2 v[92:93], v1, s[4:7], s40 offen sc1
    buffer_load_dwordx2 v[94:95], v1, s[4:7], s40 offen offset:512 sc1
rin_162:
    s_add_u32 s77, s77, 4
    s_mul_i32 s48, s75, 262144
    s_add_u32 s48, s48, 90177536
    s_lshl_b32 s40, s77, 11
    s_add_u32 s48, s48, s40
    buffer_load_dwordx4 v[100:103], v2, s[4:7], s48 offen sc1
    buffer_load_dwordx4 v[104:107], v2, s[4:7], s48 offen offset:1024 sc1
    s_add_u32 s48, s48, 65536
    buffer_load_dwordx4 v[108:111], v2, s[4:7], s48 offen sc1
    buffer_load_dwordx4 v[112:115], v2, s[4:7], s48 offen offset:1024 sc1
    s_add_u32 s48, s48, 65536
    buffer_load_dwordx4 v[116:119], v2, s[4:7], s48 offen sc1
    buffer_load_dwordx4 v[120:123], v2, s[4:7], s48 offen offset:1024 sc1
    s_add_u32 s48, s48, 65536
    buffer_load_dwordx4 v[124:127], v2, s[4:7], s48 offen sc1
    buffer_load_dwordx4 v[128:131], v2, s[4:7], s48 offen offset:1024 sc1
    s_lshl_b32 s41, s75, 5
    s_add_u32 s41, s41, s77
    s_lshl_b32 s41, s41, 10
    s_cmp_eq_u32 s74, 0
    s_cbranch_scc0 rin_163
    buffer_load_dwordx2 v[96:97], v1, s[16:19], s41 offen
    buffer_load_dwordx2 v[98:99], v1, s[16:19], s41 offen offset:512
    s_branch rin_164
rin_163:
    s_add_u32 s40, s41, 128974848
    buffer_load_dwordx2 v[96:97], v1, s[4:7], s40 offen sc1
    buffer_load_dwordx2 v[98:99], v1, s[4:7], s40 offen offset:512 sc1
rin_164:
    s_sub_u32 s77, s77, 4
    s_mul_i32 s68, s34, 7
    s_add_u32 s68, s68, s32
    s_mul_i32 s69, s35, 7
    s_add_u32 s69, s69, s32
    s_min_u32 s42, s68, 255
    s_lshr_b32 s65, s42, 2
    s_mul_i32 s65, s65, 6144
    s_add_u32 s65, s65, 4736
    s_min_u32 s42, s69, 255
    s_lshr_b32 s66, s42, 2
    s_add_u32 s66, s66, 64
    s_mul_i32 s66, s66, 6144
    s_add_u32 s66, s66, 4736
    buffer_load_dword v90, v3, s[4:7], s65 offen sc1
    buffer_load_dword v91, v3, s[4:7], s66 offen sc1
    s_waitcnt vmcnt(0)
    s_mov_b32 s78, 0
r3job0_156:
    s_mov_b32 s36, s74
    s_mov_b32 s37, s75
    s_mov_b32 s47, s76
    s_mov_b32 s53, s77
    s_cmp_eq_u32 s78, 0
    s_cbranch_scc1 r3v_170
    s_waitcnt vmcnt(1)
    s_branch r3v2_171
r3v_170:
    s_waitcnt vmcnt(0)
r3v2_171:
    s_cmp_eq_u32 s30, 0
    s_cbranch_scc0 r3w0_166
    v_cmp_le_u32 vcc, 16, v90
    s_nop 3
    s_cmp_eq_u64 vcc, -1
    s_cselect_b32 s40, 1, 0
    s_cmp_lt_u32 s68, 256
    s_cselect_b32 s40, s40, 0
    v_cmp_le_u32 vcc, 16, v91
    s_nop 3
    s_cmp_eq_u64 vcc, -1
    s_cselect_b32 s41, 2, 0
    s_cmp_lt_u32 s69, 256
    s_cselect_b32 s41, s41, 0
    s_cmp_lg_u32 s40, 0
    s_cselect_b32 s67, s40, s41
    s_min_u32 s42, s68, s69
    s_cmp_ge_u32 s42, 256
    s_cselect_b32 s67, 3, s67
    v_mov_b32 v13, 163792
    v_mov_b32 v14, s67
    ds_write_b32 v13, v14
    s_waitcnt lgkmcnt(0)
r3w0_166:
    s_barrier
    v_mov_b32 v13, 163792
    ds_read_b32 v14, v13
    s_waitcnt lgkmcnt(0)
    v_readfirstlane_b32 s67, v14
    s_mov_b32 s79, 0
    s_nop 2
    s_sub_u32 s40, s67, 1
    s_cmp_lt_u32 s40, 2
    s_cbranch_scc0 r3c_167
    s_sub_u32 s74, s67, 1
    s_cmp_eq_u32 s74, 0
    s_cselect_b32 s40, s68, s69
    s_lshr_b32 s75, s40, 2
    s_and_b32 s77, s40, 3
    s_lshl_b32 s77, s77, 3
    s_add_u32 s77, s77, s30
    s_xor_b32 s40, s74, 1
    s_add_u32 s34, s34, s40
    s_add_u32 s35, s35, s74
    s_lshl_b32 s40, s74, 6
    s_add_u32 s40, s40, s75
    s_mul_i32 s76, s40, 6144
    s_mul_i32 s48, s75, 262144
    s_add_u32 s48, s48, 90177536
    s_lshl_b32 s40, s77, 11
    s_add_u32 s48, s48, s40
    buffer_load_dwordx4 v[132:135], v2, s[4:7], s48 offen sc1
    buffer_load_dwordx4 v[136:139], v2, s[4:7], s48 offen offset:1024 sc1
    s_add_u32 s48, s48, 65536
    buffer_load_dwordx4 v[140:143], v2, s[4:7], s48 offen sc1
    buffer_load_dwordx4 v[144:147], v2, s[4:7], s48 offen offset:1024 sc1
    s_add_u32 s48, s48, 65536
    buffer_load_dwordx4 v[148:151], v2, s[4:7], s48 offen sc1
    buffer_load_dwordx4 v[152:155], v2, s[4:7], s48 offen offset:1024 sc1
    s_add_u32 s48, s48, 65536
    buffer_load_dwordx4 v[156:159], v2, s[4:7], s48 offen sc1
    buffer_load_dwordx4 v[160:163], v2, s[4:7], s48 offen offset:1024 sc1
    s_lshl_b32 s41, s75, 5
    s_add_u32 s41, s41, s77
    s_lshl_b32 s41, s41, 10
    s_cmp_eq_u32 s74, 0
    s_cbranch_scc0 rin_172
    buffer_load_dwordx2 v[196:197], v1, s[16:19], s41 offen
    buffer_load_dwordx2 v[198:199], v1, s[16:19], s41 offen offset:512
    s_branch rin_173
rin_172:
    s_add_u32 s40, s41, 128974848
    buffer_load_dwordx2 v[196:197], v1, s[4:7], s40 offen sc1
    buffer_load_dwordx2 v[198:199], v1, s[4:7], s40 offen offset:512 sc1
rin_173:
    s_add_u32 s77, s77, 4
    s_mul_i32 s48, s75, 262144
    s_add_u32 s48, s48, 90177536
    s_lshl_b32 s40, s77, 11
    s_add_u32 s48, s48, s40
    buffer_load_dwordx4 v[164:167], v2, s[4:7], s48 offen sc1
    buffer_load_dwordx4 v[168:171], v2, s[4:7], s48 offen offset:1024 sc1
    s_add_u32 s48, s48, 65536
    buffer_load_dwordx4 v[172:175], v2, s[4:7], s48 offen sc1
    buffer_load_dwordx4 v[176:179], v2, s[4:7], s48 offen offset:1024 sc1
    s_add_u32 s48, s48, 65536
    buffer_load_dwordx4 v[180:183], v2, s[4:7], s48 offen sc1
    buffer_load_dwordx4 v[184:187], v2, s[4:7], s48 offen offset:1024 sc1
    s_add_u32 s48, s48, 65536
    buffer_load_dwordx4 v[188:191], v2, s[4:7], s48 offen sc1
    buffer_load_dwordx4 v[192:195], v2, s[4:7], s48 offen offset:1024 sc1
    s_lshl_b32 s41, s75, 5
    s_add_u32 s41, s41, s77
    s_lshl_b32 s41, s41, 10
    s_cmp_eq_u32 s74, 0
    s_cbranch_scc0 rin_174
    buffer_load_dwordx2 v[200:201], v1, s[16:19], s41 offen
    buffer_load_dwordx2 v[202:203], v1, s[16:19], s41 offen offset:512
    s_branch rin_175
rin_174:
    s_add_u32 s40, s41, 128974848
    buffer_load_dwordx2 v[200:201], v1, s[4:7], s40 offen sc1
    buffer_load_dwordx2 v[202:203], v1, s[4:7], s40 offen offset:512 sc1
rin_175:
    s_sub_u32 s77, s77, 4
    s_mov_b32 s79, 1
r3c_167:
    s_lshl_b32 s54, s37, 5
    s_add_u32 s54, s54, s53
    s_lshl_b32 s54, s54, 10
    v_add_f32 v16, v16, v24
    v_add_f32 v17, v17, v25
    v_add_f32 v18, v18, v26
    v_add_f32 v19, v19, v27
    v_add_f32 v20, v20, v28
    v_add_f32 v21, v21, v29
    v_add_f32 v22, v22, v30
    v_add_f32 v23, v23, v31
    v_add_f32 v16, v16, v32
    v_add_f32 v17, v17, v33
    v_add_f32 v18, v18, v34
    v_add_f32 v19, v19, v35
    v_add_f32 v20, v20, v36
    v_add_f32 v21, v21, v37
    v_add_f32 v22, v22, v38
    v_add_f32 v23, v23, v39
    v_add_f32 v16, v16, v40
    v_add_f32 v17, v17, v41
    v_add_f32 v18, v18, v42
    v_add_f32 v19, v19, v43
    v_add_f32 v20, v20, v44
    v_add_f32 v21, v21, v45
    v_add_f32 v22, v22, v46
    v_add_f32 v23, v23, v47
    v_lshlrev_b32 v52, 16, v92
    v_and_b32 v53, 0xffff0000, v92
    v_lshlrev_b32 v54, 16, v93
    v_and_b32 v55, 0xffff0000, v93
    v_lshlrev_b32 v56, 16, v94
    v_and_b32 v57, 0xffff0000, v94
    v_lshlrev_b32 v58, 16, v95
    v_and_b32 v59, 0xffff0000, v95
    v_cvt_pk_bf16_f32 v82, v16, v17
    v_lshlrev_b32 v16, 16, v82
    v_and_b32 v17, 0xffff0000, v82
    v_cvt_pk_bf16_f32 v82, v18, v19
    v_lshlrev_b32 v18, 16, v82
    v_and_b32 v19, 0xffff0000, v82
    v_cvt_pk_bf16_f32 v82, v20, v21
    v_lshlrev_b32 v20, 16, v82
    v_and_b32 v21, 0xffff0000, v82
    v_cvt_pk_bf16_f32 v82, v22, v23
    v_lshlrev_b32 v22, 16, v82
    v_and_b32 v23, 0xffff0000, v82
    v_add_f32 v52, v52, v16
    v_add_f32 v53, v53, v17
    v_add_f32 v54, v54, v18
    v_add_f32 v55, v55, v19
    v_add_f32 v56, v56, v20
    v_add_f32 v57, v57, v21
    v_add_f32 v58, v58, v22
    v_add_f32 v59, v59, v23
    v_cvt_pk_bf16_f32 v48, v52, v53
    v_cvt_pk_bf16_f32 v49, v54, v55
    v_cvt_pk_bf16_f32 v50, v56, v57
    v_cvt_pk_bf16_f32 v51, v58, v59
    s_mul_i32 s40, s36, 0
    s_add_u32 s40, s40, s54
    s_add_u32 s40, s40, 106954752
    buffer_store_dwordx2 v[48:49], v1, s[4:7], s40 offen sc1
    buffer_store_dwordx2 v[50:51], v1, s[4:7], s40 offen offset:512 sc1
    v_lshlrev_b32 v52, 16, v48
    v_and_b32 v53, 0xffff0000, v48
    v_lshlrev_b32 v54, 16, v49
    v_and_b32 v55, 0xffff0000, v49
    v_lshlrev_b32 v56, 16, v50
    v_and_b32 v57, 0xffff0000, v50
    v_lshlrev_b32 v58, 16, v51
    v_and_b32 v59, 0xffff0000, v51
    v_add_f32 v80, v52, v53
    v_add_f32 v82, v54, v55
    v_add_f32 v81, v56, v57
    v_add_f32 v80, v80, v82
    v_add_f32 v82, v58, v59
    v_add_f32 v81, v81, v82
    v_add_f32 v80, v80, v81
    s_nop 1
    v_add_f32_dpp v80, v80, v80 row_ror:8 row_mask:0xf bank_mask:0xf
    s_nop 1
    v_add_f32_dpp v80, v80, v80 row_ror:4 row_mask:0xf bank_mask:0xf
    s_nop 1
    v_add_f32_dpp v80, v80, v80 row_ror:2 row_mask:0xf bank_mask:0xf
    s_nop 1
    v_add_f32_dpp v80, v80, v80 row_ror:1 row_mask:0xf bank_mask:0xf
    v_mov_b32 v82, v80
    s_nop 1
    v_permlane16_swap_b32 v80, v82
    v_add_f32 v80, v80, v82
    v_mov_b32 v82, v80
    s_nop 1
    v_permlane32_swap_b32 v80, v82
    v_add_f32 v80, v80, v82
    v_mul_f32 v80, 0x3b000000, v80
    v_sub_f32 v68, v52, v80
    v_sub_f32 v69, v53, v80
    v_sub_f32 v70, v54, v80
    v_sub_f32 v71, v55, v80
    v_sub_f32 v72, v56, v80
    v_sub_f32 v73, v57, v80
    v_sub_f32 v74, v58, v80
    v_sub_f32 v75, v59, v80
    v_mul_f32 v81, v68, v68
    v_fmac_f32 v81, v69, v69
    v_fmac_f32 v81, v70, v70
    v_fmac_f32 v81, v71, v71
    v_fmac_f32 v81, v72, v72
    v_fmac_f32 v81, v73, v73
    v_fmac_f32 v81, v74, v74
    v_fmac_f32 v81, v75, v75
    s_nop 1
    v_add_f32_dpp v81, v81, v81 row_ror:8 row_mask:0xf bank_mask:0xf
    s_nop 1
    v_add_f32_dpp v81, v81, v81 row_ror:4 row_mask:0xf bank_mask:0xf
    s_nop 1
    v_add_f32_dpp v81, v81, v81 row_ror:2 row_mask:0xf bank_mask:0xf
    s_nop 1
    v_add_f32_dpp v81, v81, v81 row_ror:1 row_mask:0xf bank_mask:0xf
    v_mov_b32 v82, v81
    s_nop 1
    v_permlane16_swap_b32 v81, v82
    v_add_f32 v81, v81, v82
    v_mov_b32 v82, v81
    s_nop 1
    v_permlane32_swap_b32 v81, v82
    v_add_f32 v81, v81, v82
    v_mul_f32 v81, 0x3b000000, v81
    v_cvt_pk_bf16_f32 v80, v80, v80
    v_and_b32 v80, 0xffff0000, v80
    v_cvt_pk_bf16_f32 v81, v81, v81
    v_and_b32 v81, 0xffff0000, v81
    v_add_f32 v81, 0x3727c5ac, v81
    v_cvt_pk_bf16_f32 v81, v81, v81
    v_and_b32 v81, 0xffff0000, v81
    v_sqrt_f32 v81, v81
    s_nop 0
    v_cvt_pk_bf16_f32 v81, v81, v81
    v_and_b32 v81, 0xffff0000, v81
    v_rcp_f32 v81, v81
    v_sub_f32 v68, v52, v80
    v_sub_f32 v69, v53, v80
    v_sub_f32 v70, v54, v80
    v_sub_f32 v71, v55, v80
    v_sub_f32 v72, v56, v80
    v_sub_f32 v73, v57, v80
    v_sub_f32 v74, v58, v80
    v_sub_f32 v75, v59, v80
    v_cvt_pk_bf16_f32 v82, v68, v69
    v_lshlrev_b32 v68, 16, v82
    v_and_b32 v69, 0xffff0000, v82
    v_cvt_pk_bf16_f32 v82, v70, v71
    v_lshlrev_b32 v70, 16, v82
    v_and_b32 v71, 0xffff0000, v82
    v_cvt_pk_bf16_f32 v82, v72, v73
    v_lshlrev_b32 v72, 16, v82
    v_and_b32 v73, 0xffff0000, v82
    v_cvt_pk_bf16_f32 v82, v74, v75
    v_lshlrev_b32 v74, 16, v82
    v_and_b32 v75, 0xffff0000, v82
    v_mul_f32 v68, v68, v81
    v_mul_f32 v69, v69, v81
    v_mul_f32 v70, v70, v81
    v_mul_f32 v71, v71, v81
    v_mul_f32 v72, v72, v81
    v_mul_f32 v73, v73, v81
    v_mul_f32 v74, v74, v81
    v_mul_f32 v75, v75, v81
    v_cvt_pk_bf16_f32 v64, v68, v69
    v_cvt_pk_bf16_f32 v65, v70, v71
    v_cvt_pk_bf16_f32 v66, v72, v73
    v_cvt_pk_bf16_f32 v67, v74, v75
    s_mul_i32 s40, s36, 0
    s_add_u32 s40, s40, s54
    s_add_u32 s40, s40, 109051904
    s_add_u32 s78, s47, 4864
    buffer_store_dwordx2 v[64:65], v1, s[4:7], s40 offen sc1
    buffer_store_dwordx2 v[66:67], v1, s[4:7], s40 offen offset:512 sc1
rfin_176:
    s_add_u32 s53, s53, 4
    s_lshl_b32 s54, s37, 5
    s_add_u32 s54, s54, s53
    s_lshl_b32 s54, s54, 10
    v_add_f32 v100, v100, v108
    v_add_f32 v101, v101, v109
    v_add_f32 v102, v102, v110
    v_add_f32 v103, v103, v111
    v_add_f32 v104, v104, v112
    v_add_f32 v105, v105, v113
    v_add_f32 v106, v106, v114
    v_add_f32 v107, v107, v115
    v_add_f32 v100, v100, v116
    v_add_f32 v101, v101, v117
    v_add_f32 v102, v102, v118
    v_add_f32 v103, v103, v119
    v_add_f32 v104, v104, v120
    v_add_f32 v105, v105, v121
    v_add_f32 v106, v106, v122
    v_add_f32 v107, v107, v123
    v_add_f32 v100, v100, v124
    v_add_f32 v101, v101, v125
    v_add_f32 v102, v102, v126
    v_add_f32 v103, v103, v127
    v_add_f32 v104, v104, v128
    v_add_f32 v105, v105, v129
    v_add_f32 v106, v106, v130
    v_add_f32 v107, v107, v131
    v_lshlrev_b32 v52, 16, v96
    v_and_b32 v53, 0xffff0000, v96
    v_lshlrev_b32 v54, 16, v97
    v_and_b32 v55, 0xffff0000, v97
    v_lshlrev_b32 v56, 16, v98
    v_and_b32 v57, 0xffff0000, v98
    v_lshlrev_b32 v58, 16, v99
    v_and_b32 v59, 0xffff0000, v99
    v_cvt_pk_bf16_f32 v82, v100, v101
    v_lshlrev_b32 v100, 16, v82
    v_and_b32 v101, 0xffff0000, v82
    v_cvt_pk_bf16_f32 v82, v102, v103
    v_lshlrev_b32 v102, 16, v82
    v_and_b32 v103, 0xffff0000, v82
    v_cvt_pk_bf16_f32 v82, v104, v105
    v_lshlrev_b32 v104, 16, v82
    v_and_b32 v105, 0xffff0000, v82
    v_cvt_pk_bf16_f32 v82, v106, v107
    v_lshlrev_b32 v106, 16, v82
    v_and_b32 v107, 0xffff0000, v82
    v_add_f32 v52, v52, v100
    v_add_f32 v53, v53, v101
    v_add_f32 v54, v54, v102
    v_add_f32 v55, v55, v103
    v_add_f32 v56, v56, v104
    v_add_f32 v57, v57, v105
    v_add_f32 v58, v58, v106
    v_add_f32 v59, v59, v107
    v_cvt_pk_bf16_f32 v208, v52, v53
    v_cvt_pk_bf16_f32 v209, v54, v55
    v_cvt_pk_bf16_f32 v210, v56, v57
    v_cvt_pk_bf16_f32 v211, v58, v59
    s_mul_i32 s40, s36, 0
    s_add_u32 s40, s40, s54
    s_add_u32 s40, s40, 106954752
    buffer_store_dwordx2 v[208:209], v1, s[4:7], s40 offen sc1
    buffer_store_dwordx2 v[210:211], v1, s[4:7], s40 offen offset:512 sc1
    v_lshlrev_b32 v52, 16, v208
    v_and_b32 v53, 0xffff0000, v208
    v_lshlrev_b32 v54, 16, v209
    v_and_b32 v55, 0xffff0000, v209
    v_lshlrev_b32 v56, 16, v210
    v_and_b32 v57, 0xffff0000, v210
    v_lshlrev_b32 v58, 16, v211
    v_and_b32 v59, 0xffff0000, v211
    v_add_f32 v80, v52, v53
    v_add_f32 v82, v54, v55
    v_add_f32 v81, v56, v57
    v_add_f32 v80, v80, v82
    v_add_f32 v82, v58, v59
    v_add_f32 v81, v81, v82
    v_add_f32 v80, v80, v81
    s_nop 1
    v_add_f32_dpp v80, v80, v80 row_ror:8 row_mask:0xf bank_mask:0xf
    s_nop 1
    v_add_f32_dpp v80, v80, v80 row_ror:4 row_mask:0xf bank_mask:0xf
    s_nop 1
    v_add_f32_dpp v80, v80, v80 row_ror:2 row_mask:0xf bank_mask:0xf
    s_nop 1
    v_add_f32_dpp v80, v80, v80 row_ror:1 row_mask:0xf bank_mask:0xf
    v_mov_b32 v82, v80
    s_nop 1
    v_permlane16_swap_b32 v80, v82
    v_add_f32 v80, v80, v82
    v_mov_b32 v82, v80
    s_nop 1
    v_permlane32_swap_b32 v80, v82
    v_add_f32 v80, v80, v82
    v_mul_f32 v80, 0x3b000000, v80
    v_sub_f32 v220, v52, v80
    v_sub_f32 v221, v53, v80
    v_sub_f32 v222, v54, v80
    v_sub_f32 v223, v55, v80
    v_sub_f32 v224, v56, v80
    v_sub_f32 v225, v57, v80
    v_sub_f32 v226, v58, v80
    v_sub_f32 v227, v59, v80
    v_mul_f32 v81, v220, v220
    v_fmac_f32 v81, v221, v221
    v_fmac_f32 v81, v222, v222
    v_fmac_f32 v81, v223, v223
    v_fmac_f32 v81, v224, v224
    v_fmac_f32 v81, v225, v225
    v_fmac_f32 v81, v226, v226
    v_fmac_f32 v81, v227, v227
    s_nop 1
    v_add_f32_dpp v81, v81, v81 row_ror:8 row_mask:0xf bank_mask:0xf
    s_nop 1
    v_add_f32_dpp v81, v81, v81 row_ror:4 row_mask:0xf bank_mask:0xf
    s_nop 1
    v_add_f32_dpp v81, v81, v81 row_ror:2 row_mask:0xf bank_mask:0xf
    s_nop 1
    v_add_f32_dpp v81, v81, v81 row_ror:1 row_mask:0xf bank_mask:0xf
    v_mov_b32 v82, v81
    s_nop 1
    v_permlane16_swap_b32 v81, v82
    v_add_f32 v81, v81, v82
    v_mov_b32 v82, v81
    s_nop 1
    v_permlane32_swap_b32 v81, v82
    v_add_f32 v81, v81, v82
    v_mul_f32 v81, 0x3b000000, v81
    v_cvt_pk_bf16_f32 v80, v80, v80
    v_and_b32 v80, 0xffff0000, v80
    v_cvt_pk_bf16_f32 v81, v81, v81
    v_and_b32 v81, 0xffff0000, v81
    v_add_f32 v81, 0x3727c5ac, v81
    v_cvt_pk_bf16_f32 v81, v81, v81
    v_and_b32 v81, 0xffff0000, v81
    v_sqrt_f32 v81, v81
    s_nop 0
    v_cvt_pk_bf16_f32 v81, v81, v81
    v_and_b32 v81, 0xffff0000, v81
    v_rcp_f32 v81, v81
    v_sub_f32 v220, v52, v80
    v_sub_f32 v221, v53, v80
    v_sub_f32 v222, v54, v80
    v_sub_f32 v223, v55, v80
    v_sub_f32 v224, v56, v80
    v_sub_f32 v225, v57, v80
    v_sub_f32 v226, v58, v80
    v_sub_f32 v227, v59, v80
    v_cvt_pk_bf16_f32 v82, v220, v221
    v_lshlrev_b32 v220, 16, v82
    v_and_b32 v221, 0xffff0000, v82
    v_cvt_pk_bf16_f32 v82, v222, v223
    v_lshlrev_b32 v222, 16, v82
    v_and_b32 v223, 0xffff0000, v82
    v_cvt_pk_bf16_f32 v82, v224, v225
    v_lshlrev_b32 v224, 16, v82
    v_and_b32 v225, 0xffff0000, v82
    v_cvt_pk_bf16_f32 v82, v226, v227
    v_lshlrev_b32 v226, 16, v82
    v_and_b32 v227, 0xffff0000, v82
    v_mul_f32 v220, v220, v81
    v_mul_f32 v221, v221, v81
    v_mul_f32 v222, v222, v81
    v_mul_f32 v223, v223, v81
    v_mul_f32 v224, v224, v81
    v_mul_f32 v225, v225, v81
    v_mul_f32 v226, v226, v81
    v_mul_f32 v227, v227, v81
    v_cvt_pk_bf16_f32 v216, v220, v221
    v_cvt_pk_bf16_f32 v217, v222, v223
    v_cvt_pk_bf16_f32 v218, v224, v225
    v_cvt_pk_bf16_f32 v219, v226, v227
    s_mul_i32 s40, s36, 0
    s_add_u32 s40, s40, s54
    s_add_u32 s40, s40, 109051904
    s_add_u32 s78, s47, 4864
    buffer_store_dwordx2 v[216:217], v1, s[4:7], s40 offen sc1
    buffer_store_dwordx2 v[218:219], v1, s[4:7], s40 offen offset:512 sc1
rfin_177:
    s_sub_u32 s53, s53, 4
    s_mul_i32 s68, s34, 7
    s_add_u32 s68, s68, s32
    s_mul_i32 s69, s35, 7
    s_add_u32 s69, s69, s32
    s_min_u32 s42, s68, 255
    s_lshr_b32 s65, s42, 2
    s_mul_i32 s65, s65, 6144
    s_add_u32 s65, s65, 4736
    s_min_u32 s42, s69, 255
    s_lshr_b32 s66, s42, 2
    s_add_u32 s66, s66, 64
    s_mul_i32 s66, s66, 6144
    s_add_u32 s66, s66, 4736
    buffer_load_dword v90, v3, s[4:7], s65 offen sc1
    buffer_load_dword v91, v3, s[4:7], s66 offen sc1
    s_waitcnt vmcnt(2)
    s_cmp_eq_u32 s78, 0
    s_cbranch_scc1 r3s1_168
    s_barrier
    s_cmp_eq_u32 s30, 0
    s_cbranch_scc0 ws_178
    s_mov_b64 exec, 1
    v_mov_b32 v13, 2
    v_mov_b32 v14, 0
    buffer_atomic_add v13, v14, s[4:7], s78 offen
    s_mov_b64 exec, -1
ws_178:
r3s1_168:
    s_cmp_eq_u32 s79, 1
    s_cbranch_scc1 r3go_169
    s_mul_i32 s68, s34, 7
    s_add_u32 s68, s68, s32
    s_mul_i32 s69, s35, 7
    s_add_u32 s69, s69, s32
    s_min_u32 s42, s68, 255
    s_lshr_b32 s65, s42, 2
    s_mul_i32 s65, s65, 6144
    s_add_u32 s65, s65, 4736
    s_min_u32 s42, s69, 255
    s_lshr_b32 s66, s42, 2
    s_add_u32 s66, s66, 64
    s_mul_i32 s66, s66, 6144
    s_add_u32 s66, s66, 4736
    s_cmp_eq_u32 s30, 0
    s_cbranch_scc0 r3mp_179
r3mpl_180:
    buffer_load_dword v90, v3, s[4:7], s65 offen sc1
    buffer_load_dword v91, v3, s[4:7], s66 offen sc1
    s_waitcnt vmcnt(0)
    v_cmp_le_u32 vcc, 16, v90
    s_nop 3
    s_cmp_eq_u64 vcc, -1
    s_cselect_b32 s40, 1, 0
    s_cmp_lt_u32 s68, 256
    s_cselect_b32 s40, s40, 0
    v_cmp_le_u32 vcc, 16, v91
    s_nop 3
    s_cmp_eq_u64 vcc, -1
    s_cselect_b32 s41, 2, 0
    s_cmp_lt_u32 s69, 256
    s_cselect_b32 s41, s41, 0
    s_cmp_lg_u32 s40, 0
    s_cselect_b32 s67, s40, s41
    s_min_u32 s42, s68, s69
    s_cmp_ge_u32 s42, 256
    s_cselect_b32 s67, 3, s67
    s_cmp_lg_u32 s67, 0
    s_cbranch_scc1 r3mpd_181
    s_add_u32 s31, s31, 1
    s_cmp_gt_u32 s31, 300000
    s_cselect_b32 s67, 3, 0
    s_cbranch_scc1 r3mpd_181
    s_sleep 1
    s_branch r3mpl_180
r3mpd_181:
    v_mov_b32 v13, 163792
    v_mov_b32 v14, s67
    ds_write_b32 v13, v14
    s_waitcnt lgkmcnt(0)
r3mp_179:
    s_barrier
    v_mov_b32 v13, 163792
    ds_read_b32 v14, v13
    s_waitcnt lgkmcnt(0)
    v_readfirstlane_b32 s67, v14
    s_nop 3
    s_cmp_eq_u32 s67, 3
    s_cbranch_scc1 r3done_155
    s_sub_u32 s74, s67, 1
    s_cmp_eq_u32 s74, 0
    s_cselect_b32 s40, s68, s69
    s_lshr_b32 s75, s40, 2
    s_and_b32 s77, s40, 3
    s_lshl_b32 s77, s77, 3
    s_add_u32 s77, s77, s30
    s_xor_b32 s40, s74, 1
    s_add_u32 s34, s34, s40
    s_add_u32 s35, s35, s74
    s_lshl_b32 s40, s74, 6
    s_add_u32 s40, s40, s75
    s_mul_i32 s76, s40, 6144
    s_mul_i32 s48, s75, 262144
    s_add_u32 s48, s48, 90177536
    s_lshl_b32 s40, s77, 11
    s_add_u32 s48, s48, s40
    buffer_load_dwordx4 v[132:135], v2, s[4:7], s48 offen sc1
    buffer_load_dwordx4 v[136:139], v2, s[4:7], s48 offen offset:1024 sc1
    s_add_u32 s48, s48, 65536
    buffer_load_dwordx4 v[140:143], v2, s[4:7], s48 offen sc1
    buffer_load_dwordx4 v[144:147], v2, s[4:7], s48 offen offset:1024 sc1
    s_add_u32 s48, s48, 65536
    buffer_load_dwordx4 v[148:151], v2, s[4:7], s48 offen sc1
    buffer_load_dwordx4 v[152:155], v2, s[4:7], s48 offen offset:1024 sc1
    s_add_u32 s48, s48, 65536
    buffer_load_dwordx4 v[156:159], v2, s[4:7], s48 offen sc1
    buffer_load_dwordx4 v[160:163], v2, s[4:7], s48 offen offset:1024 sc1
    s_lshl_b32 s41, s75, 5
    s_add_u32 s41, s41, s77
    s_lshl_b32 s41, s41, 10
    s_cmp_eq_u32 s74, 0
    s_cbranch_scc0 rin_182
    buffer_load_dwordx2 v[196:197], v1, s[16:19], s41 offen
    buffer_load_dwordx2 v[198:199], v1, s[16:19], s41 offen offset:512
    s_branch rin_183
rin_182:
    s_add_u32 s40, s41, 128974848
    buffer_load_dwordx2 v[196:197], v1, s[4:7], s40 offen sc1
    buffer_load_dwordx2 v[198:199], v1, s[4:7], s40 offen offset:512 sc1
rin_183:
    s_add_u32 s77, s77, 4
    s_mul_i32 s48, s75, 262144
    s_add_u32 s48, s48, 90177536
    s_lshl_b32 s40, s77, 11
    s_add_u32 s48, s48, s40
    buffer_load_dwordx4 v[164:167], v2, s[4:7], s48 offen sc1
    buffer_load_dwordx4 v[168:171], v2, s[4:7], s48 offen offset:1024 sc1
    s_add_u32 s48, s48, 65536
    buffer_load_dwordx4 v[172:175], v2, s[4:7], s48 offen sc1
    buffer_load_dwordx4 v[176:179], v2, s[4:7], s48 offen offset:1024 sc1
    s_add_u32 s48, s48, 65536
    buffer_load_dwordx4 v[180:183], v2, s[4:7], s48 offen sc1
    buffer_load_dwordx4 v[184:187], v2, s[4:7], s48 offen offset:1024 sc1
    s_add_u32 s48, s48, 65536
    buffer_load_dwordx4 v[188:191], v2, s[4:7], s48 offen sc1
    buffer_load_dwordx4 v[192:195], v2, s[4:7], s48 offen offset:1024 sc1
    s_lshl_b32 s41, s75, 5
    s_add_u32 s41, s41, s77
    s_lshl_b32 s41, s41, 10
    s_cmp_eq_u32 s74, 0
    s_cbranch_scc0 rin_184
    buffer_load_dwordx2 v[200:201], v1, s[16:19], s41 offen
    buffer_load_dwordx2 v[202:203], v1, s[16:19], s41 offen offset:512
    s_branch rin_185
rin_184:
    s_add_u32 s40, s41, 128974848
    buffer_load_dwordx2 v[200:201], v1, s[4:7], s40 offen sc1
    buffer_load_dwordx2 v[202:203], v1, s[4:7], s40 offen offset:512 sc1
rin_185:
    s_sub_u32 s77, s77, 4
    s_mul_i32 s68, s34, 7
    s_add_u32 s68, s68, s32
    s_mul_i32 s69, s35, 7
    s_add_u32 s69, s69, s32
    s_min_u32 s42, s68, 255
    s_lshr_b32 s65, s42, 2
    s_mul_i32 s65, s65, 6144
    s_add_u32 s65, s65, 4736
    s_min_u32 s42, s69, 255
    s_lshr_b32 s66, s42, 2
    s_add_u32 s66, s66, 64
    s_mul_i32 s66, s66, 6144
    s_add_u32 s66, s66, 4736
    buffer_load_dword v90, v3, s[4:7], s65 offen sc1
    buffer_load_dword v91, v3, s[4:7], s66 offen sc1
    s_waitcnt vmcnt(0)
r3go_169:
r3job1_157:
    s_mov_b32 s36, s74
    s_mov_b32 s37, s75
    s_mov_b32 s47, s76
    s_mov_b32 s53, s77
    s_cmp_eq_u32 s78, 0
    s_cbranch_scc1 r3v_191
    s_waitcnt vmcnt(1)
    s_branch r3v2_192
r3v_191:
    s_waitcnt vmcnt(0)
r3v2_192:
    s_cmp_eq_u32 s30, 0
    s_cbranch_scc0 r3w0_187
    v_cmp_le_u32 vcc, 16, v90
    s_nop 3
    s_cmp_eq_u64 vcc, -1
    s_cselect_b32 s40, 1, 0
    s_cmp_lt_u32 s68, 256
    s_cselect_b32 s40, s40, 0
    v_cmp_le_u32 vcc, 16, v91
    s_nop 3
    s_cmp_eq_u64 vcc, -1
    s_cselect_b32 s41, 2, 0
    s_cmp_lt_u32 s69, 256
    s_cselect_b32 s41, s41, 0
    s_cmp_lg_u32 s40, 0
    s_cselect_b32 s67, s40, s41
    s_min_u32 s42, s68, s69
    s_cmp_ge_u32 s42, 256
    s_cselect_b32 s67, 3, s67
    v_mov_b32 v13, 163792
    v_mov_b32 v14, s67
    ds_write_b32 v13, v14
    s_waitcnt lgkmcnt(0)
r3w0_187:
    s_barrier
    v_mov_b32 v13, 163792
    ds_read_b32 v14, v13
    s_waitcnt lgkmcnt(0)
    v_readfirstlane_b32 s67, v14
    s_mov_b32 s79, 0
    s_nop 2
    s_sub_u32 s40, s67, 1
    s_cmp_lt_u32 s40, 2
    s_cbranch_scc0 r3c_188
    s_sub_u32 s74, s67, 1
    s_cmp_eq_u32 s74, 0
    s_cselect_b32 s40, s68, s69
    s_lshr_b32 s75, s40, 2
    s_and_b32 s77, s40, 3
    s_lshl_b32 s77, s77, 3
    s_add_u32 s77, s77, s30
    s_xor_b32 s40, s74, 1
    s_add_u32 s34, s34, s40
    s_add_u32 s35, s35, s74
    s_lshl_b32 s40, s74, 6
    s_add_u32 s40, s40, s75
    s_mul_i32 s76, s40, 6144
    s_mul_i32 s48, s75, 262144
    s_add_u32 s48, s48, 90177536
    s_lshl_b32 s40, s77, 11
    s_add_u32 s48, s48, s40
    buffer_load_dwordx4 v[16:19], v2, s[4:7], s48 offen sc1
    buffer_load_dwordx4 v[20:23], v2, s[4:7], s48 offen offset:1024 sc1
    s_add_u32 s48, s48, 65536
    buffer_load_dwordx4 v[24:27], v2, s[4:7], s48 offen sc1
    buffer_load_dwordx4 v[28:31], v2, s[4:7], s48 offen offset:1024 sc1
    s_add_u32 s48, s48, 65536
    buffer_load_dwordx4 v[32:35], v2, s[4:7], s48 offen sc1
    buffer_load_dwordx4 v[36:39], v2, s[4:7], s48 offen offset:1024 sc1
    s_add_u32 s48, s48, 65536
    buffer_load_dwordx4 v[40:43], v2, s[4:7], s48 offen sc1
    buffer_load_dwordx4 v[44:47], v2, s[4:7], s48 offen offset:1024 sc1
    s_lshl_b32 s41, s75, 5
    s_add_u32 s41, s41, s77
    s_lshl_b32 s41, s41, 10
    s_cmp_eq_u32 s74, 0
    s_cbranch_scc0 rin_193
    buffer_load_dwordx2 v[92:93], v1, s[16:19], s41 offen
    buffer_load_dwordx2 v[94:95], v1, s[16:19], s41 offen offset:512
    s_branch rin_194
rin_193:
    s_add_u32 s40, s41, 128974848
    buffer_load_dwordx2 v[92:93], v1, s[4:7], s40 offen sc1
    buffer_load_dwordx2 v[94:95], v1, s[4:7], s40 offen offset:512 sc1
rin_194:
    s_add_u32 s77, s77, 4
    s_mul_i32 s48, s75, 262144
    s_add_u32 s48, s48, 90177536
    s_lshl_b32 s40, s77, 11
    s_add_u32 s48, s48, s40
    buffer_load_dwordx4 v[100:103], v2, s[4:7], s48 offen sc1
    buffer_load_dwordx4 v[104:107], v2, s[4:7], s48 offen offset:1024 sc1
    s_add_u32 s48, s48, 65536
    buffer_load_dwordx4 v[108:111], v2, s[4:7], s48 offen sc1
    buffer_load_dwordx4 v[112:115], v2, s[4:7], s48 offen offset:1024 sc1
    s_add_u32 s48, s48, 65536
    buffer_load_dwordx4 v[116:119], v2, s[4:7], s48 offen sc1
    buffer_load_dwordx4 v[120:123], v2, s[4:7], s48 offen offset:1024 sc1
    s_add_u32 s48, s48, 65536
    buffer_load_dwordx4 v[124:127], v2, s[4:7], s48 offen sc1
    buffer_load_dwordx4 v[128:131], v2, s[4:7], s48 offen offset:1024 sc1
    s_lshl_b32 s41, s75, 5
    s_add_u32 s41, s41, s77
    s_lshl_b32 s41, s41, 10
    s_cmp_eq_u32 s74, 0
    s_cbranch_scc0 rin_195
    buffer_load_dwordx2 v[96:97], v1, s[16:19], s41 offen
    buffer_load_dwordx2 v[98:99], v1, s[16:19], s41 offen offset:512
    s_branch rin_196
rin_195:
    s_add_u32 s40, s41, 128974848
    buffer_load_dwordx2 v[96:97], v1, s[4:7], s40 offen sc1
    buffer_load_dwordx2 v[98:99], v1, s[4:7], s40 offen offset:512 sc1
rin_196:
    s_sub_u32 s77, s77, 4
    s_mov_b32 s79, 1
r3c_188:
    s_lshl_b32 s54, s37, 5
    s_add_u32 s54, s54, s53
    s_lshl_b32 s54, s54, 10
    v_add_f32 v132, v132, v140
    v_add_f32 v133, v133, v141
    v_add_f32 v134, v134, v142
    v_add_f32 v135, v135, v143
    v_add_f32 v136, v136, v144
    v_add_f32 v137, v137, v145
    v_add_f32 v138, v138, v146
    v_add_f32 v139, v139, v147
    v_add_f32 v132, v132, v148
    v_add_f32 v133, v133, v149
    v_add_f32 v134, v134, v150
    v_add_f32 v135, v135, v151
    v_add_f32 v136, v136, v152
    v_add_f32 v137, v137, v153
    v_add_f32 v138, v138, v154
    v_add_f32 v139, v139, v155
    v_add_f32 v132, v132, v156
    v_add_f32 v133, v133, v157
    v_add_f32 v134, v134, v158
    v_add_f32 v135, v135, v159
    v_add_f32 v136, v136, v160
    v_add_f32 v137, v137, v161
    v_add_f32 v138, v138, v162
    v_add_f32 v139, v139, v163
    v_lshlrev_b32 v52, 16, v196
    v_and_b32 v53, 0xffff0000, v196
    v_lshlrev_b32 v54, 16, v197
    v_and_b32 v55, 0xffff0000, v197
    v_lshlrev_b32 v56, 16, v198
    v_and_b32 v57, 0xffff0000, v198
    v_lshlrev_b32 v58, 16, v199
    v_and_b32 v59, 0xffff0000, v199
    v_cvt_pk_bf16_f32 v82, v132, v133
    v_lshlrev_b32 v132, 16, v82
    v_and_b32 v133, 0xffff0000, v82
    v_cvt_pk_bf16_f32 v82, v134, v135
    v_lshlrev_b32 v134, 16, v82
    v_and_b32 v135, 0xffff0000, v82
    v_cvt_pk_bf16_f32 v82, v136, v137
    v_lshlrev_b32 v136, 16, v82
    v_and_b32 v137, 0xffff0000, v82
    v_cvt_pk_bf16_f32 v82, v138, v139
    v_lshlrev_b32 v138, 16, v82
    v_and_b32 v139, 0xffff0000, v82
    v_add_f32 v52, v52, v132
    v_add_f32 v53, v53, v133
    v_add_f32 v54, v54, v134
    v_add_f32 v55, v55, v135
    v_add_f32 v56, v56, v136
    v_add_f32 v57, v57, v137
    v_add_f32 v58, v58, v138
    v_add_f32 v59, v59, v139
    v_cvt_pk_bf16_f32 v48, v52, v53
    v_cvt_pk_bf16_f32 v49, v54, v55
    v_cvt_pk_bf16_f32 v50, v56, v57
    v_cvt_pk_bf16_f32 v51, v58, v59
    s_mul_i32 s40, s36, 0
    s_add_u32 s40, s40, s54
    s_add_u32 s40, s40, 106954752
    buffer_store_dwordx2 v[48:49], v1, s[4:7], s40 offen sc1
    buffer_store_dwordx2 v[50:51], v1, s[4:7], s40 offen offset:512 sc1
    v_lshlrev_b32 v52, 16, v48
    v_and_b32 v53, 0xffff0000, v48
    v_lshlrev_b32 v54, 16, v49
    v_and_b32 v55, 0xffff0000, v49
    v_lshlrev_b32 v56, 16, v50
    v_and_b32 v57, 0xffff0000, v50
    v_lshlrev_b32 v58, 16, v51
    v_and_b32 v59, 0xffff0000, v51
    v_add_f32 v80, v52, v53
    v_add_f32 v82, v54, v55
    v_add_f32 v81, v56, v57
    v_add_f32 v80, v80, v82
    v_add_f32 v82, v58, v59
    v_add_f32 v81, v81, v82
    v_add_f32 v80, v80, v81
    s_nop 1
    v_add_f32_dpp v80, v80, v80 row_ror:8 row_mask:0xf bank_mask:0xf
    s_nop 1
    v_add_f32_dpp v80, v80, v80 row_ror:4 row_mask:0xf bank_mask:0xf
    s_nop 1
    v_add_f32_dpp v80, v80, v80 row_ror:2 row_mask:0xf bank_mask:0xf
    s_nop 1
    v_add_f32_dpp v80, v80, v80 row_ror:1 row_mask:0xf bank_mask:0xf
    v_mov_b32 v82, v80
    s_nop 1
    v_permlane16_swap_b32 v80, v82
    v_add_f32 v80, v80, v82
    v_mov_b32 v82, v80
    s_nop 1
    v_permlane32_swap_b32 v80, v82
    v_add_f32 v80, v80, v82
    v_mul_f32 v80, 0x3b000000, v80
    v_sub_f32 v68, v52, v80
    v_sub_f32 v69, v53, v80
    v_sub_f32 v70, v54, v80
    v_sub_f32 v71, v55, v80
    v_sub_f32 v72, v56, v80
    v_sub_f32 v73, v57, v80
    v_sub_f32 v74, v58, v80
    v_sub_f32 v75, v59, v80
    v_mul_f32 v81, v68, v68
    v_fmac_f32 v81, v69, v69
    v_fmac_f32 v81, v70, v70
    v_fmac_f32 v81, v71, v71
    v_fmac_f32 v81, v72, v72
    v_fmac_f32 v81, v73, v73
    v_fmac_f32 v81, v74, v74
    v_fmac_f32 v81, v75, v75
    s_nop 1
    v_add_f32_dpp v81, v81, v81 row_ror:8 row_mask:0xf bank_mask:0xf
    s_nop 1
    v_add_f32_dpp v81, v81, v81 row_ror:4 row_mask:0xf bank_mask:0xf
    s_nop 1
    v_add_f32_dpp v81, v81, v81 row_ror:2 row_mask:0xf bank_mask:0xf
    s_nop 1
    v_add_f32_dpp v81, v81, v81 row_ror:1 row_mask:0xf bank_mask:0xf
    v_mov_b32 v82, v81
    s_nop 1
    v_permlane16_swap_b32 v81, v82
    v_add_f32 v81, v81, v82
    v_mov_b32 v82, v81
    s_nop 1
    v_permlane32_swap_b32 v81, v82
    v_add_f32 v81, v81, v82
    v_mul_f32 v81, 0x3b000000, v81
    v_cvt_pk_bf16_f32 v80, v80, v80
    v_and_b32 v80, 0xffff0000, v80
    v_cvt_pk_bf16_f32 v81, v81, v81
    v_and_b32 v81, 0xffff0000, v81
    v_add_f32 v81, 0x3727c5ac, v81
    v_cvt_pk_bf16_f32 v81, v81, v81
    v_and_b32 v81, 0xffff0000, v81
    v_sqrt_f32 v81, v81
    s_nop 0
    v_cvt_pk_bf16_f32 v81, v81, v81
    v_and_b32 v81, 0xffff0000, v81
    v_rcp_f32 v81, v81
    v_sub_f32 v68, v52, v80
    v_sub_f32 v69, v53, v80
    v_sub_f32 v70, v54, v80
    v_sub_f32 v71, v55, v80
    v_sub_f32 v72, v56, v80
    v_sub_f32 v73, v57, v80
    v_sub_f32 v74, v58, v80
    v_sub_f32 v75, v59, v80
    v_cvt_pk_bf16_f32 v82, v68, v69
    v_lshlrev_b32 v68, 16, v82
    v_and_b32 v69, 0xffff0000, v82
    v_cvt_pk_bf16_f32 v82, v70, v71
    v_lshlrev_b32 v70, 16, v82
    v_and_b32 v71, 0xffff0000, v82
    v_cvt_pk_bf16_f32 v82, v72, v73
    v_lshlrev_b32 v72, 16, v82
    v_and_b32 v73, 0xffff0000, v82
    v_cvt_pk_bf16_f32 v82, v74, v75
    v_lshlrev_b32 v74, 16, v82
    v_and_b32 v75, 0xffff0000, v82
    v_mul_f32 v68, v68, v81
    v_mul_f32 v69, v69, v81
    v_mul_f32 v70, v70, v81
    v_mul_f32 v71, v71, v81
    v_mul_f32 v72, v72, v81
    v_mul_f32 v73, v73, v81
    v_mul_f32 v74, v74, v81
    v_mul_f32 v75, v75, v81
    v_cvt_pk_bf16_f32 v64, v68, v69
    v_cvt_pk_bf16_f32 v65, v70, v71
    v_cvt_pk_bf16_f32 v66, v72, v73
    v_cvt_pk_bf16_f32 v67, v74, v75
    s_mul_i32 s40, s36, 0
    s_add_u32 s40, s40, s54
    s_add_u32 s40, s40, 109051904
    s_add_u32 s78, s47, 4864
    buffer_store_dwordx2 v[64:65], v1, s[4:7], s40 offen sc1
    buffer_store_dwordx2 v[66:67], v1, s[4:7], s40 offen offset:512 sc1
rfin_197:
    s_add_u32 s53, s53, 4
    s_lshl_b32 s54, s37, 5
    s_add_u32 s54, s54, s53
    s_lshl_b32 s54, s54, 10
    v_add_f32 v164, v164, v172
    v_add_f32 v165, v165, v173
    v_add_f32 v166, v166, v174
    v_add_f32 v167, v167, v175
    v_add_f32 v168, v168, v176
    v_add_f32 v169, v169, v177
    v_add_f32 v170, v170, v178
    v_add_f32 v171, v171, v179
    v_add_f32 v164, v164, v180
    v_add_f32 v165, v165, v181
    v_add_f32 v166, v166, v182
    v_add_f32 v167, v167, v183
    v_add_f32 v168, v168, v184
    v_add_f32 v169, v169, v185
    v_add_f32 v170, v170, v186
    v_add_f32 v171, v171, v187
    v_add_f32 v164, v164, v188
    v_add_f32 v165, v165, v189
    v_add_f32 v166, v166, v190
    v_add_f32 v167, v167, v191
    v_add_f32 v168, v168, v192
    v_add_f32 v169, v169, v193
    v_add_f32 v170, v170, v194
    v_add_f32 v171, v171, v195
    v_lshlrev_b32 v52, 16, v200
    v_and_b32 v53, 0xffff0000, v200
    v_lshlrev_b32 v54, 16, v201
    v_and_b32 v55, 0xffff0000, v201
    v_lshlrev_b32 v56, 16, v202
    v_and_b32 v57, 0xffff0000, v202
    v_lshlrev_b32 v58, 16, v203
    v_and_b32 v59, 0xffff0000, v203
    v_cvt_pk_bf16_f32 v82, v164, v165
    v_lshlrev_b32 v164, 16, v82
    v_and_b32 v165, 0xffff0000, v82
    v_cvt_pk_bf16_f32 v82, v166, v167
    v_lshlrev_b32 v166, 16, v82
    v_and_b32 v167, 0xffff0000, v82
    v_cvt_pk_bf16_f32 v82, v168, v169
    v_lshlrev_b32 v168, 16, v82
    v_and_b32 v169, 0xffff0000, v82
    v_cvt_pk_bf16_f32 v82, v170, v171
    v_lshlrev_b32 v170, 16, v82
    v_and_b32 v171, 0xffff0000, v82
    v_add_f32 v52, v52, v164
    v_add_f32 v53, v53, v165
    v_add_f32 v54, v54, v166
    v_add_f32 v55, v55, v167
    v_add_f32 v56, v56, v168
    v_add_f32 v57, v57, v169
    v_add_f32 v58, v58, v170
    v_add_f32 v59, v59, v171
    v_cvt_pk_bf16_f32 v208, v52, v53
    v_cvt_pk_bf16_f32 v209, v54, v55
    v_cvt_pk_bf16_f32 v210, v56, v57
    v_cvt_pk_bf16_f32 v211, v58, v59
    s_mul_i32 s40, s36, 0
    s_add_u32 s40, s40, s54
    s_add_u32 s40, s40, 106954752
    buffer_store_dwordx2 v[208:209], v1, s[4:7], s40 offen sc1
    buffer_store_dwordx2 v[210:211], v1, s[4:7], s40 offen offset:512 sc1
    v_lshlrev_b32 v52, 16, v208
    v_and_b32 v53, 0xffff0000, v208
    v_lshlrev_b32 v54, 16, v209
    v_and_b32 v55, 0xffff0000, v209
    v_lshlrev_b32 v56, 16, v210
    v_and_b32 v57, 0xffff0000, v210
    v_lshlrev_b32 v58, 16, v211
    v_and_b32 v59, 0xffff0000, v211
    v_add_f32 v80, v52, v53
    v_add_f32 v82, v54, v55
    v_add_f32 v81, v56, v57
    v_add_f32 v80, v80, v82
    v_add_f32 v82, v58, v59
    v_add_f32 v81, v81, v82
    v_add_f32 v80, v80, v81
    s_nop 1
    v_add_f32_dpp v80, v80, v80 row_ror:8 row_mask:0xf bank_mask:0xf
    s_nop 1
    v_add_f32_dpp v80, v80, v80 row_ror:4 row_mask:0xf bank_mask:0xf
    s_nop 1
    v_add_f32_dpp v80, v80, v80 row_ror:2 row_mask:0xf bank_mask:0xf
    s_nop 1
    v_add_f32_dpp v80, v80, v80 row_ror:1 row_mask:0xf bank_mask:0xf
    v_mov_b32 v82, v80
    s_nop 1
    v_permlane16_swap_b32 v80, v82
    v_add_f32 v80, v80, v82
    v_mov_b32 v82, v80
    s_nop 1
    v_permlane32_swap_b32 v80, v82
    v_add_f32 v80, v80, v82
    v_mul_f32 v80, 0x3b000000, v80
    v_sub_f32 v220, v52, v80
    v_sub_f32 v221, v53, v80
    v_sub_f32 v222, v54, v80
    v_sub_f32 v223, v55, v80
    v_sub_f32 v224, v56, v80
    v_sub_f32 v225, v57, v80
    v_sub_f32 v226, v58, v80
    v_sub_f32 v227, v59, v80
    v_mul_f32 v81, v220, v220
    v_fmac_f32 v81, v221, v221
    v_fmac_f32 v81, v222, v222
    v_fmac_f32 v81, v223, v223
    v_fmac_f32 v81, v224, v224
    v_fmac_f32 v81, v225, v225
    v_fmac_f32 v81, v226, v226
    v_fmac_f32 v81, v227, v227
    s_nop 1
    v_add_f32_dpp v81, v81, v81 row_ror:8 row_mask:0xf bank_mask:0xf
    s_nop 1
    v_add_f32_dpp v81, v81, v81 row_ror:4 row_mask:0xf bank_mask:0xf
    s_nop 1
    v_add_f32_dpp v81, v81, v81 row_ror:2 row_mask:0xf bank_mask:0xf
    s_nop 1
    v_add_f32_dpp v81, v81, v81 row_ror:1 row_mask:0xf bank_mask:0xf
    v_mov_b32 v82, v81
    s_nop 1
    v_permlane16_swap_b32 v81, v82
    v_add_f32 v81, v81, v82
    v_mov_b32 v82, v81
    s_nop 1
    v_permlane32_swap_b32 v81, v82
    v_add_f32 v81, v81, v82
    v_mul_f32 v81, 0x3b000000, v81
    v_cvt_pk_bf16_f32 v80, v80, v80
    v_and_b32 v80, 0xffff0000, v80
    v_cvt_pk_bf16_f32 v81, v81, v81
    v_and_b32 v81, 0xffff0000, v81
    v_add_f32 v81, 0x3727c5ac, v81
    v_cvt_pk_bf16_f32 v81, v81, v81
    v_and_b32 v81, 0xffff0000, v81
    v_sqrt_f32 v81, v81
    s_nop 0
    v_cvt_pk_bf16_f32 v81, v81, v81
    v_and_b32 v81, 0xffff0000, v81
    v_rcp_f32 v81, v81
    v_sub_f32 v220, v52, v80
    v_sub_f32 v221, v53, v80
    v_sub_f32 v222, v54, v80
    v_sub_f32 v223, v55, v80
    v_sub_f32 v224, v56, v80
    v_sub_f32 v225, v57, v80
    v_sub_f32 v226, v58, v80
    v_sub_f32 v227, v59, v80
    v_cvt_pk_bf16_f32 v82, v220, v221
    v_lshlrev_b32 v220, 16, v82
    v_and_b32 v221, 0xffff0000, v82
    v_cvt_pk_bf16_f32 v82, v222, v223
    v_lshlrev_b32 v222, 16, v82
    v_and_b32 v223, 0xffff0000, v82
    v_cvt_pk_bf16_f32 v82, v224, v225
    v_lshlrev_b32 v224, 16, v82
    v_and_b32 v225, 0xffff0000, v82
    v_cvt_pk_bf16_f32 v82, v226, v227
    v_lshlrev_b32 v226, 16, v82
    v_and_b32 v227, 0xffff0000, v82
    v_mul_f32 v220, v220, v81
    v_mul_f32 v221, v221, v81
    v_mul_f32 v222, v222, v81
    v_mul_f32 v223, v223, v81
    v_mul_f32 v224, v224, v81
    v_mul_f32 v225, v225, v81
    v_mul_f32 v226, v226, v81
    v_mul_f32 v227, v227, v81
    v_cvt_pk_bf16_f32 v216, v220, v221
    v_cvt_pk_bf16_f32 v217, v222, v223
    v_cvt_pk_bf16_f32 v218, v224, v225
    v_cvt_pk_bf16_f32 v219, v226, v227
    s_mul_i32 s40, s36, 0
    s_add_u32 s40, s40, s54
    s_add_u32 s40, s40, 109051904
    s_add_u32 s78, s47, 4864
    buffer_store_dwordx2 v[216:217], v1, s[4:7], s40 offen sc1
    buffer_store_dwordx2 v[218:219], v1, s[4:7], s40 offen offset:512 sc1
rfin_198:
    s_sub_u32 s53, s53, 4
    s_mul_i32 s68, s34, 7
    s_add_u32 s68, s68, s32
    s_mul_i32 s69, s35, 7
    s_add_u32 s69, s69, s32
    s_min_u32 s42, s68, 255
    s_lshr_b32 s65, s42, 2
    s_mul_i32 s65, s65, 6144
    s_add_u32 s65, s65, 4736
    s_min_u32 s42, s69, 255
    s_lshr_b32 s66, s42, 2
    s_add_u32 s66, s66, 64
    s_mul_i32 s66, s66, 6144
    s_add_u32 s66, s66, 4736
    buffer_load_dword v90, v3, s[4:7], s65 offen sc1
    buffer_load_dword v91, v3, s[4:7], s66 offen sc1
    s_waitcnt vmcnt(2)
    s_cmp_eq_u32 s78, 0
    s_cbranch_scc1 r3s1_189
    s_barrier
    s_cmp_eq_u32 s30, 0
    s_cbranch_scc0 ws_199
    s_mov_b64 exec, 1
    v_mov_b32 v13, 2
    v_mov_b32 v14, 0
    buffer_atomic_add v13, v14, s[4:7], s78 offen
    s_mov_b64 exec, -1
ws_199:
r3s1_189:
    s_cmp_eq_u32 s79, 1
    s_cbranch_scc1 r3go_190
    s_mul_i32 s68, s34, 7
    s_add_u32 s68, s68, s32
    s_mul_i32 s69, s35, 7
    s_add_u32 s69, s69, s32
    s_min_u32 s42, s68, 255
    s_lshr_b32 s65, s42, 2
    s_mul_i32 s65, s65, 6144
    s_add_u32 s65, s65, 4736
    s_min_u32 s42, s69, 255
    s_lshr_b32 s66, s42, 2
    s_add_u32 s66, s66, 64
    s_mul_i32 s66, s66, 6144
    s_add_u32 s66, s66, 4736
    s_cmp_eq_u32 s30, 0
    s_cbranch_scc0 r3mp_200
r3mpl_201:
    buffer_load_dword v90, v3, s[4:7], s65 offen sc1
    buffer_load_dword v91, v3, s[4:7], s66 offen sc1
    s_waitcnt vmcnt(0)
    v_cmp_le_u32 vcc, 16, v90
    s_nop 3
    s_cmp_eq_u64 vcc, -1
    s_cselect_b32 s40, 1, 0
    s_cmp_lt_u32 s68, 256
    s_cselect_b32 s40, s40, 0
    v_cmp_le_u32 vcc, 16, v91
    s_nop 3
    s_cmp_eq_u64 vcc, -1
    s_cselect_b32 s41, 2, 0
    s_cmp_lt_u32 s69, 256
    s_cselect_b32 s41, s41, 0
    s_cmp_lg_u32 s40, 0
    s_cselect_b32 s67, s40, s41
    s_min_u32 s42, s68, s69
    s_cmp_ge_u32 s42, 256
    s_cselect_b32 s67, 3, s67
    s_cmp_lg_u32 s67, 0
    s_cbranch_scc1 r3mpd_202
    s_add_u32 s31, s31, 1
    s_cmp_gt_u32 s31, 300000
    s_cselect_b32 s67, 3, 0
    s_cbranch_scc1 r3mpd_202
    s_sleep 1
    s_branch r3mpl_201
r3mpd_202:
    v_mov_b32 v13, 163792
    v_mov_b32 v14, s67
    ds_write_b32 v13, v14
    s_waitcnt lgkmcnt(0)
r3mp_200:
    s_barrier
    v_mov_b32 v13, 163792
    ds_read_b32 v14, v13
    s_waitcnt lgkmcnt(0)
    v_readfirstlane_b32 s67, v14
    s_nop 3
    s_cmp_eq_u32 s67, 3
    s_cbranch_scc1 r3done_155
    s_sub_u32 s74, s67, 1
    s_cmp_eq_u32 s74, 0
    s_cselect_b32 s40, s68, s69
    s_lshr_b32 s75, s40, 2
    s_and_b32 s77, s40, 3
    s_lshl_b32 s77, s77, 3
    s_add_u32 s77, s77, s30
    s_xor_b32 s40, s74, 1
    s_add_u32 s34, s34, s40
    s_add_u32 s35, s35, s74
    s_lshl_b32 s40, s74, 6
    s_add_u32 s40, s40, s75
    s_mul_i32 s76, s40, 6144
    s_mul_i32 s48, s75, 262144
    s_add_u32 s48, s48, 90177536
    s_lshl_b32 s40, s77, 11
    s_add_u32 s48, s48, s40
    buffer_load_dwordx4 v[16:19], v2, s[4:7], s48 offen sc1
    buffer_load_dwordx4 v[20:23], v2, s[4:7], s48 offen offset:1024 sc1
    s_add_u32 s48, s48, 65536
    buffer_load_dwordx4 v[24:27], v2, s[4:7], s48 offen sc1
    buffer_load_dwordx4 v[28:31], v2, s[4:7], s48 offen offset:1024 sc1
    s_add_u32 s48, s48, 65536
    buffer_load_dwordx4 v[32:35], v2, s[4:7], s48 offen sc1
    buffer_load_dwordx4 v[36:39], v2, s[4:7], s48 offen offset:1024 sc1
    s_add_u32 s48, s48, 65536
    buffer_load_dwordx4 v[40:43], v2, s[4:7], s48 offen sc1
    buffer_load_dwordx4 v[44:47], v2, s[4:7], s48 offen offset:1024 sc1
    s_lshl_b32 s41, s75, 5
    s_add_u32 s41, s41, s77
    s_lshl_b32 s41, s41, 10
    s_cmp_eq_u32 s74, 0
    s_cbranch_scc0 rin_203
    buffer_load_dwordx2 v[92:93], v1, s[16:19], s41 offen
    buffer_load_dwordx2 v[94:95], v1, s[16:19], s41 offen offset:512
    s_branch rin_204
rin_203:
    s_add_u32 s40, s41, 128974848
    buffer_load_dwordx2 v[92:93], v1, s[4:7], s40 offen sc1
    buffer_load_dwordx2 v[94:95], v1, s[4:7], s40 offen offset:512 sc1
rin_204:
    s_add_u32 s77, s77, 4
    s_mul_i32 s48, s75, 262144
    s_add_u32 s48, s48, 90177536
    s_lshl_b32 s40, s77, 11
    s_add_u32 s48, s48, s40
    buffer_load_dwordx4 v[100:103], v2, s[4:7], s48 offen sc1
    buffer_load_dwordx4 v[104:107], v2, s[4:7], s48 offen offset:1024 sc1
    s_add_u32 s48, s48, 65536
    buffer_load_dwordx4 v[108:111], v2, s[4:7], s48 offen sc1
    buffer_load_dwordx4 v[112:115], v2, s[4:7], s48 offen offset:1024 sc1
    s_add_u32 s48, s48, 65536
    buffer_load_dwordx4 v[116:119], v2, s[4:7], s48 offen sc1
    buffer_load_dwordx4 v[120:123], v2, s[4:7], s48 offen offset:1024 sc1
    s_add_u32 s48, s48, 65536
    buffer_load_dwordx4 v[124:127], v2, s[4:7], s48 offen sc1
    buffer_load_dwordx4 v[128:131], v2, s[4:7], s48 offen offset:1024 sc1
    s_lshl_b32 s41, s75, 5
    s_add_u32 s41, s41, s77
    s_lshl_b32 s41, s41, 10
    s_cmp_eq_u32 s74, 0
    s_cbranch_scc0 rin_205
    buffer_load_dwordx2 v[96:97], v1, s[16:19], s41 offen
    buffer_load_dwordx2 v[98:99], v1, s[16:19], s41 offen offset:512
    s_branch rin_206
rin_205:
    s_add_u32 s40, s41, 128974848
    buffer_load_dwordx2 v[96:97], v1, s[4:7], s40 offen sc1
    buffer_load_dwordx2 v[98:99], v1, s[4:7], s40 offen offset:512 sc1
rin_206:
    s_sub_u32 s77, s77, 4
    s_mul_i32 s68, s34, 7
    s_add_u32 s68, s68, s32
    s_mul_i32 s69, s35, 7
    s_add_u32 s69, s69, s32
    s_min_u32 s42, s68, 255
    s_lshr_b32 s65, s42, 2
    s_mul_i32 s65, s65, 6144
    s_add_u32 s65, s65, 4736
    s_min_u32 s42, s69, 255
    s_lshr_b32 s66, s42, 2
    s_add_u32 s66, s66, 64
    s_mul_i32 s66, s66, 6144
    s_add_u32 s66, s66, 4736
    buffer_load_dword v90, v3, s[4:7], s65 offen sc1
    buffer_load_dword v91, v3, s[4:7], s66 offen sc1
    s_waitcnt vmcnt(0)
r3go_190:
    s_branch r3job0_156
r3done_155:
    s_waitcnt vmcnt(0)
    s_branch L_exit
L_s2:
    v_lshlrev_b32 v1, 4, v0
    v_mov_b32 v2, 0
    v_lshrrev_b32 v13, 4, v0
    v_and_b32 v14, 15, v0
    v_lshlrev_b32 v3, 4, v14
    v_lshl_add_u32 v3, v13, 9, v3
    v_lshlrev_b32 v13, 2, v13
    v_add_u32 v15, 0, v13
    v_cmp_le_u32 s[56:57], v15, v14
    v_add_u32 v15, 1, v13
    v_cmp_le_u32 s[58:59], v15, v14
    v_add_u32 v15, 2, v13
    v_cmp_le_u32 s[60:61], v15, v14
    v_add_u32 v15, 3, v13
    v_cmp_le_u32 s[62:63], v15, v14
    s_mov_b32 s72, 0x3db504f3
    s_mov_b32 s73, 0x3fb8aa3b
    s_mov_b32 s32, s33
    v_bfe_u32 v2, v0, 3, 2
    v_lshlrev_b32 v2, 7, v2
    v_and_b32 v13, 7, v0
    v_min_u32 v13, 1, v13
    v_lshl_add_u32 v2, v13, 2, v2
    v_bfe_u32 v250, v0, 3, 2
    v_lshlrev_b32 v250, 7, v250
    v_add_u32 v251, 4, v250
    s_cmp_lt_u32 s32, 14
    s_cselect_b32 s36, 0, 1
    s_cselect_b32 s40, 0, 14
    s_sub_u32 s68, s32, s40
    s_mov_b32 s79, 0
s2job_207:
    s_cmp_ge_u32 s68, 512
    s_cbranch_scc1 s2done_208
    s_lshr_b32 s37, s68, 3
    s_and_b32 s53, s68, 7
    s_lshl_b32 s70, s53, 9
    s_lshl_b32 s53, s53, 2
    s_add_u32 s53, s53, s30
    s_lshl_b32 s40, s36, 6
    s_add_u32 s40, s40, s37
    s_mul_i32 s40, s40, 6144
    s_add_u32 s70, s70, s40
    s_add_u32 s70, s70, 128
    s_lshl_b32 s40, s36, 6
    s_add_u32 s40, s40, s37
    s_mul_i32 s47, s40, 6144
    s_cmp_eq_u32 s79, 1
    s_cbranch_scc1 s2have_209
    s_cmp_eq_u32 s30, 0
    s_cbranch_scc0 s2wf_212
poll_213:
    buffer_load_dword v13, v250, s[4:7], s70 offen offset:0 sc1
    s_waitcnt vmcnt(0)
    v_cmp_ne_u32 vcc, 0, v13
    s_nop 3
    s_cmp_eq_u64 vcc, -1
    s_cbranch_scc1 polld_214
    s_add_u32 s31, s31, 1
    s_cmp_gt_u32 s31, 300000
    s_cbranch_scc1 polld_214
    s_sleep 1
    s_branch poll_213
polld_214:
s2wf_212:
    s_barrier
    s_mul_i32 s48, s37, 786432
    s_add_u32 s48, s48, 6291456
    s_mul_i32 s40, s53, 24576
    s_add_u32 s48, s48, s40
    buffer_load_dwordx4 v[16:19], v1, s[4:7], s48 offen offset:0 sc1
    buffer_load_dwordx4 v[20:23], v1, s[4:7], s48 offen offset:1024 sc1
    buffer_load_dwordx4 v[24:27], v1, s[4:7], s48 offen offset:2048 sc1
    buffer_load_dwordx4 v[28:31], v1, s[4:7], s48 offen offset:3072 sc1
    s_add_u32 s48, s48, 4096
    buffer_load_dwordx4 v[32:35], v1, s[4:7], s48 offen offset:0 sc1
    buffer_load_dwordx4 v[36:39], v1, s[4:7], s48 offen offset:1024 sc1
    buffer_load_dwordx4 v[40:43], v1, s[4:7], s48 offen offset:2048 sc1
    buffer_load_dwordx4 v[44:47], v1, s[4:7], s48 offen offset:3072 sc1
    s_add_u32 s48, s48, 4096
    buffer_load_dwordx4 v[48:51], v1, s[4:7], s48 offen offset:0 sc1
    buffer_load_dwordx4 v[52:55], v1, s[4:7], s48 offen offset:1024 sc1
    buffer_load_dwordx4 v[56:59], v1, s[4:7], s48 offen offset:2048 sc1
    buffer_load_dwordx4 v[60:63], v1, s[4:7], s48 offen offset:3072 sc1
    s_add_u32 s48, s48, 4096
    buffer_load_dwordx4 v[64:67], v1, s[4:7], s48 offen offset:0 sc1
    buffer_load_dwordx4 v[68:71], v1, s[4:7], s48 offen offset:1024 sc1
    buffer_load_dwordx4 v[72:75], v1, s[4:7], s48 offen offset:2048 sc1
    buffer_load_dwordx4 v[76:79], v1, s[4:7], s48 offen offset:3072 sc1
    s_add_u32 s48, s48, 4096
    buffer_load_dwordx4 v[80:83], v1, s[4:7], s48 offen offset:0 sc1
    buffer_load_dwordx4 v[84:87], v1, s[4:7], s48 offen offset:1024 sc1
    buffer_load_dwordx4 v[88:91], v1, s[4:7], s48 offen offset:2048 sc1
    buffer_load_dwordx4 v[92:95], v1, s[4:7], s48 offen offset:3072 sc1
    s_add_u32 s48, s48, 4096
    buffer_load_dwordx4 v[96:99], v1, s[4:7], s48 offen offset:0 sc1
    buffer_load_dwordx4 v[100:103], v1, s[4:7], s48 offen offset:1024 sc1
    buffer_load_dwordx4 v[104:107], v1, s[4:7], s48 offen offset:2048 sc1
    buffer_load_dwordx4 v[108:111], v1, s[4:7], s48 offen offset:3072 sc1
    s_add_u32 s48, s48, 4096
s2have_209:
    s_cmp_eq_u32 s30, 0
    s_cbranch_scc0 s2wf_215
poll_216:
    buffer_load_dword v13, v251, s[4:7], s70 offen offset:0 sc1
    s_waitcnt vmcnt(0)
    v_cmp_ne_u32 vcc, 0, v13
    s_nop 3
    s_cmp_eq_u64 vcc, -1
    s_cbranch_scc1 polld_217
    s_add_u32 s31, s31, 1
    s_cmp_gt_u32 s31, 300000
    s_cbranch_scc1 polld_217
    s_sleep 1
    s_branch poll_216
polld_217:
s2wf_215:
    s_barrier
    s_mul_i32 s48, s37, 262144
    s_add_u32 s48, s48, 56623104
    s_lshl_b32 s40, s53, 13
    s_add_u32 s48, s48, s40
    buffer_load_dwordx4 v[112:115], v1, s[4:7], s48 offen offset:0 sc1
    buffer_load_dwordx4 v[116:119], v1, s[4:7], s48 offen offset:1024 sc1
    buffer_load_dwordx4 v[120:123], v1, s[4:7], s48 offen offset:2048 sc1
    buffer_load_dwordx4 v[124:127], v1, s[4:7], s48 offen offset:3072 sc1
    s_add_u32 s48, s48, 4096
    buffer_load_dwordx4 v[128:131], v1, s[4:7], s48 offen offset:0 sc1
    buffer_load_dwordx4 v[132:135], v1, s[4:7], s48 offen offset:1024 sc1
    buffer_load_dwordx4 v[136:139], v1, s[4:7], s48 offen offset:2048 sc1
    buffer_load_dwordx4 v[140:143], v1, s[4:7], s48 offen offset:3072 sc1
    s_add_u32 s48, s48, 4096
    s_add_u32 s69, s68, 14
    s_min_u32 s42, s69, 511
    s_lshr_b32 s74, s42, 3
    s_and_b32 s77, s42, 7
    s_lshl_b32 s76, s77, 9
    s_lshl_b32 s77, s77, 2
    s_add_u32 s77, s77, s30
    s_lshl_b32 s40, s36, 6
    s_add_u32 s40, s40, s74
    s_mul_i32 s40, s40, 6144
    s_add_u32 s76, s76, s40
    s_add_u32 s76, s76, 128
    buffer_load_dword v15, v250, s[4:7], s76 offen sc1
    s_waitcnt vmcnt(0)
    v_mfma_f32_16x16x32_bf16 v[144:147], v[112:115], v[16:19], 0
    v_mfma_f32_16x16x32_bf16 v[148:151], v[112:115], v[32:35], 0
    v_mfma_f32_16x16x32_bf16 v[152:155], v[48:51], v[16:19], 0
    v_mfma_f32_16x16x32_bf16 v[160:163], v[48:51], v[32:35], 0
    v_mfma_f32_16x16x32_bf16 v[164:167], v[64:67], v[32:35], 0
    v_mfma_f32_16x16x32_bf16 v[144:147], v[116:119], v[20:23], v[144:147]
    v_mfma_f32_16x16x32_bf16 v[148:151], v[116:119], v[36:39], v[148:151]
    v_mfma_f32_16x16x32_bf16 v[152:155], v[52:55], v[20:23], v[152:155]
    v_mfma_f32_16x16x32_bf16 v[160:163], v[52:55], v[36:39], v[160:163]
    v_mfma_f32_16x16x32_bf16 v[164:167], v[68:71], v[36:39], v[164:167]
    v_mfma_f32_16x16x32_bf16 v[144:147], v[120:123], v[24:27], v[144:147]
    v_mfma_f32_16x16x32_bf16 v[148:151], v[120:123], v[40:43], v[148:151]
    v_mfma_f32_16x16x32_bf16 v[152:155], v[56:59], v[24:27], v[152:155]
    v_mfma_f32_16x16x32_bf16 v[160:163], v[56:59], v[40:43], v[160:163]
    v_mfma_f32_16x16x32_bf16 v[164:167], v[72:75], v[40:43], v[164:167]
    v_mfma_f32_16x16x32_bf16 v[144:147], v[124:127], v[28:31], v[144:147]
    v_mfma_f32_16x16x32_bf16 v[148:151], v[124:127], v[44:47], v[148:151]
    v_mfma_f32_16x16x32_bf16 v[152:155], v[60:63], v[28:31], v[152:155]
    v_mfma_f32_16x16x32_bf16 v[160:163], v[60:63], v[44:47], v[160:163]
    v_mfma_f32_16x16x32_bf16 v[164:167], v[76:79], v[44:47], v[164:167]
    s_nop 3
    v_cvt_pk_bf16_f32 v246, v144, v145
    v_lshlrev_b32 v144, 16, v246
    v_and_b32 v145, 0xffff0000, v246
    v_mul_f32 v144, s72, v144
    v_mul_f32 v145, s72, v145
    v_cvt_pk_bf16_f32 v246, v144, v145
    v_lshlrev_b32 v144, 16, v246
    v_and_b32 v145, 0xffff0000, v246
    v_cvt_pk_bf16_f32 v246, v146, v147
    v_lshlrev_b32 v146, 16, v246
    v_and_b32 v147, 0xffff0000, v246
    v_mul_f32 v146, s72, v146
    v_mul_f32 v147, s72, v147
    v_cvt_pk_bf16_f32 v246, v146, v147
    v_lshlrev_b32 v146, 16, v246
    v_and_b32 v147, 0xffff0000, v246
    v_cvt_pk_bf16_f32 v246, v152, v153
    v_lshlrev_b32 v152, 16, v246
    v_and_b32 v153, 0xffff0000, v246
    v_mul_f32 v152, s72, v152
    v_mul_f32 v153, s72, v153
    v_cvt_pk_bf16_f32 v246, v152, v153
    v_lshlrev_b32 v152, 16, v246
    v_and_b32 v153, 0xffff0000, v246
    v_cvt_pk_bf16_f32 v246, v154, v155
    v_lshlrev_b32 v154, 16, v246
    v_and_b32 v155, 0xffff0000, v246
    v_mul_f32 v154, s72, v154
    v_mul_f32 v155, s72, v155
    v_cvt_pk_bf16_f32 v246, v154, v155
    v_lshlrev_b32 v154, 16, v246
    v_and_b32 v155, 0xffff0000, v246
    v_mov_b32 v246, 0xce6e6b28
    v_cndmask_b32 v152, v246, v152, s[56:57]
    v_cndmask_b32 v153, v246, v153, s[58:59]
    v_cndmask_b32 v154, v246, v154, s[60:61]
    v_cndmask_b32 v155, v246, v155, s[62:63]
    v_max_f32 v244, v144, v145
    v_max3_f32 v244, v244, v146, v147
    v_max3_f32 v244, v244, v152, v153
    v_max3_f32 v244, v244, v154, v155
    v_mov_b32 v246, v244
    s_nop 1
    v_permlane16_swap_b32 v244, v246
    v_max_f32 v244, v244, v246
    v_mov_b32 v246, v244
    s_nop 1
    v_permlane32_swap_b32 v244, v246
    v_max_f32 v244, v244, v246
    v_mul_f32 v244, s73, v244
    v_fma_f32 v144, v144, s73, -v244
    v_fma_f32 v145, v145, s73, -v244
    v_fma_f32 v146, v146, s73, -v244
    v_fma_f32 v147, v147, s73, -v244
    v_fma_f32 v152, v152, s73, -v244
    v_fma_f32 v153, v153, s73, -v244
    v_fma_f32 v154, v154, s73, -v244
    v_fma_f32 v155, v155, s73, -v244
    v_exp_f32 v144, v144
    v_exp_f32 v145, v145
    v_exp_f32 v146, v146
    v_exp_f32 v147, v147
    v_exp_f32 v152, v152
    v_exp_f32 v153, v153
    v_exp_f32 v154, v154
    v_exp_f32 v155, v155
    v_add_f32 v245, v144, v145
    v_add_f32 v245, v245, v146
    v_add_f32 v245, v245, v147
    v_mul_f32 v245, 0.5, v245
    v_add_f32 v245, v245, v152
    v_add_f32 v245, v245, v153
    v_add_f32 v245, v245, v154
    v_add_f32 v245, v245, v155
    v_mov_b32 v246, v245
    s_nop 1
    v_permlane16_swap_b32 v245, v246
    v_add_f32 v245, v245, v246
    v_mov_b32 v246, v245
    s_nop 1
    v_permlane32_swap_b32 v245, v246
    v_add_f32 v245, v245, v246
    v_rcp_f32 v245, v245
    s_nop 0
    v_mul_f32 v144, v144, v245
    v_mul_f32 v145, v145, v245
    v_mul_f32 v146, v146, v245
    v_mul_f32 v147, v147, v245
    v_mul_f32 v152, v152, v245
    v_mul_f32 v153, v153, v245
    v_mul_f32 v154, v154, v245
    v_mul_f32 v155, v155, v245
    v_cvt_pk_bf16_f32 v176, v144, v145
    v_cvt_pk_bf16_f32 v177, v146, v147
    v_cvt_pk_bf16_f32 v168, v152, v153
    v_cvt_pk_bf16_f32 v169, v154, v155
    v_mov_b32 v170, 0
    v_mov_b32 v171, 0
    v_cvt_pk_bf16_f32 v246, v148, v149
    v_lshlrev_b32 v148, 16, v246
    v_and_b32 v149, 0xffff0000, v246
    v_mul_f32 v148, s72, v148
    v_mul_f32 v149, s72, v149
    v_cvt_pk_bf16_f32 v246, v148, v149
    v_lshlrev_b32 v148, 16, v246
    v_and_b32 v149, 0xffff0000, v246
    v_cvt_pk_bf16_f32 v246, v150, v151
    v_lshlrev_b32 v150, 16, v246
    v_and_b32 v151, 0xffff0000, v246
    v_mul_f32 v150, s72, v150
    v_mul_f32 v151, s72, v151
    v_cvt_pk_bf16_f32 v246, v150, v151
    v_lshlrev_b32 v150, 16, v246
    v_and_b32 v151, 0xffff0000, v246
    v_cvt_pk_bf16_f32 v246, v160, v161
    v_lshlrev_b32 v160, 16, v246
    v_and_b32 v161, 0xffff0000, v246
    v_mul_f32 v160, s72, v160
    v_mul_f32 v161, s72, v161
    v_cvt_pk_bf16_f32 v246, v160, v161
    v_lshlrev_b32 v160, 16, v246
    v_and_b32 v161, 0xffff0000, v246
    v_cvt_pk_bf16_f32 v246, v162, v163
    v_lshlrev_b32 v162, 16, v246
    v_and_b32 v163, 0xffff0000, v246
    v_mul_f32 v162, s72, v162
    v_mul_f32 v163, s72, v163
    v_cvt_pk_bf16_f32 v246, v162, v163
    v_lshlrev_b32 v162, 16, v246
    v_and_b32 v163, 0xffff0000, v246
    v_cvt_pk_bf16_f32 v246, v164, v165
    v_lshlrev_b32 v164, 16, v246
    v_and_b32 v165, 0xffff0000, v246
    v_mul_f32 v164, s72, v164
    v_mul_f32 v165, s72, v165
    v_cvt_pk_bf16_f32 v246, v164, v165
    v_lshlrev_b32 v164, 16, v246
    v_and_b32 v165, 0xffff0000, v246
    v_cvt_pk_bf16_f32 v246, v166, v167
    v_lshlrev_b32 v166, 16, v246
    v_and_b32 v167, 0xffff0000, v246
    v_mul_f32 v166, s72, v166
    v_mul_f32 v167, s72, v167
    v_cvt_pk_bf16_f32 v246, v166, v167
    v_lshlrev_b32 v166, 16, v246
    v_and_b32 v167, 0xffff0000, v246
    v_mov_b32 v246, 0xce6e6b28
    v_cndmask_b32 v164, v246, v164, s[56:57]
    v_cndmask_b32 v165, v246, v165, s[58:59]
    v_cndmask_b32 v166, v246, v166, s[60:61]
    v_cndmask_b32 v167, v246, v167, s[62:63]
    v_max_f32 v244, v148, v149
    v_max3_f32 v244, v244, v150, v151
    v_max3_f32 v244, v244, v160, v161
    v_max3_f32 v244, v244, v162, v163
    v_max3_f32 v244, v244, v164, v165
    v_max3_f32 v244, v244, v166, v167
    v_mov_b32 v246, v244
    s_nop 1
    v_permlane16_swap_b32 v244, v246
    v_max_f32 v244, v244, v246
    v_mov_b32 v246, v244
    s_nop 1
    v_permlane32_swap_b32 v244, v246
    v_max_f32 v244, v244, v246
    v_mul_f32 v244, s73, v244
    v_fma_f32 v148, v148, s73, -v244
    v_fma_f32 v149, v149, s73, -v244
    v_fma_f32 v150, v150, s73, -v244
    v_fma_f32 v151, v151, s73, -v244
    v_fma_f32 v160, v160, s73, -v244
    v_fma_f32 v161, v161, s73, -v244
    v_fma_f32 v162, v162, s73, -v244
    v_fma_f32 v163, v163, s73, -v244
    v_fma_f32 v164, v164, s73, -v244
    v_fma_f32 v165, v165, s73, -v244
    v_fma_f32 v166, v166, s73, -v244
    v_fma_f32 v167, v167, s73, -v244
    v_exp_f32 v148, v148
    v_exp_f32 v149, v149
    v_exp_f32 v150, v150
    v_exp_f32 v151, v151
    v_exp_f32 v160, v160
    v_exp_f32 v161, v161
    v_exp_f32 v162, v162
    v_exp_f32 v163, v163
    v_exp_f32 v164, v164
    v_exp_f32 v165, v165
    v_exp_f32 v166, v166
    v_exp_f32 v167, v167
    v_add_f32 v245, v148, v149
    v_add_f32 v245, v245, v150
    v_add_f32 v245, v245, v151
    v_mul_f32 v245, 0.5, v245
    v_add_f32 v245, v245, v160
    v_add_f32 v245, v245, v161
    v_add_f32 v245, v245, v162
    v_add_f32 v245, v245, v163
    v_add_f32 v245, v245, v164
    v_add_f32 v245, v245, v165
    v_add_f32 v245, v245, v166
    v_add_f32 v245, v245, v167
    v_mov_b32 v246, v245
    s_nop 1
    v_permlane16_swap_b32 v245, v246
    v_add_f32 v245, v245, v246
    v_mov_b32 v246, v245
    s_nop 1
    v_permlane32_swap_b32 v245, v246
    v_add_f32 v245, v245, v246
    v_rcp_f32 v245, v245
    s_nop 0
    v_mul_f32 v148, v148, v245
    v_mul_f32 v149, v149, v245
    v_mul_f32 v150, v150, v245
    v_mul_f32 v151, v151, v245
    v_mul_f32 v160, v160, v245
    v_mul_f32 v161, v161, v245
    v_mul_f32 v162, v162, v245
    v_mul_f32 v163, v163, v245
    v_mul_f32 v164, v164, v245
    v_mul_f32 v165, v165, v245
    v_mul_f32 v166, v166, v245
    v_mul_f32 v167, v167, v245
    v_cvt_pk_bf16_f32 v178, v148, v149
    v_cvt_pk_bf16_f32 v179, v150, v151
    v_cvt_pk_bf16_f32 v172, v160, v161
    v_cvt_pk_bf16_f32 v173, v162, v163
    v_cvt_pk_bf16_f32 v174, v164, v165
    v_cvt_pk_bf16_f32 v175, v166, v167
    v_mfma_f32_16x16x32_bf16 v[180:183], v[80:83], v[168:171], 0
    v_mfma_f32_16x16x32_bf16 v[184:187], v[84:87], v[168:171], 0
    v_mfma_f32_16x16x32_bf16 v[188:191], v[88:91], v[168:171], 0
    v_mfma_f32_16x16x32_bf16 v[192:195], v[92:95], v[168:171], 0
    v_mfma_f32_16x16x32_bf16 v[196:199], v[96:99], v[168:171], 0
    v_mfma_f32_16x16x32_bf16 v[200:203], v[100:103], v[168:171], 0
    v_mfma_f32_16x16x32_bf16 v[204:207], v[104:107], v[168:171], 0
    v_mfma_f32_16x16x32_bf16 v[208:211], v[108:111], v[168:171], 0
    v_mfma_f32_16x16x16_bf16 v[180:183], v[128:129], v[176:177], v[180:183]
    v_mfma_f32_16x16x16_bf16 v[184:187], v[130:131], v[176:177], v[184:187]
    v_mfma_f32_16x16x16_bf16 v[188:191], v[132:133], v[176:177], v[188:191]
    v_mfma_f32_16x16x16_bf16 v[192:195], v[134:135], v[176:177], v[192:195]
    v_mfma_f32_16x16x16_bf16 v[196:199], v[136:137], v[176:177], v[196:199]
    v_mfma_f32_16x16x16_bf16 v[200:203], v[138:139], v[176:177], v[200:203]
    v_mfma_f32_16x16x16_bf16 v[204:207], v[140:141], v[176:177], v[204:207]
    v_mfma_f32_16x16x16_bf16 v[208:211], v[142:143], v[176:177], v[208:211]
    v_mfma_f32_16x16x32_bf16 v[212:215], v[80:83], v[172:175], 0
    v_mfma_f32_16x16x32_bf16 v[216:219], v[84:87], v[172:175], 0
    v_mfma_f32_16x16x32_bf16 v[220:223], v[88:91], v[172:175], 0
    v_mfma_f32_16x16x32_bf16 v[224:227], v[92:95], v[172:175], 0
    v_mfma_f32_16x16x32_bf16 v[228:231], v[96:99], v[172:175], 0
    v_mfma_f32_16x16x32_bf16 v[232:235], v[100:103], v[172:175], 0
    v_mfma_f32_16x16x32_bf16 v[236:239], v[104:107], v[172:175], 0
    v_mfma_f32_16x16x32_bf16 v[240:243], v[108:111], v[172:175], 0
    v_mfma_f32_16x16x16_bf16 v[212:215], v[128:129], v[178:179], v[212:215]
    v_mfma_f32_16x16x16_bf16 v[216:219], v[130:131], v[178:179], v[216:219]
    v_mfma_f32_16x16x16_bf16 v[220:223], v[132:133], v[178:179], v[220:223]
    v_mfma_f32_16x16x16_bf16 v[224:227], v[134:135], v[178:179], v[224:227]
    v_mfma_f32_16x16x16_bf16 v[228:231], v[136:137], v[178:179], v[228:231]
    v_mfma_f32_16x16x16_bf16 v[232:235], v[138:139], v[178:179], v[232:235]
    v_mfma_f32_16x16x16_bf16 v[236:239], v[140:141], v[178:179], v[236:239]
    v_mfma_f32_16x16x16_bf16 v[240:243], v[142:143], v[178:179], v[240:243]
    s_mul_i32 s49, s37, 262144
    s_add_u32 s49, s49, 73400320
    s_lshl_b32 s40, s53, 13
    s_add_u32 s49, s49, s40
    v_cvt_pk_bf16_f32 v144, v180, v181
    v_cvt_pk_bf16_f32 v145, v182, v183
    v_cvt_pk_bf16_f32 v146, v184, v185
    v_cvt_pk_bf16_f32 v147, v186, v187
    buffer_store_dwordx4 v[144:147], v3, s[4:7], s49 offen offset:0 sc1
    v_cvt_pk_bf16_f32 v148, v212, v213
    v_cvt_pk_bf16_f32 v149, v214, v215
    v_cvt_pk_bf16_f32 v150, v216, v217
    v_cvt_pk_bf16_f32 v151, v218, v219
    buffer_store_dwordx4 v[148:151], v3, s[4:7], s49 offen offset:256 sc1
    s_add_u32 s49, s49, 2048
    v_cvt_pk_bf16_f32 v152, v188, v189
    v_cvt_pk_bf16_f32 v153, v190, v191
    v_cvt_pk_bf16_f32 v154, v192, v193
    v_cvt_pk_bf16_f32 v155, v194, v195
    buffer_store_dwordx4 v[152:155], v3, s[4:7], s49 offen offset:0 sc1
    v_cvt_pk_bf16_f32 v156, v220, v221
    v_cvt_pk_bf16_f32 v157, v222, v223
    v_cvt_pk_bf16_f32 v158, v224, v225
    v_cvt_pk_bf16_f32 v159, v226, v227
    buffer_store_dwordx4 v[156:159], v3, s[4:7], s49 offen offset:256 sc1
    s_add_u32 s49, s49, 2048
    v_cvt_pk_bf16_f32 v144, v196, v197
    v_cvt_pk_bf16_f32 v145, v198, v199
    v_cvt_pk_bf16_f32 v146, v200, v201
    v_cvt_pk_bf16_f32 v147, v202, v203
    buffer_store_dwordx4 v[144:147], v3, s[4:7], s49 offen offset:0 sc1
    v_cvt_pk_bf16_f32 v148, v228, v229
    v_cvt_pk_bf16_f32 v149, v230, v231
    v_cvt_pk_bf16_f32 v150, v232, v233
    v_cvt_pk_bf16_f32 v151, v234, v235
    buffer_store_dwordx4 v[148:151], v3, s[4:7], s49 offen offset:256 sc1
    s_add_u32 s49, s49, 2048
    v_cvt_pk_bf16_f32 v152, v204, v205
    v_cvt_pk_bf16_f32 v153, v206, v207
    v_cvt_pk_bf16_f32 v154, v208, v209
    v_cvt_pk_bf16_f32 v155, v210, v211
    buffer_store_dwordx4 v[152:155], v3, s[4:7], s49 offen offset:0 sc1
    v_cvt_pk_bf16_f32 v156, v236, v237
    v_cvt_pk_bf16_f32 v157, v238, v239
    v_cvt_pk_bf16_f32 v158, v240, v241
    v_cvt_pk_bf16_f32 v159, v242, v243
    buffer_store_dwordx4 v[156:159], v3, s[4:7], s49 offen offset:256 sc1
    s_lshr_b32 s41, s53, 3
    s_lshl_b32 s41, s41, 7
    s_add_u32 s41, s41, s47
    s_add_u32 s78, s41, 4224
    s_cmp_eq_u32 s30, 0
    s_cbranch_scc0 s2w0_218
    v_cmp_ne_u32 vcc, 0, v15
    s_nop 3
    s_cmp_eq_u64 vcc, -1
    s_cselect_b32 s67, 1, 0
    s_cmp_lt_u32 s69, 512
    s_cselect_b32 s67, s67, 0
    v_mov_b32 v13, 163792
    v_mov_b32 v14, s67
    ds_write_b32 v13, v14
    s_waitcnt lgkmcnt(0)
s2w0_218:
    s_barrier
    v_mov_b32 v13, 163792
    ds_read_b32 v14, v13
    s_waitcnt lgkmcnt(0)
    v_readfirstlane_b32 s67, v14
    s_nop 3
    s_mov_b32 s79, s67
    s_cmp_eq_u32 s79, 1
    s_cbranch_scc0 s2noq_210
    s_mul_i32 s48, s74, 786432
    s_add_u32 s48, s48, 6291456
    s_mul_i32 s40, s77, 24576
    s_add_u32 s48, s48, s40
    buffer_load_dwordx4 v[16:19], v1, s[4:7], s48 offen offset:0 sc1
    buffer_load_dwordx4 v[20:23], v1, s[4:7], s48 offen offset:1024 sc1
    buffer_load_dwordx4 v[24:27], v1, s[4:7], s48 offen offset:2048 sc1
    buffer_load_dwordx4 v[28:31], v1, s[4:7], s48 offen offset:3072 sc1
    s_add_u32 s48, s48, 4096
    buffer_load_dwordx4 v[32:35], v1, s[4:7], s48 offen offset:0 sc1
    buffer_load_dwordx4 v[36:39], v1, s[4:7], s48 offen offset:1024 sc1
    buffer_load_dwordx4 v[40:43], v1, s[4:7], s48 offen offset:2048 sc1
    buffer_load_dwordx4 v[44:47], v1, s[4:7], s48 offen offset:3072 sc1
    s_add_u32 s48, s48, 4096
    buffer_load_dwordx4 v[48:51], v1, s[4:7], s48 offen offset:0 sc1
    buffer_load_dwordx4 v[52:55], v1, s[4:7], s48 offen offset:1024 sc1
    buffer_load_dwordx4 v[56:59], v1, s[4:7], s48 offen offset:2048 sc1
    buffer_load_dwordx4 v[60:63], v1, s[4:7], s48 offen offset:3072 sc1
    s_add_u32 s48, s48, 4096
    buffer_load_dwordx4 v[64:67], v1, s[4:7], s48 offen offset:0 sc1
    buffer_load_dwordx4 v[68:71], v1, s[4:7], s48 offen offset:1024 sc1
    buffer_load_dwordx4 v[72:75], v1, s[4:7], s48 offen offset:2048 sc1
    buffer_load_dwordx4 v[76:79], v1, s[4:7], s48 offen offset:3072 sc1
    s_add_u32 s48, s48, 4096
    buffer_load_dwordx4 v[80:83], v1, s[4:7], s48 offen offset:0 sc1
    buffer_load_dwordx4 v[84:87], v1, s[4:7], s48 offen offset:1024 sc1
    buffer_load_dwordx4 v[88:91], v1, s[4:7], s48 offen offset:2048 sc1
    buffer_load_dwordx4 v[92:95], v1, s[4:7], s48 offen offset:3072 sc1
    s_add_u32 s48, s48, 4096
    buffer_load_dwordx4 v[96:99], v1, s[4:7], s48 offen offset:0 sc1
    buffer_load_dwordx4 v[100:103], v1, s[4:7], s48 offen offset:1024 sc1
    buffer_load_dwordx4 v[104:107], v1, s[4:7], s48 offen offset:2048 sc1
    buffer_load_dwordx4 v[108:111], v1, s[4:7], s48 offen offset:3072 sc1
    s_add_u32 s48, s48, 4096
    s_waitcnt vmcnt(24)
    s_branch s2sg_211
s2noq_210:
    s_waitcnt vmcnt(0)
s2sg_211:
    s_barrier
    s_cmp_eq_u32 s30, 0
    s_cbranch_scc0 ws_219
    s_mov_b64 exec, 1
    v_mov_b32 v13, 1
    v_mov_b32 v14, 0
    buffer_atomic_add v13, v14, s[4:7], s78 offen
    s_mov_b64 exec, -1
ws_219:
    s_mov_b32 s68, s69
    s_branch s2job_207
s2done_208:
    s_waitcnt vmcnt(0)
    s_branch L_exit
L_exit:
    s_endpgm

.section .rodata,"a"
.p2align 6
.amdhsa_kernel interleave_layers__memory_aug_recurrent_mem_tr__swiglu_ffn__prompt_kernel
  .amdhsa_next_free_vgpr 512
  .amdhsa_next_free_sgpr 102
  .amdhsa_accum_offset 256
  .amdhsa_group_segment_fixed_size 0
  .amdhsa_kernarg_size 112
  .amdhsa_user_sgpr_count 2
  .amdhsa_user_sgpr_kernarg_segment_ptr 1
  .amdhsa_system_sgpr_workgroup_id_x 1
.end_amdhsa_kernel
```
